```python
import torch

def _softmax(x, axis=-1):
    return torch.softmax(x, dim=axis)
def _gelu(x):
    return torch.nn.functional.gelu(x, approximate="tanh")
def _silu(x):
    return torch.nn.functional.silu(x)
def _sigmoid(x):
    return torch.sigmoid(x)
def _layernorm(x, axis=-1, eps=1e-5):
    m = x.mean(dim=axis, keepdim=True)
    v = x.var(dim=axis, keepdim=True, unbiased=False)
    return (x - m) / torch.sqrt(v + eps)
def _scatter_add(tgt, idx, src, axis=0):
    return tgt.clone().index_add_(axis, idx, src)
def _segment_sum(src, seg, n):
    out = torch.zeros((n,) + src.shape[1:], dtype=src.dtype)
    return out.index_add_(0, seg, src)
def _pad(x, pw):
    flat = tuple(v for pair in reversed(pw) for v in pair)
    return torch.nn.functional.pad(x, flat)

kernel_name = 'parallel_sum__grouped_kv_mqa__glu_gated_reglu__prompt'

def setup_inputs():

    _w = (lambda a: (lambda t: t.to(torch.bfloat16) if t.is_floating_point() else t)(torch.as_tensor(a)))
    def _A_setup():
        B, S, D, H = 1, 2048, 576, 32
        Dh = D // H
        return {
            "x": _w((lambda *s: torch.randn(*s, dtype=torch.bfloat16) * 0.05)(B, S, D)),
            "wq": _w((lambda *s: torch.randn(*s, dtype=torch.bfloat16) * 0.05)(D, H * Dh)),
            "wk": _w((lambda *s: torch.randn(*s, dtype=torch.bfloat16) * 0.05)(D, Dh)),
            "wv": _w((lambda *s: torch.randn(*s, dtype=torch.bfloat16) * 0.05)(D, Dh)),
            "wo": _w((lambda *s: torch.randn(*s, dtype=torch.bfloat16) * 0.05)(H * Dh, D)),
        }
    _A_in = _A_setup()

    def _B_setup():
        B, S, D, F = 1, 2048, 576, 4608
        return {
            "x": _w((lambda *s: torch.randn(*s, dtype=torch.bfloat16) * 0.05)(B, S, D)),
            "W_gate": _w((lambda *s: torch.randn(*s, dtype=torch.bfloat16) * 0.4)(D, F) * (2.0 / D) ** 0.5),
            "W_up": _w((lambda *s: torch.randn(*s, dtype=torch.bfloat16) * 0.4)(D, F) * (2.0 / D) ** 0.5),
            "W_down": _w((lambda *s: torch.randn(*s, dtype=torch.bfloat16) * 0.4)(F, D) * (1.0 / F) ** 0.5),
        }
    _B_in = _B_setup()

    return {
        "A_x": _A_in["x"],
        "A_wq": _A_in["wq"],
        "A_wk": _A_in["wk"],
        "A_wv": _A_in["wv"],
        "A_wo": _A_in["wo"],
        "B_x": _B_in["x"],
        "B_W_gate": _B_in["W_gate"],
        "B_W_up": _B_in["W_up"],
        "B_W_down": _B_in["W_down"],
    }

def reference(A_x, A_wq, A_wk, A_wv, A_wo, B_x, B_W_gate, B_W_up, B_W_down):
    def _A_ref(x, wq, wk, wv, wo):
        B, S, D = x.shape
        H = 32
        Dh = D // H
        q = (lambda x, *d: x.permute(*d))((x @ wq).reshape(B, S, H, Dh), 0, 2, 1, 3)
        k = x @ wk
        v = x @ wv
        scores = torch.einsum("bhqd,bkd->bhqk", q, k) * (Dh ** -0.5)
        p = _softmax(scores, axis=-1)
        o = torch.einsum("bhqk,bkd->bhqd", p, v)
        return (lambda x, *d: x.permute(*d))(o, 0, 2, 1, 3).reshape(B, S, H * Dh) @ wo

    def _B_ref(x, W_gate, W_up, W_down):
        gate = torch.einsum("bsd,df->bsf", x, W_gate)
        up = torch.einsum("bsd,df->bsf", x, W_up)
        gate = gate * (lambda x, dt: x.to(dt))(gate > 0, gate.dtype)
        h = gate * up
        return torch.einsum("bsf,fd->bsd", h, W_down)

    x = A_x
    xn = _layernorm(x, axis=-1)
    return x + _A_ref(xn, A_wq, A_wk, A_wv, A_wo) + _B_ref(xn, B_W_gate, B_W_up, B_W_down)
```

```asm
; @launch grid=(256,1,1) block=(512,1,1) lds=163840
.amdgcn_target "amdgcn-amd-amdhsa--gfx950"

.text
.globl parallel_sum__grouped_kv_mqa__glu_gated_reglu__prompt_kernel
.p2align 8
.type parallel_sum__grouped_kv_mqa__glu_gated_reglu__prompt_kernel,@function
parallel_sum__grouped_kv_mqa__glu_gated_reglu__prompt_kernel:
    s_cmp_ge_u32 s2, 256
    s_cbranch_scc1 END
    s_load_dwordx16 s[16:31], s[0:1], 0
    s_load_dwordx8 s[32:39], s[0:1], 64
    v_lshrrev_b32 v1, 6, v0
    v_mov_b32 v120, v0
    v_and_b32 v0, 63, v0
    v_readfirstlane_b32 s3, v1
    v_lshlrev_b32 v1, 4, v0
    s_lshr_b32 s4, s2, 4
    s_and_b32 s5, s2, 7
    s_lshl_b32 s5, s5, 1
    s_bfe_u32 s56, s2, 0x10003
    s_add_u32 s5, s5, s56
    s_lshl_b32 s56, s4, 7
    s_lshl_b32 s57, s5, 3
    s_add_u32 s56, s56, s57
    s_add_u32 s56, s56, s3
    s_mul_i32 s56, s56, 1152
    v_lshlrev_b32 v100, 5, v0
    v_mov_b32 v101, 0x7fffff00
    v_cmp_gt_u32 vcc, 36, v0
    s_lshl_b32 s57, s4, 7
    s_add_u32 s57, s57, 5554176
    v_cndmask_b32 v100, v101, v100, vcc
    s_mov_b32 s76, 0
    s_mov_b32 s77, 0
    v_mov_b32 v122, 0
    s_waitcnt lgkmcnt(0)
    s_mov_b32 s40, s16
    s_mov_b32 s41, s17
    s_mov_b32 s42, 2359296
    s_mov_b32 s43, 0x20000
    s_mov_b32 s44, s38
    s_mov_b32 s45, s39
    s_mov_b32 s46, 43319296
    s_mov_b32 s47, 0x20000
    buffer_load_dwordx4 v[104:107], v100, s[40:43], s56 offen
    buffer_load_dwordx4 v[108:111], v100, s[40:43], s56 offen offset:16
    s_mov_b32 s52, s36
    s_mov_b32 s53, s37
    s_mov_b32 s54, 256
    s_mov_b32 s55, 0x20000
    s_cmp_ge_u32 s3, 6
    s_cbranch_scc1 PRO_B0
    s_lshr_b32 s60, s2, 3
    s_mul_i32 s60, s60, 162
    v_subrev_u32 v121, 192, v120
    v_cmp_gt_u32 vcc, 192, v120
    s_nop 1
    v_cndmask_b32 v121, v121, v120, vcc
    v_min_u32 v121, 161, v121
    v_add_u32 v121, s60, v121
    v_mul_u32_u24 v122, 7282, v121
    v_lshrrev_b32 v122, 16, v122
    v_mul_u32_u24 v123, 9, v122
    v_sub_u32 v123, v121, v123
    s_movk_i32 s61, 0x2400
    v_mul_lo_u32 v122, v122, s61
    v_lshl_add_u32 v122, v123, 7, v122
    v_lshlrev_b32 v123, 7, v121
    s_and_b32 s62, s2, 7
    s_mul_i32 s61, s62, 1152
    s_mul_i32 s62, s62, 663552
    s_cmp_ge_u32 s3, 3
    s_cselect_b32 s40, s30, s28
    s_cselect_b32 s41, s31, s29
    s_mov_b32 s42, 5308416
    s_mov_b32 s48, s32
    s_mov_b32 s49, s33
    s_mov_b32 s50, 5308416
    s_mov_b32 s51, 0x20000
    v_lshlrev_b32 v123, 17, v0
    buffer_load_dword v124, v123, s[40:43], s61 offen
    s_cbranch_scc1 PRO_A1
    buffer_load_dword v125, v123, s[48:51], s61 offen
    s_branch PRO_LN
PRO_A1:
    s_getpc_b64 s[62:63]
PC_REF:
    s_sub_u32 s62, s62, PC_REF-parallel_sum__grouped_kv_mqa__glu_gated_reglu__prompt_kernel
    s_subb_u32 s63, s63, 0
    s_lshr_b32 s60, s2, 3
    s_and_b32 s60, s60, 3
    s_mul_i32 s60, s60, 16384
    v_subrev_u32 v123, 192, v120
    v_lshlrev_b32 v123, 7, v123
    v_min_u32 v123, 16256, v123
    v_add_u32 v123, s60, v123
    v_min_u32 v123, CODE_END-parallel_sum__grouped_kv_mqa__glu_gated_reglu__prompt_kernel-4, v123
    global_load_dword v125, v123, s[62:63]
    s_branch PRO_LN
PRO_B0:
    buffer_load_dwordx2 v[124:125], off, s[44:47], s57 sc1
    s_nop 0
    s_mul_i32 s57, s4, 147456
    buffer_load_dword v126, off, s[44:47], s57 sc1
PRO_LN:
    s_waitcnt vmcnt(2)
LN_GO:
    v_lshlrev_b32 v128, 16, v104
    v_and_b32 v129, 0xffff0000, v104
    v_lshlrev_b32 v130, 16, v105
    v_and_b32 v131, 0xffff0000, v105
    v_lshlrev_b32 v132, 16, v106
    v_and_b32 v133, 0xffff0000, v106
    v_lshlrev_b32 v134, 16, v107
    v_and_b32 v135, 0xffff0000, v107
    v_lshlrev_b32 v136, 16, v108
    v_and_b32 v137, 0xffff0000, v108
    v_lshlrev_b32 v138, 16, v109
    v_and_b32 v139, 0xffff0000, v109
    v_lshlrev_b32 v140, 16, v110
    v_and_b32 v141, 0xffff0000, v110
    v_lshlrev_b32 v142, 16, v111
    v_and_b32 v143, 0xffff0000, v111
    v_add_f32 v144, v128, v136
    v_add_f32 v145, v129, v137
    v_add_f32 v146, v130, v138
    v_add_f32 v147, v131, v139
    v_add_f32 v148, v132, v140
    v_add_f32 v149, v133, v141
    v_add_f32 v150, v134, v142
    v_add_f32 v151, v135, v143
    v_add_f32 v144, v144, v148
    v_add_f32 v145, v145, v149
    v_add_f32 v146, v146, v150
    v_add_f32 v147, v147, v151
    v_add_f32 v144, v144, v146
    v_add_f32 v145, v145, v147
    v_add_f32 v144, v144, v145
    s_nop 1
    v_add_f32_dpp v144, v144, v144 row_shr:1 row_mask:0xf bank_mask:0xf bound_ctrl:0
    s_nop 1
    v_add_f32_dpp v144, v144, v144 row_shr:2 row_mask:0xf bank_mask:0xf bound_ctrl:0
    s_nop 1
    v_add_f32_dpp v144, v144, v144 row_shr:4 row_mask:0xf bank_mask:0xf bound_ctrl:0
    s_nop 1
    v_add_f32_dpp v144, v144, v144 row_shr:8 row_mask:0xf bank_mask:0xf bound_ctrl:0
    s_nop 1
    v_add_f32_dpp v144, v144, v144 row_bcast:15 row_mask:0xa bank_mask:0xf
    s_nop 1
    v_add_f32_dpp v144, v144, v144 row_bcast:31 row_mask:0xc bank_mask:0xf
    s_nop 1
    v_readlane_b32 s58, v144, 63
    s_nop 1
    v_mov_b32 v102, 0x3ae38e39
    v_mul_f32 v102, s58, v102
    v_mov_b32 v144, 0
    v_mov_b32 v145, 0
    s_mov_b32 exec_hi, 15
    v_sub_f32 v146, v128, v102
    v_fmac_f32 v144, v146, v146
    v_sub_f32 v147, v129, v102
    v_fmac_f32 v145, v147, v147
    v_sub_f32 v146, v130, v102
    v_fmac_f32 v144, v146, v146
    v_sub_f32 v147, v131, v102
    v_fmac_f32 v145, v147, v147
    v_sub_f32 v146, v132, v102
    v_fmac_f32 v144, v146, v146
    v_sub_f32 v147, v133, v102
    v_fmac_f32 v145, v147, v147
    v_sub_f32 v146, v134, v102
    v_fmac_f32 v144, v146, v146
    v_sub_f32 v147, v135, v102
    v_fmac_f32 v145, v147, v147
    v_sub_f32 v146, v136, v102
    v_fmac_f32 v144, v146, v146
    v_sub_f32 v147, v137, v102
    v_fmac_f32 v145, v147, v147
    v_sub_f32 v146, v138, v102
    v_fmac_f32 v144, v146, v146
    v_sub_f32 v147, v139, v102
    v_fmac_f32 v145, v147, v147
    v_sub_f32 v146, v140, v102
    v_fmac_f32 v144, v146, v146
    v_sub_f32 v147, v141, v102
    v_fmac_f32 v145, v147, v147
    v_sub_f32 v146, v142, v102
    v_fmac_f32 v144, v146, v146
    v_sub_f32 v147, v143, v102
    v_fmac_f32 v145, v147, v147
    v_add_f32 v144, v144, v145
    s_mov_b32 exec_hi, -1
    s_nop 3
    s_nop 1
    v_add_f32_dpp v144, v144, v144 row_shr:1 row_mask:0xf bank_mask:0xf bound_ctrl:0
    s_nop 1
    v_add_f32_dpp v144, v144, v144 row_shr:2 row_mask:0xf bank_mask:0xf bound_ctrl:0
    s_nop 1
    v_add_f32_dpp v144, v144, v144 row_shr:4 row_mask:0xf bank_mask:0xf bound_ctrl:0
    s_nop 1
    v_add_f32_dpp v144, v144, v144 row_shr:8 row_mask:0xf bank_mask:0xf bound_ctrl:0
    s_nop 1
    v_add_f32_dpp v144, v144, v144 row_bcast:15 row_mask:0xa bank_mask:0xf
    s_nop 1
    v_add_f32_dpp v144, v144, v144 row_bcast:31 row_mask:0xc bank_mask:0xf
    s_nop 1
    v_readlane_b32 s58, v144, 63
    s_nop 1
    v_mov_b32 v103, 0x3ae38e39
    v_mul_f32 v103, s58, v103
    v_cvt_pk_bf16_f32 v101, v102, v103
    v_lshlrev_b32 v102, 16, v101
    v_and_b32 v103, 0xffff0000, v101
    v_add_f32 v103, 0x3727c5ac, v103
    v_cvt_pk_bf16_f32 v103, v103, v103
    v_lshlrev_b32 v103, 16, v103
    v_sqrt_f32 v103, v103
    s_nop 0
    v_cvt_pk_bf16_f32 v103, v103, v103
    v_lshlrev_b32 v103, 16, v103
    v_rcp_f32 v103, v103
    v_sub_f32 v128, v128, v102
    v_sub_f32 v129, v129, v102
    v_sub_f32 v130, v130, v102
    v_sub_f32 v131, v131, v102
    v_sub_f32 v132, v132, v102
    v_sub_f32 v133, v133, v102
    v_sub_f32 v134, v134, v102
    v_sub_f32 v135, v135, v102
    v_sub_f32 v136, v136, v102
    v_sub_f32 v137, v137, v102
    v_sub_f32 v138, v138, v102
    v_sub_f32 v139, v139, v102
    v_sub_f32 v140, v140, v102
    v_sub_f32 v141, v141, v102
    v_sub_f32 v142, v142, v102
    v_sub_f32 v143, v143, v102
    v_cvt_pk_bf16_f32 v112, v128, v129
    v_cvt_pk_bf16_f32 v113, v130, v131
    v_cvt_pk_bf16_f32 v114, v132, v133
    v_cvt_pk_bf16_f32 v115, v134, v135
    v_cvt_pk_bf16_f32 v116, v136, v137
    v_cvt_pk_bf16_f32 v117, v138, v139
    v_cvt_pk_bf16_f32 v118, v140, v141
    v_cvt_pk_bf16_f32 v119, v142, v143
    v_lshlrev_b32 v128, 16, v112
    v_and_b32 v129, 0xffff0000, v112
    v_lshlrev_b32 v130, 16, v113
    v_and_b32 v131, 0xffff0000, v113
    v_lshlrev_b32 v132, 16, v114
    v_and_b32 v133, 0xffff0000, v114
    v_lshlrev_b32 v134, 16, v115
    v_and_b32 v135, 0xffff0000, v115
    v_lshlrev_b32 v136, 16, v116
    v_and_b32 v137, 0xffff0000, v116
    v_lshlrev_b32 v138, 16, v117
    v_and_b32 v139, 0xffff0000, v117
    v_lshlrev_b32 v140, 16, v118
    v_and_b32 v141, 0xffff0000, v118
    v_lshlrev_b32 v142, 16, v119
    v_and_b32 v143, 0xffff0000, v119
    v_mul_f32 v128, v128, v103
    v_mul_f32 v129, v129, v103
    v_mul_f32 v130, v130, v103
    v_mul_f32 v131, v131, v103
    v_mul_f32 v132, v132, v103
    v_mul_f32 v133, v133, v103
    v_mul_f32 v134, v134, v103
    v_mul_f32 v135, v135, v103
    v_mul_f32 v136, v136, v103
    v_mul_f32 v137, v137, v103
    v_mul_f32 v138, v138, v103
    v_mul_f32 v139, v139, v103
    v_mul_f32 v140, v140, v103
    v_mul_f32 v141, v141, v103
    v_mul_f32 v142, v142, v103
    v_mul_f32 v143, v143, v103
    v_cvt_pk_bf16_f32 v112, v128, v129
    v_cvt_pk_bf16_f32 v113, v130, v131
    v_cvt_pk_bf16_f32 v114, v132, v133
    v_cvt_pk_bf16_f32 v115, v134, v135
    v_cvt_pk_bf16_f32 v116, v136, v137
    v_cvt_pk_bf16_f32 v117, v138, v139
    v_cvt_pk_bf16_f32 v118, v140, v141
    v_cvt_pk_bf16_f32 v119, v142, v143
    s_mul_i32 s58, s3, 1168
    s_add_u32 s58, s58, 153984
    v_lshlrev_b32 v100, 5, v0
    v_add_u32 v100, s58, v100
    s_mov_b32 exec_hi, 15
    ds_write_b128 v100, v[112:115]
    ds_write_b128 v100, v[116:119] offset:16
    s_mov_b32 exec_hi, -1
    s_waitcnt lgkmcnt(0)
    s_barrier
    s_cmp_lt_u32 s3, 4
    s_cbranch_scc1 PRO_NOPRIO
    s_setprio 1
PRO_NOPRIO:
    s_cmp_ge_u32 s3, 6
    s_cbranch_scc1 PRO_B
    s_mov_b32 s48, s32
    s_mov_b32 s49, s33
    s_mov_b32 s50, 5308416
    s_mov_b32 s51, 0x20000
    s_cmp_ge_u32 s3, 3
    s_cselect_b32 s40, s30, s28
    s_cselect_b32 s41, s31, s29
    s_mov_b32 s42, 5308416
    s_cselect_b32 s8, 9248, 0
    s_cselect_b32 s58, 3, 0
    s_sub_u32 s58, s3, s58
    s_mul_i32 s59, s58, 3072
    s_add_u32 s8, s8, s59
    s_mul_i32 s59, s58, 192
    s_mul_i32 s6, s5, 576
    s_mov_b32 s60, 9216
    s_and_b32 s61, s2, 7
    s_mul_i32 s61, s61, 1152
    v_add_u32 v104, s59, v0
    v_mul_u32_u24 v105, 1821, v104
    v_lshrrev_b32 v105, 16, v105
    v_mul_u32_u24 v7, 36, v105
    v_sub_u32 v104, v104, v7
    v_bfe_u32 v7, v105, 3, 1
    v_lshlrev_b32 v7, 1, v7
    v_xor_b32 v104, v104, v7
    v_mul_lo_u32 v105, v105, s60
    v_lshl_add_u32 v7, v104, 4, v105
    v_add_u32 v104, s59, v0
    v_add_u32 v104, 64, v104
    v_mul_u32_u24 v105, 1821, v104
    v_lshrrev_b32 v105, 16, v105
    v_mul_u32_u24 v8, 36, v105
    v_sub_u32 v104, v104, v8
    v_bfe_u32 v8, v105, 3, 1
    v_lshlrev_b32 v8, 1, v8
    v_xor_b32 v104, v104, v8
    v_mul_lo_u32 v105, v105, s60
    v_lshl_add_u32 v8, v104, 4, v105
    v_add_u32 v104, s59, v0
    v_add_u32 v104, 128, v104
    v_mul_u32_u24 v105, 1821, v104
    v_lshrrev_b32 v105, 16, v105
    v_mul_u32_u24 v9, 36, v105
    v_sub_u32 v104, v104, v9
    v_bfe_u32 v9, v105, 3, 1
    v_lshlrev_b32 v9, 1, v9
    v_xor_b32 v104, v104, v9
    v_mul_lo_u32 v105, v105, s60
    v_lshl_add_u32 v9, v104, 4, v105
    s_barrier
    buffer_load_dword v124, v122, s[40:43], s61 offen
    s_add_u32 m0, s8, 102656
    s_nop 0
    buffer_load_dwordx4 v7, s[40:43], s6 offen lds
    s_add_u32 m0, s8, 103680
    s_nop 0
    buffer_load_dwordx4 v8, s[40:43], s6 offen lds
    s_add_u32 m0, s8, 104704
    s_nop 0
    buffer_load_dwordx4 v9, s[40:43], s6 offen lds
    s_add_u32 s6, s6, 147456
    s_add_u32 m0, s8, 128320
    s_nop 0
    buffer_load_dwordx4 v7, s[40:43], s6 offen lds
    s_add_u32 m0, s8, 129344
    s_nop 0
    buffer_load_dwordx4 v8, s[40:43], s6 offen lds
    s_add_u32 m0, s8, 130368
    s_nop 0
    buffer_load_dwordx4 v9, s[40:43], s6 offen lds
    s_add_u32 s6, s6, 147456
    s_mul_i32 s59, s3, 192
    s_mul_i32 s11, s3, 3072
    s_mul_i32 s10, s5, 331776
    v_add_u32 v104, s59, v0
    v_lshrrev_b32 v105, 3, v104
    v_mul_u32_u24 v105, 7282, v105
    v_lshrrev_b32 v105, 16, v105
    v_mul_u32_u24 v11, 72, v105
    v_sub_u32 v104, v104, v11
    v_bfe_u32 v11, v105, 1, 1
    v_lshlrev_b32 v11, 2, v11
    v_xor_b32 v104, v104, v11
    v_mul_u32_u24 v105, 1152, v105
    v_lshl_add_u32 v11, v104, 4, v105
    v_add_u32 v104, s59, v0
    v_add_u32 v104, 64, v104
    v_lshrrev_b32 v105, 3, v104
    v_mul_u32_u24 v105, 7282, v105
    v_lshrrev_b32 v105, 16, v105
    v_mul_u32_u24 v12, 72, v105
    v_sub_u32 v104, v104, v12
    v_bfe_u32 v12, v105, 1, 1
    v_lshlrev_b32 v12, 2, v12
    v_xor_b32 v104, v104, v12
    v_mul_u32_u24 v105, 1152, v105
    v_lshl_add_u32 v12, v104, 4, v105
    v_add_u32 v104, s59, v0
    v_add_u32 v104, 128, v104
    v_lshrrev_b32 v105, 3, v104
    v_mul_u32_u24 v105, 7282, v105
    v_lshrrev_b32 v105, 16, v105
    v_mul_u32_u24 v13, 72, v105
    v_sub_u32 v104, v104, v13
    v_bfe_u32 v13, v105, 1, 1
    v_lshlrev_b32 v13, 2, v13
    v_xor_b32 v104, v104, v13
    v_mul_u32_u24 v105, 1152, v105
    v_lshl_add_u32 v13, v104, 4, v105
    v_lshrrev_b32 v112, 5, v0
    v_bfe_u32 v113, v0, 2, 2
    v_bfe_u32 v114, v0, 4, 1
    v_and_b32 v115, 3, v0
    s_lshr_b32 s56, s3, 1
    s_and_b32 s57, s3, 1
    v_lshl_add_u32 v116, v114, 3, v113
    v_mul_u32_u24 v117, 25664, v112
    v_add_u32 v117, 102656, v117
    v_mul_u32_u24 v2, 576, v116
    v_add_u32 v2, v2, v117
    v_lshl_add_u32 v2, v115, 3, v2
    s_mul_i32 s58, s56, 160
    v_add_u32 v2, s58, v2
    v_lshlrev_b32 v118, 5, v114
    v_sub_u32 v119, 0, v118
    s_and_b32 s58, s56, 1
    s_cmp_eq_u32 s58, 0
    s_cselect_b64 s[74:75], -1, 0
    v_cndmask_b32 v5, v119, v118, s[74:75]
    v_sub_u32 v3, v2, v5
    v_add_u32 v2, v2, v5
    v_lshl_add_u32 v117, v116, 6, v117
    v_add_u32 v5, v117, v118
    v_lshl_add_u32 v5, v115, 3, v5
    v_add_u32 v5, 18464, v5
    v_xor_b32 v118, 32, v118
    v_and_b32 v119, 1, v115
    v_lshl_add_u32 v118, v119, 10, v118
    v_add_u32 v118, 18464, v118
    v_lshlrev_b32 v119, 3, v119
    v_add_u32 v119, 20512, v119
    v_cmp_gt_u32 vcc, 2, v115
    s_nop 1
    v_cndmask_b32 v118, v119, v118, vcc
    v_add_u32 v6, v117, v118
    s_mul_i32 s58, s57, 25664
    s_add_u32 s58, s58, 124192
    v_add_u32 v4, s58, v1
    s_add_u32 m0, s8, 51328
    s_nop 0
    buffer_load_dwordx4 v7, s[40:43], s6 offen lds
    s_add_u32 m0, s8, 52352
    s_nop 0
    buffer_load_dwordx4 v8, s[40:43], s6 offen lds
    s_add_u32 m0, s8, 53376
    s_nop 0
    buffer_load_dwordx4 v9, s[40:43], s6 offen lds
    s_add_u32 s6, s6, 147456
    s_add_u32 m0, s8, 76992
    s_nop 0
    buffer_load_dwordx4 v7, s[40:43], s6 offen lds
    s_add_u32 m0, s8, 78016
    s_nop 0
    buffer_load_dwordx4 v8, s[40:43], s6 offen lds
    s_add_u32 m0, s8, 79040
    s_nop 0
    buffer_load_dwordx4 v9, s[40:43], s6 offen lds
    s_add_u32 s6, s6, 147456
    s_waitcnt vmcnt(6)
    s_barrier
    ds_read_b128 v[64:67], v4 offset:0
    ds_read_b128 v[68:71], v4 offset:1024
    ds_read_b128 v[72:75], v4 offset:2048
    ds_read_b128 v[76:79], v4 offset:3072
    ds_read_b64_tr_b16 v[16:17], v2 offset:0
    ds_read_b64_tr_b16 v[18:19], v2 offset:2304
    ds_read_b64_tr_b16 v[20:21], v2 offset:9248
    ds_read_b64_tr_b16 v[22:23], v2 offset:11552
    ds_read_b64_tr_b16 v[24:25], v3 offset:32
    ds_read_b64_tr_b16 v[26:27], v3 offset:2336
    ds_read_b64_tr_b16 v[28:29], v3 offset:9280
    ds_read_b64_tr_b16 v[30:31], v3 offset:11584
    ds_read_b64_tr_b16 v[32:33], v2 offset:64
    ds_read_b64_tr_b16 v[34:35], v2 offset:2368
    ds_read_b64_tr_b16 v[36:37], v2 offset:9312
    ds_read_b64_tr_b16 v[38:39], v2 offset:11616
    ds_read_b64_tr_b16 v[40:41], v3 offset:96
    ds_read_b64_tr_b16 v[42:43], v3 offset:2400
    ds_read_b64_tr_b16 v[44:45], v3 offset:9344
    ds_read_b64_tr_b16 v[46:47], v3 offset:11648
    ds_read_b64_tr_b16 v[48:49], v2 offset:128
    ds_read_b64_tr_b16 v[50:51], v2 offset:2432
    ds_read_b64_tr_b16 v[52:53], v2 offset:9376
    ds_read_b64_tr_b16 v[54:55], v2 offset:11680
    s_waitcnt vmcnt(0) lgkmcnt(0)
    s_barrier
    v_mfma_f32_16x16x32_bf16 v[96:99], v[16:19], v[64:67], 0
    v_subrev_u32 v4, 51328, v4
    v_subrev_u32 v2, 51328, v2
    v_mfma_f32_16x16x32_bf16 v[100:103], v[16:19], v[68:71], 0
    v_subrev_u32 v3, 51328, v3
    ds_read_b128 v[80:83], v4 offset:0
    v_mfma_f32_16x16x32_bf16 v[104:107], v[16:19], v[72:75], 0
    ds_read_b128 v[84:87], v4 offset:1024
    ds_read_b128 v[88:91], v4 offset:2048
    v_mfma_f32_16x16x32_bf16 v[108:111], v[16:19], v[76:79], 0
    ds_read_b64_tr_b16 v[16:17], v2 offset:0
    ds_read_b64_tr_b16 v[18:19], v2 offset:2304
    v_mfma_f32_16x16x32_bf16 v[112:115], v[20:23], v[64:67], 0
    ds_read_b128 v[92:95], v4 offset:3072
    ds_read_b64_tr_b16 v[56:57], v2 offset:128
    v_mfma_f32_16x16x32_bf16 v[116:119], v[20:23], v[68:71], 0
    ds_read_b64_tr_b16 v[58:59], v2 offset:2432
    ds_read_b64_tr_b16 v[60:61], v2 offset:9376
    v_mfma_f32_16x16x32_bf16 v[120:123], v[20:23], v[72:75], 0
    ds_read_b64_tr_b16 v[62:63], v2 offset:11680
    s_add_u32 m0, s8, 0
    v_mfma_f32_16x16x32_bf16 v[124:127], v[20:23], v[76:79], 0
    ds_read_b64_tr_b16 v[20:21], v2 offset:9248
    ds_read_b64_tr_b16 v[22:23], v2 offset:11552
    v_mfma_f32_16x16x32_bf16 v[128:131], v[24:27], v[64:67], 0
    buffer_load_dwordx4 v7, s[40:43], s6 offen lds
    s_add_u32 m0, s8, 1024
    v_mfma_f32_16x16x32_bf16 v[132:135], v[24:27], v[68:71], 0
    buffer_load_dwordx4 v8, s[40:43], s6 offen lds
    s_add_u32 m0, s8, 2048
    v_mfma_f32_16x16x32_bf16 v[136:139], v[24:27], v[72:75], 0
    buffer_load_dwordx4 v9, s[40:43], s6 offen lds
    s_add_u32 s6, s6, 147456
    v_mfma_f32_16x16x32_bf16 v[140:143], v[24:27], v[76:79], 0
    ds_read_b64_tr_b16 v[24:25], v3 offset:32
    ds_read_b64_tr_b16 v[26:27], v3 offset:2336
    v_mfma_f32_16x16x32_bf16 v[144:147], v[28:31], v[64:67], 0
    s_add_u32 m0, s8, 25664
    v_mfma_f32_16x16x32_bf16 v[148:151], v[28:31], v[68:71], 0
    buffer_load_dwordx4 v7, s[40:43], s6 offen lds
    s_add_u32 m0, s8, 26688
    v_mfma_f32_16x16x32_bf16 v[152:155], v[28:31], v[72:75], 0
    buffer_load_dwordx4 v8, s[40:43], s6 offen lds
    v_mfma_f32_16x16x32_bf16 v[156:159], v[28:31], v[76:79], 0
    ds_read_b64_tr_b16 v[28:29], v3 offset:9280
    ds_read_b64_tr_b16 v[30:31], v3 offset:11584
    v_mfma_f32_16x16x32_bf16 v[160:163], v[32:35], v[64:67], 0
    s_add_u32 m0, s8, 27712
    v_mfma_f32_16x16x32_bf16 v[164:167], v[32:35], v[68:71], 0
    buffer_load_dwordx4 v9, s[40:43], s6 offen lds
    v_mfma_f32_16x16x32_bf16 v[168:171], v[32:35], v[72:75], 0
    s_add_u32 s6, s6, 147456
    v_mfma_f32_16x16x32_bf16 v[172:175], v[32:35], v[76:79], 0
    ds_read_b64_tr_b16 v[32:33], v2 offset:64
    ds_read_b64_tr_b16 v[34:35], v2 offset:2368
    v_mfma_f32_16x16x32_bf16 v[176:179], v[36:39], v[64:67], 0
    s_add_u32 m0, s8, 102656
    v_mfma_f32_16x16x32_bf16 v[180:183], v[36:39], v[68:71], 0
    buffer_load_dwordx4 v7, s[40:43], s6 offen lds
    v_mfma_f32_16x16x32_bf16 v[184:187], v[36:39], v[72:75], 0
    s_add_u32 m0, s8, 103680
    v_mfma_f32_16x16x32_bf16 v[188:191], v[36:39], v[76:79], 0
    ds_read_b64_tr_b16 v[36:37], v2 offset:9312
    v_mfma_f32_16x16x32_bf16 v[192:195], v[40:43], v[64:67], 0
    ds_read_b64_tr_b16 v[38:39], v2 offset:11616
    v_mfma_f32_16x16x32_bf16 v[196:199], v[40:43], v[68:71], 0
    buffer_load_dwordx4 v8, s[40:43], s6 offen lds
    v_mfma_f32_16x16x32_bf16 v[200:203], v[40:43], v[72:75], 0
    s_add_u32 m0, s8, 104704
    v_mfma_f32_16x16x32_bf16 v[204:207], v[40:43], v[76:79], 0
    ds_read_b64_tr_b16 v[40:41], v3 offset:96
    v_mfma_f32_16x16x32_bf16 v[208:211], v[44:47], v[64:67], 0
    ds_read_b64_tr_b16 v[42:43], v3 offset:2400
    v_mfma_f32_16x16x32_bf16 v[212:215], v[44:47], v[68:71], 0
    buffer_load_dwordx4 v9, s[40:43], s6 offen lds
    v_mfma_f32_16x16x32_bf16 v[216:219], v[44:47], v[72:75], 0
    s_add_u32 s6, s6, 147456
    v_mfma_f32_16x16x32_bf16 v[220:223], v[44:47], v[76:79], 0
    ds_read_b64_tr_b16 v[44:45], v3 offset:9344
    v_mfma_f32_16x16x32_bf16 v[224:227], v[48:51], v[64:67], 0
    ds_read_b64_tr_b16 v[46:47], v3 offset:11648
    v_mfma_f32_16x16x32_bf16 v[228:231], v[48:51], v[68:71], 0
    s_add_u32 m0, s8, 128320
    v_mfma_f32_16x16x32_bf16 v[232:235], v[48:51], v[72:75], 0
    buffer_load_dwordx4 v7, s[40:43], s6 offen lds
    v_mfma_f32_16x16x32_bf16 v[236:239], v[48:51], v[76:79], 0
    s_add_u32 m0, s8, 129344
    v_mfma_f32_16x16x32_bf16 v[240:243], v[52:55], v[64:67], 0
    buffer_load_dwordx4 v8, s[40:43], s6 offen lds
    v_mfma_f32_16x16x32_bf16 v[244:247], v[52:55], v[68:71], 0
    s_add_u32 m0, s8, 130368
    v_mfma_f32_16x16x32_bf16 v[248:251], v[52:55], v[72:75], 0
    buffer_load_dwordx4 v9, s[40:43], s6 offen lds
    v_mfma_f32_16x16x32_bf16 v[252:255], v[52:55], v[76:79], 0
    s_add_u32 s6, s6, 147456
    s_mov_b32 s12, 2
G1A:
    s_waitcnt vmcnt(6) lgkmcnt(0)
    s_barrier
    v_mfma_f32_16x16x32_bf16 v[96:99], v[16:19], v[80:83], v[96:99]
    v_subrev_u32 v4, 51328, v4
    v_mfma_f32_16x16x32_bf16 v[100:103], v[16:19], v[84:87], v[100:103]
    v_subrev_u32 v2, 51328, v2
    v_mfma_f32_16x16x32_bf16 v[104:107], v[16:19], v[88:91], v[104:107]
    v_subrev_u32 v3, 51328, v3
    v_mfma_f32_16x16x32_bf16 v[108:111], v[16:19], v[92:95], v[108:111]
    ds_read_b64_tr_b16 v[16:17], v2 offset:0
    ds_read_b64_tr_b16 v[18:19], v2 offset:2304
    v_mfma_f32_16x16x32_bf16 v[112:115], v[20:23], v[80:83], v[112:115]
    ds_read_b128 v[64:67], v4 offset:0
    v_mfma_f32_16x16x32_bf16 v[116:119], v[20:23], v[84:87], v[116:119]
    ds_read_b128 v[68:71], v4 offset:1024
    v_mfma_f32_16x16x32_bf16 v[120:123], v[20:23], v[88:91], v[120:123]
    ds_read_b128 v[72:75], v4 offset:2048
    v_mfma_f32_16x16x32_bf16 v[124:127], v[20:23], v[92:95], v[124:127]
    ds_read_b64_tr_b16 v[20:21], v2 offset:9248
    v_mfma_f32_16x16x32_bf16 v[128:131], v[24:27], v[80:83], v[128:131]
    ds_read_b64_tr_b16 v[22:23], v2 offset:11552
    v_mfma_f32_16x16x32_bf16 v[132:135], v[24:27], v[84:87], v[132:135]
    ds_read_b128 v[76:79], v4 offset:3072
    v_mfma_f32_16x16x32_bf16 v[136:139], v[24:27], v[88:91], v[136:139]
    ds_read_b64_tr_b16 v[48:49], v2 offset:128
    v_mfma_f32_16x16x32_bf16 v[140:143], v[24:27], v[92:95], v[140:143]
    ds_read_b64_tr_b16 v[24:25], v3 offset:32
    v_mfma_f32_16x16x32_bf16 v[144:147], v[28:31], v[80:83], v[144:147]
    ds_read_b64_tr_b16 v[26:27], v3 offset:2336
    v_mfma_f32_16x16x32_bf16 v[148:151], v[28:31], v[84:87], v[148:151]
    ds_read_b64_tr_b16 v[50:51], v2 offset:2432
    v_mfma_f32_16x16x32_bf16 v[152:155], v[28:31], v[88:91], v[152:155]
    ds_read_b64_tr_b16 v[52:53], v2 offset:9376
    v_mfma_f32_16x16x32_bf16 v[156:159], v[28:31], v[92:95], v[156:159]
    ds_read_b64_tr_b16 v[28:29], v3 offset:9280
    v_mfma_f32_16x16x32_bf16 v[160:163], v[32:35], v[80:83], v[160:163]
    ds_read_b64_tr_b16 v[30:31], v3 offset:11584
    v_mfma_f32_16x16x32_bf16 v[164:167], v[32:35], v[84:87], v[164:167]
    ds_read_b64_tr_b16 v[54:55], v2 offset:11680
    v_mfma_f32_16x16x32_bf16 v[168:171], v[32:35], v[88:91], v[168:171]
    s_add_u32 m0, s8, 51328
    v_mfma_f32_16x16x32_bf16 v[172:175], v[32:35], v[92:95], v[172:175]
    ds_read_b64_tr_b16 v[32:33], v2 offset:64
    v_mfma_f32_16x16x32_bf16 v[176:179], v[36:39], v[80:83], v[176:179]
    ds_read_b64_tr_b16 v[34:35], v2 offset:2368
    v_mfma_f32_16x16x32_bf16 v[180:183], v[36:39], v[84:87], v[180:183]
    buffer_load_dwordx4 v7, s[40:43], s6 offen lds
    v_mfma_f32_16x16x32_bf16 v[184:187], v[36:39], v[88:91], v[184:187]
    s_add_u32 m0, s8, 52352
    v_mfma_f32_16x16x32_bf16 v[188:191], v[36:39], v[92:95], v[188:191]
    ds_read_b64_tr_b16 v[36:37], v2 offset:9312
    v_mfma_f32_16x16x32_bf16 v[192:195], v[40:43], v[80:83], v[192:195]
    ds_read_b64_tr_b16 v[38:39], v2 offset:11616
    v_mfma_f32_16x16x32_bf16 v[196:199], v[40:43], v[84:87], v[196:199]
    buffer_load_dwordx4 v8, s[40:43], s6 offen lds
    v_mfma_f32_16x16x32_bf16 v[200:203], v[40:43], v[88:91], v[200:203]
    s_add_u32 m0, s8, 53376
    v_mfma_f32_16x16x32_bf16 v[204:207], v[40:43], v[92:95], v[204:207]
    ds_read_b64_tr_b16 v[40:41], v3 offset:96
    v_mfma_f32_16x16x32_bf16 v[208:211], v[44:47], v[80:83], v[208:211]
    ds_read_b64_tr_b16 v[42:43], v3 offset:2400
    v_mfma_f32_16x16x32_bf16 v[212:215], v[44:47], v[84:87], v[212:215]
    buffer_load_dwordx4 v9, s[40:43], s6 offen lds
    v_mfma_f32_16x16x32_bf16 v[216:219], v[44:47], v[88:91], v[216:219]
    s_add_u32 s6, s6, 147456
    v_mfma_f32_16x16x32_bf16 v[220:223], v[44:47], v[92:95], v[220:223]
    ds_read_b64_tr_b16 v[44:45], v3 offset:9344
    v_mfma_f32_16x16x32_bf16 v[224:227], v[56:59], v[80:83], v[224:227]
    ds_read_b64_tr_b16 v[46:47], v3 offset:11648
    v_mfma_f32_16x16x32_bf16 v[228:231], v[56:59], v[84:87], v[228:231]
    s_add_u32 m0, s8, 76992
    v_mfma_f32_16x16x32_bf16 v[232:235], v[56:59], v[88:91], v[232:235]
    buffer_load_dwordx4 v7, s[40:43], s6 offen lds
    v_mfma_f32_16x16x32_bf16 v[236:239], v[56:59], v[92:95], v[236:239]
    s_add_u32 m0, s8, 78016
    v_mfma_f32_16x16x32_bf16 v[240:243], v[60:63], v[80:83], v[240:243]
    buffer_load_dwordx4 v8, s[40:43], s6 offen lds
    v_mfma_f32_16x16x32_bf16 v[244:247], v[60:63], v[84:87], v[244:247]
    s_add_u32 m0, s8, 79040
    v_mfma_f32_16x16x32_bf16 v[248:251], v[60:63], v[88:91], v[248:251]
    buffer_load_dwordx4 v9, s[40:43], s6 offen lds
    v_mfma_f32_16x16x32_bf16 v[252:255], v[60:63], v[92:95], v[252:255]
    s_add_u32 s6, s6, 147456
    s_waitcnt vmcnt(6) lgkmcnt(0)
    s_barrier
    v_mfma_f32_16x16x32_bf16 v[96:99], v[16:19], v[64:67], v[96:99]
    v_add_u32 v4, 102656, v4
    v_mfma_f32_16x16x32_bf16 v[100:103], v[16:19], v[68:71], v[100:103]
    v_add_u32 v2, 102656, v2
    v_mfma_f32_16x16x32_bf16 v[104:107], v[16:19], v[72:75], v[104:107]
    v_add_u32 v3, 102656, v3
    v_mfma_f32_16x16x32_bf16 v[108:111], v[16:19], v[76:79], v[108:111]
    ds_read_b64_tr_b16 v[16:17], v2 offset:0
    ds_read_b64_tr_b16 v[18:19], v2 offset:2304
    v_mfma_f32_16x16x32_bf16 v[112:115], v[20:23], v[64:67], v[112:115]
    ds_read_b128 v[80:83], v4 offset:0
    v_mfma_f32_16x16x32_bf16 v[116:119], v[20:23], v[68:71], v[116:119]
    ds_read_b128 v[84:87], v4 offset:1024
    v_mfma_f32_16x16x32_bf16 v[120:123], v[20:23], v[72:75], v[120:123]
    ds_read_b128 v[88:91], v4 offset:2048
    v_mfma_f32_16x16x32_bf16 v[124:127], v[20:23], v[76:79], v[124:127]
    ds_read_b64_tr_b16 v[20:21], v2 offset:9248
    v_mfma_f32_16x16x32_bf16 v[128:131], v[24:27], v[64:67], v[128:131]
    ds_read_b64_tr_b16 v[22:23], v2 offset:11552
    v_mfma_f32_16x16x32_bf16 v[132:135], v[24:27], v[68:71], v[132:135]
    ds_read_b128 v[92:95], v4 offset:3072
    v_mfma_f32_16x16x32_bf16 v[136:139], v[24:27], v[72:75], v[136:139]
    ds_read_b64_tr_b16 v[56:57], v2 offset:128
    v_mfma_f32_16x16x32_bf16 v[140:143], v[24:27], v[76:79], v[140:143]
    ds_read_b64_tr_b16 v[24:25], v3 offset:32
    v_mfma_f32_16x16x32_bf16 v[144:147], v[28:31], v[64:67], v[144:147]
    ds_read_b64_tr_b16 v[26:27], v3 offset:2336
    v_mfma_f32_16x16x32_bf16 v[148:151], v[28:31], v[68:71], v[148:151]
    ds_read_b64_tr_b16 v[58:59], v2 offset:2432
    v_mfma_f32_16x16x32_bf16 v[152:155], v[28:31], v[72:75], v[152:155]
    ds_read_b64_tr_b16 v[60:61], v2 offset:9376
    v_mfma_f32_16x16x32_bf16 v[156:159], v[28:31], v[76:79], v[156:159]
    ds_read_b64_tr_b16 v[28:29], v3 offset:9280
    v_mfma_f32_16x16x32_bf16 v[160:163], v[32:35], v[64:67], v[160:163]
    ds_read_b64_tr_b16 v[30:31], v3 offset:11584
    v_mfma_f32_16x16x32_bf16 v[164:167], v[32:35], v[68:71], v[164:167]
    ds_read_b64_tr_b16 v[62:63], v2 offset:11680
    v_mfma_f32_16x16x32_bf16 v[168:171], v[32:35], v[72:75], v[168:171]
    s_add_u32 m0, s8, 0
    v_mfma_f32_16x16x32_bf16 v[172:175], v[32:35], v[76:79], v[172:175]
    ds_read_b64_tr_b16 v[32:33], v2 offset:64
    v_mfma_f32_16x16x32_bf16 v[176:179], v[36:39], v[64:67], v[176:179]
    ds_read_b64_tr_b16 v[34:35], v2 offset:2368
    v_mfma_f32_16x16x32_bf16 v[180:183], v[36:39], v[68:71], v[180:183]
    buffer_load_dwordx4 v7, s[40:43], s6 offen lds
    v_mfma_f32_16x16x32_bf16 v[184:187], v[36:39], v[72:75], v[184:187]
    s_add_u32 m0, s8, 1024
    v_mfma_f32_16x16x32_bf16 v[188:191], v[36:39], v[76:79], v[188:191]
    ds_read_b64_tr_b16 v[36:37], v2 offset:9312
    v_mfma_f32_16x16x32_bf16 v[192:195], v[40:43], v[64:67], v[192:195]
    ds_read_b64_tr_b16 v[38:39], v2 offset:11616
    v_mfma_f32_16x16x32_bf16 v[196:199], v[40:43], v[68:71], v[196:199]
    buffer_load_dwordx4 v8, s[40:43], s6 offen lds
    v_mfma_f32_16x16x32_bf16 v[200:203], v[40:43], v[72:75], v[200:203]
    s_add_u32 m0, s8, 2048
    v_mfma_f32_16x16x32_bf16 v[204:207], v[40:43], v[76:79], v[204:207]
    ds_read_b64_tr_b16 v[40:41], v3 offset:96
    v_mfma_f32_16x16x32_bf16 v[208:211], v[44:47], v[64:67], v[208:211]
    ds_read_b64_tr_b16 v[42:43], v3 offset:2400
    v_mfma_f32_16x16x32_bf16 v[212:215], v[44:47], v[68:71], v[212:215]
    buffer_load_dwordx4 v9, s[40:43], s6 offen lds
    v_mfma_f32_16x16x32_bf16 v[216:219], v[44:47], v[72:75], v[216:219]
    s_add_u32 s6, s6, 147456
    v_mfma_f32_16x16x32_bf16 v[220:223], v[44:47], v[76:79], v[220:223]
    ds_read_b64_tr_b16 v[44:45], v3 offset:9344
    v_mfma_f32_16x16x32_bf16 v[224:227], v[48:51], v[64:67], v[224:227]
    ds_read_b64_tr_b16 v[46:47], v3 offset:11648
    v_mfma_f32_16x16x32_bf16 v[228:231], v[48:51], v[68:71], v[228:231]
    s_add_u32 m0, s8, 25664
    v_mfma_f32_16x16x32_bf16 v[232:235], v[48:51], v[72:75], v[232:235]
    buffer_load_dwordx4 v7, s[40:43], s6 offen lds
    v_mfma_f32_16x16x32_bf16 v[236:239], v[48:51], v[76:79], v[236:239]
    s_add_u32 m0, s8, 26688
    v_mfma_f32_16x16x32_bf16 v[240:243], v[52:55], v[64:67], v[240:243]
    buffer_load_dwordx4 v8, s[40:43], s6 offen lds
    v_mfma_f32_16x16x32_bf16 v[244:247], v[52:55], v[68:71], v[244:247]
    s_add_u32 m0, s8, 27712
    v_mfma_f32_16x16x32_bf16 v[248:251], v[52:55], v[72:75], v[248:251]
    buffer_load_dwordx4 v9, s[40:43], s6 offen lds
    v_mfma_f32_16x16x32_bf16 v[252:255], v[52:55], v[76:79], v[252:255]
    s_add_u32 s6, s6, 147456
    s_waitcnt vmcnt(6) lgkmcnt(0)
    s_barrier
    v_mfma_f32_16x16x32_bf16 v[96:99], v[16:19], v[80:83], v[96:99]
    v_subrev_u32 v4, 51328, v4
    v_mfma_f32_16x16x32_bf16 v[100:103], v[16:19], v[84:87], v[100:103]
    v_subrev_u32 v2, 51328, v2
    v_mfma_f32_16x16x32_bf16 v[104:107], v[16:19], v[88:91], v[104:107]
    v_subrev_u32 v3, 51328, v3
    v_mfma_f32_16x16x32_bf16 v[108:111], v[16:19], v[92:95], v[108:111]
    ds_read_b64_tr_b16 v[16:17], v2 offset:0
    ds_read_b64_tr_b16 v[18:19], v2 offset:2304
    v_mfma_f32_16x16x32_bf16 v[112:115], v[20:23], v[80:83], v[112:115]
    ds_read_b128 v[64:67], v4 offset:0
    v_mfma_f32_16x16x32_bf16 v[116:119], v[20:23], v[84:87], v[116:119]
    ds_read_b128 v[68:71], v4 offset:1024
    v_mfma_f32_16x16x32_bf16 v[120:123], v[20:23], v[88:91], v[120:123]
    ds_read_b128 v[72:75], v4 offset:2048
    v_mfma_f32_16x16x32_bf16 v[124:127], v[20:23], v[92:95], v[124:127]
    ds_read_b64_tr_b16 v[20:21], v2 offset:9248
    v_mfma_f32_16x16x32_bf16 v[128:131], v[24:27], v[80:83], v[128:131]
    ds_read_b64_tr_b16 v[22:23], v2 offset:11552
    v_mfma_f32_16x16x32_bf16 v[132:135], v[24:27], v[84:87], v[132:135]
    ds_read_b128 v[76:79], v4 offset:3072
    v_mfma_f32_16x16x32_bf16 v[136:139], v[24:27], v[88:91], v[136:139]
    ds_read_b64_tr_b16 v[48:49], v2 offset:128
    v_mfma_f32_16x16x32_bf16 v[140:143], v[24:27], v[92:95], v[140:143]
    ds_read_b64_tr_b16 v[24:25], v3 offset:32
    v_mfma_f32_16x16x32_bf16 v[144:147], v[28:31], v[80:83], v[144:147]
    ds_read_b64_tr_b16 v[26:27], v3 offset:2336
    v_mfma_f32_16x16x32_bf16 v[148:151], v[28:31], v[84:87], v[148:151]
    ds_read_b64_tr_b16 v[50:51], v2 offset:2432
    v_mfma_f32_16x16x32_bf16 v[152:155], v[28:31], v[88:91], v[152:155]
    ds_read_b64_tr_b16 v[52:53], v2 offset:9376
    v_mfma_f32_16x16x32_bf16 v[156:159], v[28:31], v[92:95], v[156:159]
    ds_read_b64_tr_b16 v[28:29], v3 offset:9280
    v_mfma_f32_16x16x32_bf16 v[160:163], v[32:35], v[80:83], v[160:163]
    ds_read_b64_tr_b16 v[30:31], v3 offset:11584
    v_mfma_f32_16x16x32_bf16 v[164:167], v[32:35], v[84:87], v[164:167]
    ds_read_b64_tr_b16 v[54:55], v2 offset:11680
    v_mfma_f32_16x16x32_bf16 v[168:171], v[32:35], v[88:91], v[168:171]
    s_add_u32 m0, s8, 102656
    v_mfma_f32_16x16x32_bf16 v[172:175], v[32:35], v[92:95], v[172:175]
    ds_read_b64_tr_b16 v[32:33], v2 offset:64
    v_mfma_f32_16x16x32_bf16 v[176:179], v[36:39], v[80:83], v[176:179]
    ds_read_b64_tr_b16 v[34:35], v2 offset:2368
    v_mfma_f32_16x16x32_bf16 v[180:183], v[36:39], v[84:87], v[180:183]
    buffer_load_dwordx4 v7, s[40:43], s6 offen lds
    v_mfma_f32_16x16x32_bf16 v[184:187], v[36:39], v[88:91], v[184:187]
    s_add_u32 m0, s8, 103680
    v_mfma_f32_16x16x32_bf16 v[188:191], v[36:39], v[92:95], v[188:191]
    ds_read_b64_tr_b16 v[36:37], v2 offset:9312
    v_mfma_f32_16x16x32_bf16 v[192:195], v[40:43], v[80:83], v[192:195]
    ds_read_b64_tr_b16 v[38:39], v2 offset:11616
    v_mfma_f32_16x16x32_bf16 v[196:199], v[40:43], v[84:87], v[196:199]
    buffer_load_dwordx4 v8, s[40:43], s6 offen lds
    v_mfma_f32_16x16x32_bf16 v[200:203], v[40:43], v[88:91], v[200:203]
    s_add_u32 m0, s8, 104704
    v_mfma_f32_16x16x32_bf16 v[204:207], v[40:43], v[92:95], v[204:207]
    ds_read_b64_tr_b16 v[40:41], v3 offset:96
    v_mfma_f32_16x16x32_bf16 v[208:211], v[44:47], v[80:83], v[208:211]
    ds_read_b64_tr_b16 v[42:43], v3 offset:2400
    v_mfma_f32_16x16x32_bf16 v[212:215], v[44:47], v[84:87], v[212:215]
    buffer_load_dwordx4 v9, s[40:43], s6 offen lds
    v_mfma_f32_16x16x32_bf16 v[216:219], v[44:47], v[88:91], v[216:219]
    s_add_u32 s6, s6, 147456
    v_mfma_f32_16x16x32_bf16 v[220:223], v[44:47], v[92:95], v[220:223]
    ds_read_b64_tr_b16 v[44:45], v3 offset:9344
    v_mfma_f32_16x16x32_bf16 v[224:227], v[56:59], v[80:83], v[224:227]
    ds_read_b64_tr_b16 v[46:47], v3 offset:11648
    v_mfma_f32_16x16x32_bf16 v[228:231], v[56:59], v[84:87], v[228:231]
    s_add_u32 m0, s8, 128320
    v_mfma_f32_16x16x32_bf16 v[232:235], v[56:59], v[88:91], v[232:235]
    buffer_load_dwordx4 v7, s[40:43], s6 offen lds
    v_mfma_f32_16x16x32_bf16 v[236:239], v[56:59], v[92:95], v[236:239]
    s_add_u32 m0, s8, 129344
    v_mfma_f32_16x16x32_bf16 v[240:243], v[60:63], v[80:83], v[240:243]
    buffer_load_dwordx4 v8, s[40:43], s6 offen lds
    v_mfma_f32_16x16x32_bf16 v[244:247], v[60:63], v[84:87], v[244:247]
    s_add_u32 m0, s8, 130368
    v_mfma_f32_16x16x32_bf16 v[248:251], v[60:63], v[88:91], v[248:251]
    buffer_load_dwordx4 v9, s[40:43], s6 offen lds
    v_mfma_f32_16x16x32_bf16 v[252:255], v[60:63], v[92:95], v[252:255]
    s_add_u32 s6, s6, 147456
    s_waitcnt vmcnt(6) lgkmcnt(0)
    s_barrier
    v_mfma_f32_16x16x32_bf16 v[96:99], v[16:19], v[64:67], v[96:99]
    v_subrev_u32 v4, 51328, v4
    v_mfma_f32_16x16x32_bf16 v[100:103], v[16:19], v[68:71], v[100:103]
    v_subrev_u32 v2, 51328, v2
    v_mfma_f32_16x16x32_bf16 v[104:107], v[16:19], v[72:75], v[104:107]
    v_subrev_u32 v3, 51328, v3
    v_mfma_f32_16x16x32_bf16 v[108:111], v[16:19], v[76:79], v[108:111]
    ds_read_b64_tr_b16 v[16:17], v2 offset:0
    ds_read_b64_tr_b16 v[18:19], v2 offset:2304
    v_mfma_f32_16x16x32_bf16 v[112:115], v[20:23], v[64:67], v[112:115]
    ds_read_b128 v[80:83], v4 offset:0
    v_mfma_f32_16x16x32_bf16 v[116:119], v[20:23], v[68:71], v[116:119]
    ds_read_b128 v[84:87], v4 offset:1024
    v_mfma_f32_16x16x32_bf16 v[120:123], v[20:23], v[72:75], v[120:123]
    ds_read_b128 v[88:91], v4 offset:2048
    v_mfma_f32_16x16x32_bf16 v[124:127], v[20:23], v[76:79], v[124:127]
    ds_read_b64_tr_b16 v[20:21], v2 offset:9248
    v_mfma_f32_16x16x32_bf16 v[128:131], v[24:27], v[64:67], v[128:131]
    ds_read_b64_tr_b16 v[22:23], v2 offset:11552
    v_mfma_f32_16x16x32_bf16 v[132:135], v[24:27], v[68:71], v[132:135]
    ds_read_b128 v[92:95], v4 offset:3072
    v_mfma_f32_16x16x32_bf16 v[136:139], v[24:27], v[72:75], v[136:139]
    ds_read_b64_tr_b16 v[56:57], v2 offset:128
    v_mfma_f32_16x16x32_bf16 v[140:143], v[24:27], v[76:79], v[140:143]
    ds_read_b64_tr_b16 v[24:25], v3 offset:32
    v_mfma_f32_16x16x32_bf16 v[144:147], v[28:31], v[64:67], v[144:147]
    ds_read_b64_tr_b16 v[26:27], v3 offset:2336
    v_mfma_f32_16x16x32_bf16 v[148:151], v[28:31], v[68:71], v[148:151]
    ds_read_b64_tr_b16 v[58:59], v2 offset:2432
    v_mfma_f32_16x16x32_bf16 v[152:155], v[28:31], v[72:75], v[152:155]
    ds_read_b64_tr_b16 v[60:61], v2 offset:9376
    v_mfma_f32_16x16x32_bf16 v[156:159], v[28:31], v[76:79], v[156:159]
    ds_read_b64_tr_b16 v[28:29], v3 offset:9280
    v_mfma_f32_16x16x32_bf16 v[160:163], v[32:35], v[64:67], v[160:163]
    ds_read_b64_tr_b16 v[30:31], v3 offset:11584
    v_mfma_f32_16x16x32_bf16 v[164:167], v[32:35], v[68:71], v[164:167]
    ds_read_b64_tr_b16 v[62:63], v2 offset:11680
    v_mfma_f32_16x16x32_bf16 v[168:171], v[32:35], v[72:75], v[168:171]
    s_add_u32 m0, s8, 51328
    v_mfma_f32_16x16x32_bf16 v[172:175], v[32:35], v[76:79], v[172:175]
    ds_read_b64_tr_b16 v[32:33], v2 offset:64
    v_mfma_f32_16x16x32_bf16 v[176:179], v[36:39], v[64:67], v[176:179]
    ds_read_b64_tr_b16 v[34:35], v2 offset:2368
    v_mfma_f32_16x16x32_bf16 v[180:183], v[36:39], v[68:71], v[180:183]
    buffer_load_dwordx4 v7, s[40:43], s6 offen lds
    v_mfma_f32_16x16x32_bf16 v[184:187], v[36:39], v[72:75], v[184:187]
    s_add_u32 m0, s8, 52352
    v_mfma_f32_16x16x32_bf16 v[188:191], v[36:39], v[76:79], v[188:191]
    ds_read_b64_tr_b16 v[36:37], v2 offset:9312
    v_mfma_f32_16x16x32_bf16 v[192:195], v[40:43], v[64:67], v[192:195]
    ds_read_b64_tr_b16 v[38:39], v2 offset:11616
    v_mfma_f32_16x16x32_bf16 v[196:199], v[40:43], v[68:71], v[196:199]
    buffer_load_dwordx4 v8, s[40:43], s6 offen lds
    v_mfma_f32_16x16x32_bf16 v[200:203], v[40:43], v[72:75], v[200:203]
    s_add_u32 m0, s8, 53376
    v_mfma_f32_16x16x32_bf16 v[204:207], v[40:43], v[76:79], v[204:207]
    ds_read_b64_tr_b16 v[40:41], v3 offset:96
    v_mfma_f32_16x16x32_bf16 v[208:211], v[44:47], v[64:67], v[208:211]
    ds_read_b64_tr_b16 v[42:43], v3 offset:2400
    v_mfma_f32_16x16x32_bf16 v[212:215], v[44:47], v[68:71], v[212:215]
    buffer_load_dwordx4 v9, s[40:43], s6 offen lds
    v_mfma_f32_16x16x32_bf16 v[216:219], v[44:47], v[72:75], v[216:219]
    s_add_u32 s6, s6, 147456
    v_mfma_f32_16x16x32_bf16 v[220:223], v[44:47], v[76:79], v[220:223]
    ds_read_b64_tr_b16 v[44:45], v3 offset:9344
    v_mfma_f32_16x16x32_bf16 v[224:227], v[48:51], v[64:67], v[224:227]
    ds_read_b64_tr_b16 v[46:47], v3 offset:11648
    v_mfma_f32_16x16x32_bf16 v[228:231], v[48:51], v[68:71], v[228:231]
    s_add_u32 m0, s8, 76992
    v_mfma_f32_16x16x32_bf16 v[232:235], v[48:51], v[72:75], v[232:235]
    buffer_load_dwordx4 v7, s[40:43], s6 offen lds
    v_mfma_f32_16x16x32_bf16 v[236:239], v[48:51], v[76:79], v[236:239]
    s_add_u32 m0, s8, 78016
    v_mfma_f32_16x16x32_bf16 v[240:243], v[52:55], v[64:67], v[240:243]
    buffer_load_dwordx4 v8, s[40:43], s6 offen lds
    v_mfma_f32_16x16x32_bf16 v[244:247], v[52:55], v[68:71], v[244:247]
    s_add_u32 m0, s8, 79040
    v_mfma_f32_16x16x32_bf16 v[248:251], v[52:55], v[72:75], v[248:251]
    buffer_load_dwordx4 v9, s[40:43], s6 offen lds
    v_mfma_f32_16x16x32_bf16 v[252:255], v[52:55], v[76:79], v[252:255]
    s_add_u32 s6, s6, 147456
    s_waitcnt vmcnt(6) lgkmcnt(0)
    s_barrier
    v_mfma_f32_16x16x32_bf16 v[96:99], v[16:19], v[80:83], v[96:99]
    v_add_u32 v4, 102656, v4
    v_mfma_f32_16x16x32_bf16 v[100:103], v[16:19], v[84:87], v[100:103]
    v_add_u32 v2, 102656, v2
    v_mfma_f32_16x16x32_bf16 v[104:107], v[16:19], v[88:91], v[104:107]
    v_add_u32 v3, 102656, v3
    v_mfma_f32_16x16x32_bf16 v[108:111], v[16:19], v[92:95], v[108:111]
    ds_read_b64_tr_b16 v[16:17], v2 offset:0
    ds_read_b64_tr_b16 v[18:19], v2 offset:2304
    v_mfma_f32_16x16x32_bf16 v[112:115], v[20:23], v[80:83], v[112:115]
    ds_read_b128 v[64:67], v4 offset:0
    v_mfma_f32_16x16x32_bf16 v[116:119], v[20:23], v[84:87], v[116:119]
    ds_read_b128 v[68:71], v4 offset:1024
    v_mfma_f32_16x16x32_bf16 v[120:123], v[20:23], v[88:91], v[120:123]
    ds_read_b128 v[72:75], v4 offset:2048
    v_mfma_f32_16x16x32_bf16 v[124:127], v[20:23], v[92:95], v[124:127]
    ds_read_b64_tr_b16 v[20:21], v2 offset:9248
    v_mfma_f32_16x16x32_bf16 v[128:131], v[24:27], v[80:83], v[128:131]
    ds_read_b64_tr_b16 v[22:23], v2 offset:11552
    v_mfma_f32_16x16x32_bf16 v[132:135], v[24:27], v[84:87], v[132:135]
    ds_read_b128 v[76:79], v4 offset:3072
    v_mfma_f32_16x16x32_bf16 v[136:139], v[24:27], v[88:91], v[136:139]
    ds_read_b64_tr_b16 v[48:49], v2 offset:128
    v_mfma_f32_16x16x32_bf16 v[140:143], v[24:27], v[92:95], v[140:143]
    ds_read_b64_tr_b16 v[24:25], v3 offset:32
    v_mfma_f32_16x16x32_bf16 v[144:147], v[28:31], v[80:83], v[144:147]
    ds_read_b64_tr_b16 v[26:27], v3 offset:2336
    v_mfma_f32_16x16x32_bf16 v[148:151], v[28:31], v[84:87], v[148:151]
    ds_read_b64_tr_b16 v[50:51], v2 offset:2432
    v_mfma_f32_16x16x32_bf16 v[152:155], v[28:31], v[88:91], v[152:155]
    ds_read_b64_tr_b16 v[52:53], v2 offset:9376
    v_mfma_f32_16x16x32_bf16 v[156:159], v[28:31], v[92:95], v[156:159]
    ds_read_b64_tr_b16 v[28:29], v3 offset:9280
    v_mfma_f32_16x16x32_bf16 v[160:163], v[32:35], v[80:83], v[160:163]
    ds_read_b64_tr_b16 v[30:31], v3 offset:11584
    v_mfma_f32_16x16x32_bf16 v[164:167], v[32:35], v[84:87], v[164:167]
    ds_read_b64_tr_b16 v[54:55], v2 offset:11680
    v_mfma_f32_16x16x32_bf16 v[168:171], v[32:35], v[88:91], v[168:171]
    s_add_u32 m0, s8, 0
    v_mfma_f32_16x16x32_bf16 v[172:175], v[32:35], v[92:95], v[172:175]
    ds_read_b64_tr_b16 v[32:33], v2 offset:64
    v_mfma_f32_16x16x32_bf16 v[176:179], v[36:39], v[80:83], v[176:179]
    ds_read_b64_tr_b16 v[34:35], v2 offset:2368
    v_mfma_f32_16x16x32_bf16 v[180:183], v[36:39], v[84:87], v[180:183]
    buffer_load_dwordx4 v7, s[40:43], s6 offen lds
    v_mfma_f32_16x16x32_bf16 v[184:187], v[36:39], v[88:91], v[184:187]
    s_add_u32 m0, s8, 1024
    v_mfma_f32_16x16x32_bf16 v[188:191], v[36:39], v[92:95], v[188:191]
    ds_read_b64_tr_b16 v[36:37], v2 offset:9312
    v_mfma_f32_16x16x32_bf16 v[192:195], v[40:43], v[80:83], v[192:195]
    ds_read_b64_tr_b16 v[38:39], v2 offset:11616
    v_mfma_f32_16x16x32_bf16 v[196:199], v[40:43], v[84:87], v[196:199]
    buffer_load_dwordx4 v8, s[40:43], s6 offen lds
    v_mfma_f32_16x16x32_bf16 v[200:203], v[40:43], v[88:91], v[200:203]
    s_add_u32 m0, s8, 2048
    v_mfma_f32_16x16x32_bf16 v[204:207], v[40:43], v[92:95], v[204:207]
    ds_read_b64_tr_b16 v[40:41], v3 offset:96
    v_mfma_f32_16x16x32_bf16 v[208:211], v[44:47], v[80:83], v[208:211]
    ds_read_b64_tr_b16 v[42:43], v3 offset:2400
    v_mfma_f32_16x16x32_bf16 v[212:215], v[44:47], v[84:87], v[212:215]
    buffer_load_dwordx4 v9, s[40:43], s6 offen lds
    v_mfma_f32_16x16x32_bf16 v[216:219], v[44:47], v[88:91], v[216:219]
    s_add_u32 s6, s6, 147456
    v_mfma_f32_16x16x32_bf16 v[220:223], v[44:47], v[92:95], v[220:223]
    ds_read_b64_tr_b16 v[44:45], v3 offset:9344
    v_mfma_f32_16x16x32_bf16 v[224:227], v[56:59], v[80:83], v[224:227]
    ds_read_b64_tr_b16 v[46:47], v3 offset:11648
    v_mfma_f32_16x16x32_bf16 v[228:231], v[56:59], v[84:87], v[228:231]
    s_add_u32 m0, s8, 25664
    v_mfma_f32_16x16x32_bf16 v[232:235], v[56:59], v[88:91], v[232:235]
    buffer_load_dwordx4 v7, s[40:43], s6 offen lds
    v_mfma_f32_16x16x32_bf16 v[236:239], v[56:59], v[92:95], v[236:239]
    s_add_u32 m0, s8, 26688
    v_mfma_f32_16x16x32_bf16 v[240:243], v[60:63], v[80:83], v[240:243]
    buffer_load_dwordx4 v8, s[40:43], s6 offen lds
    v_mfma_f32_16x16x32_bf16 v[244:247], v[60:63], v[84:87], v[244:247]
    s_add_u32 m0, s8, 27712
    v_mfma_f32_16x16x32_bf16 v[248:251], v[60:63], v[88:91], v[248:251]
    buffer_load_dwordx4 v9, s[40:43], s6 offen lds
    v_mfma_f32_16x16x32_bf16 v[252:255], v[60:63], v[92:95], v[252:255]
    s_add_u32 s6, s6, 147456
    s_waitcnt vmcnt(6) lgkmcnt(0)
    s_barrier
    v_mfma_f32_16x16x32_bf16 v[96:99], v[16:19], v[64:67], v[96:99]
    v_subrev_u32 v4, 51328, v4
    v_mfma_f32_16x16x32_bf16 v[100:103], v[16:19], v[68:71], v[100:103]
    v_subrev_u32 v2, 51328, v2
    v_mfma_f32_16x16x32_bf16 v[104:107], v[16:19], v[72:75], v[104:107]
    v_subrev_u32 v3, 51328, v3
    v_mfma_f32_16x16x32_bf16 v[108:111], v[16:19], v[76:79], v[108:111]
    ds_read_b64_tr_b16 v[16:17], v2 offset:0
    ds_read_b64_tr_b16 v[18:19], v2 offset:2304
    v_mfma_f32_16x16x32_bf16 v[112:115], v[20:23], v[64:67], v[112:115]
    ds_read_b128 v[80:83], v4 offset:0
    v_mfma_f32_16x16x32_bf16 v[116:119], v[20:23], v[68:71], v[116:119]
    ds_read_b128 v[84:87], v4 offset:1024
    v_mfma_f32_16x16x32_bf16 v[120:123], v[20:23], v[72:75], v[120:123]
    ds_read_b128 v[88:91], v4 offset:2048
    v_mfma_f32_16x16x32_bf16 v[124:127], v[20:23], v[76:79], v[124:127]
    ds_read_b64_tr_b16 v[20:21], v2 offset:9248
    v_mfma_f32_16x16x32_bf16 v[128:131], v[24:27], v[64:67], v[128:131]
    ds_read_b64_tr_b16 v[22:23], v2 offset:11552
    v_mfma_f32_16x16x32_bf16 v[132:135], v[24:27], v[68:71], v[132:135]
    ds_read_b128 v[92:95], v4 offset:3072
    v_mfma_f32_16x16x32_bf16 v[136:139], v[24:27], v[72:75], v[136:139]
    ds_read_b64_tr_b16 v[56:57], v2 offset:128
    v_mfma_f32_16x16x32_bf16 v[140:143], v[24:27], v[76:79], v[140:143]
    ds_read_b64_tr_b16 v[24:25], v3 offset:32
    v_mfma_f32_16x16x32_bf16 v[144:147], v[28:31], v[64:67], v[144:147]
    ds_read_b64_tr_b16 v[26:27], v3 offset:2336
    v_mfma_f32_16x16x32_bf16 v[148:151], v[28:31], v[68:71], v[148:151]
    ds_read_b64_tr_b16 v[58:59], v2 offset:2432
    v_mfma_f32_16x16x32_bf16 v[152:155], v[28:31], v[72:75], v[152:155]
    ds_read_b64_tr_b16 v[60:61], v2 offset:9376
    v_mfma_f32_16x16x32_bf16 v[156:159], v[28:31], v[76:79], v[156:159]
    ds_read_b64_tr_b16 v[28:29], v3 offset:9280
    v_mfma_f32_16x16x32_bf16 v[160:163], v[32:35], v[64:67], v[160:163]
    ds_read_b64_tr_b16 v[30:31], v3 offset:11584
    v_mfma_f32_16x16x32_bf16 v[164:167], v[32:35], v[68:71], v[164:167]
    ds_read_b64_tr_b16 v[62:63], v2 offset:11680
    v_mfma_f32_16x16x32_bf16 v[168:171], v[32:35], v[72:75], v[168:171]
    s_add_u32 m0, s8, 102656
    v_mfma_f32_16x16x32_bf16 v[172:175], v[32:35], v[76:79], v[172:175]
    ds_read_b64_tr_b16 v[32:33], v2 offset:64
    v_mfma_f32_16x16x32_bf16 v[176:179], v[36:39], v[64:67], v[176:179]
    ds_read_b64_tr_b16 v[34:35], v2 offset:2368
    v_mfma_f32_16x16x32_bf16 v[180:183], v[36:39], v[68:71], v[180:183]
    buffer_load_dwordx4 v7, s[40:43], s6 offen lds
    v_mfma_f32_16x16x32_bf16 v[184:187], v[36:39], v[72:75], v[184:187]
    s_add_u32 m0, s8, 103680
    v_mfma_f32_16x16x32_bf16 v[188:191], v[36:39], v[76:79], v[188:191]
    ds_read_b64_tr_b16 v[36:37], v2 offset:9312
    v_mfma_f32_16x16x32_bf16 v[192:195], v[40:43], v[64:67], v[192:195]
    ds_read_b64_tr_b16 v[38:39], v2 offset:11616
    v_mfma_f32_16x16x32_bf16 v[196:199], v[40:43], v[68:71], v[196:199]
    buffer_load_dwordx4 v8, s[40:43], s6 offen lds
    v_mfma_f32_16x16x32_bf16 v[200:203], v[40:43], v[72:75], v[200:203]
    s_add_u32 m0, s8, 104704
    v_mfma_f32_16x16x32_bf16 v[204:207], v[40:43], v[76:79], v[204:207]
    ds_read_b64_tr_b16 v[40:41], v3 offset:96
    v_mfma_f32_16x16x32_bf16 v[208:211], v[44:47], v[64:67], v[208:211]
    ds_read_b64_tr_b16 v[42:43], v3 offset:2400
    v_mfma_f32_16x16x32_bf16 v[212:215], v[44:47], v[68:71], v[212:215]
    buffer_load_dwordx4 v9, s[40:43], s6 offen lds
    v_mfma_f32_16x16x32_bf16 v[216:219], v[44:47], v[72:75], v[216:219]
    s_add_u32 s6, s6, 147456
    v_mfma_f32_16x16x32_bf16 v[220:223], v[44:47], v[76:79], v[220:223]
    ds_read_b64_tr_b16 v[44:45], v3 offset:9344
    v_mfma_f32_16x16x32_bf16 v[224:227], v[48:51], v[64:67], v[224:227]
    ds_read_b64_tr_b16 v[46:47], v3 offset:11648
    v_mfma_f32_16x16x32_bf16 v[228:231], v[48:51], v[68:71], v[228:231]
    s_add_u32 m0, s8, 128320
    v_mfma_f32_16x16x32_bf16 v[232:235], v[48:51], v[72:75], v[232:235]
    buffer_load_dwordx4 v7, s[40:43], s6 offen lds
    v_mfma_f32_16x16x32_bf16 v[236:239], v[48:51], v[76:79], v[236:239]
    s_add_u32 m0, s8, 129344
    v_mfma_f32_16x16x32_bf16 v[240:243], v[52:55], v[64:67], v[240:243]
    buffer_load_dwordx4 v8, s[40:43], s6 offen lds
    v_mfma_f32_16x16x32_bf16 v[244:247], v[52:55], v[68:71], v[244:247]
    s_add_u32 m0, s8, 130368
    v_mfma_f32_16x16x32_bf16 v[248:251], v[52:55], v[72:75], v[248:251]
    buffer_load_dwordx4 v9, s[40:43], s6 offen lds
    v_mfma_f32_16x16x32_bf16 v[252:255], v[52:55], v[76:79], v[252:255]
    s_add_u32 s6, s6, 147456
    s_sub_u32 s12, s12, 1
    s_cmp_lg_u32 s12, 0
    s_cbranch_scc1 G1A
    s_waitcnt vmcnt(6) lgkmcnt(0)
    s_barrier
    v_mfma_f32_16x16x32_bf16 v[96:99], v[16:19], v[80:83], v[96:99]
    v_subrev_u32 v4, 51328, v4
    v_mfma_f32_16x16x32_bf16 v[100:103], v[16:19], v[84:87], v[100:103]
    v_subrev_u32 v2, 51328, v2
    v_mfma_f32_16x16x32_bf16 v[104:107], v[16:19], v[88:91], v[104:107]
    v_subrev_u32 v3, 51328, v3
    v_mfma_f32_16x16x32_bf16 v[108:111], v[16:19], v[92:95], v[108:111]
    ds_read_b64_tr_b16 v[16:17], v2 offset:0
    ds_read_b64_tr_b16 v[18:19], v2 offset:2304
    v_mfma_f32_16x16x32_bf16 v[112:115], v[20:23], v[80:83], v[112:115]
    ds_read_b128 v[64:67], v4 offset:0
    v_mfma_f32_16x16x32_bf16 v[116:119], v[20:23], v[84:87], v[116:119]
    ds_read_b128 v[68:71], v4 offset:1024
    v_mfma_f32_16x16x32_bf16 v[120:123], v[20:23], v[88:91], v[120:123]
    ds_read_b128 v[72:75], v4 offset:2048
    v_mfma_f32_16x16x32_bf16 v[124:127], v[20:23], v[92:95], v[124:127]
    ds_read_b64_tr_b16 v[20:21], v2 offset:9248
    v_mfma_f32_16x16x32_bf16 v[128:131], v[24:27], v[80:83], v[128:131]
    ds_read_b64_tr_b16 v[22:23], v2 offset:11552
    v_mfma_f32_16x16x32_bf16 v[132:135], v[24:27], v[84:87], v[132:135]
    ds_read_b128 v[76:79], v4 offset:3072
    v_mfma_f32_16x16x32_bf16 v[136:139], v[24:27], v[88:91], v[136:139]
    ds_read_b64_tr_b16 v[48:49], v2 offset:128
    v_mfma_f32_16x16x32_bf16 v[140:143], v[24:27], v[92:95], v[140:143]
    ds_read_b64_tr_b16 v[24:25], v3 offset:32
    v_mfma_f32_16x16x32_bf16 v[144:147], v[28:31], v[80:83], v[144:147]
    ds_read_b64_tr_b16 v[26:27], v3 offset:2336
    v_mfma_f32_16x16x32_bf16 v[148:151], v[28:31], v[84:87], v[148:151]
    ds_read_b64_tr_b16 v[50:51], v2 offset:2432
    v_mfma_f32_16x16x32_bf16 v[152:155], v[28:31], v[88:91], v[152:155]
    ds_read_b64_tr_b16 v[52:53], v2 offset:9376
    v_mfma_f32_16x16x32_bf16 v[156:159], v[28:31], v[92:95], v[156:159]
    ds_read_b64_tr_b16 v[28:29], v3 offset:9280
    v_mfma_f32_16x16x32_bf16 v[160:163], v[32:35], v[80:83], v[160:163]
    ds_read_b64_tr_b16 v[30:31], v3 offset:11584
    v_mfma_f32_16x16x32_bf16 v[164:167], v[32:35], v[84:87], v[164:167]
    ds_read_b64_tr_b16 v[54:55], v2 offset:11680
    v_mfma_f32_16x16x32_bf16 v[168:171], v[32:35], v[88:91], v[168:171]
    s_add_u32 m0, s8, 51328
    v_mfma_f32_16x16x32_bf16 v[172:175], v[32:35], v[92:95], v[172:175]
    ds_read_b64_tr_b16 v[32:33], v2 offset:64
    v_mfma_f32_16x16x32_bf16 v[176:179], v[36:39], v[80:83], v[176:179]
    ds_read_b64_tr_b16 v[34:35], v2 offset:2368
    v_mfma_f32_16x16x32_bf16 v[180:183], v[36:39], v[84:87], v[180:183]
    buffer_load_dwordx4 v7, s[40:43], s6 offen lds
    v_mfma_f32_16x16x32_bf16 v[184:187], v[36:39], v[88:91], v[184:187]
    s_add_u32 m0, s8, 52352
    v_mfma_f32_16x16x32_bf16 v[188:191], v[36:39], v[92:95], v[188:191]
    ds_read_b64_tr_b16 v[36:37], v2 offset:9312
    v_mfma_f32_16x16x32_bf16 v[192:195], v[40:43], v[80:83], v[192:195]
    ds_read_b64_tr_b16 v[38:39], v2 offset:11616
    v_mfma_f32_16x16x32_bf16 v[196:199], v[40:43], v[84:87], v[196:199]
    buffer_load_dwordx4 v8, s[40:43], s6 offen lds
    v_mfma_f32_16x16x32_bf16 v[200:203], v[40:43], v[88:91], v[200:203]
    s_add_u32 m0, s8, 53376
    v_mfma_f32_16x16x32_bf16 v[204:207], v[40:43], v[92:95], v[204:207]
    ds_read_b64_tr_b16 v[40:41], v3 offset:96
    v_mfma_f32_16x16x32_bf16 v[208:211], v[44:47], v[80:83], v[208:211]
    ds_read_b64_tr_b16 v[42:43], v3 offset:2400
    v_mfma_f32_16x16x32_bf16 v[212:215], v[44:47], v[84:87], v[212:215]
    buffer_load_dwordx4 v9, s[40:43], s6 offen lds
    v_mfma_f32_16x16x32_bf16 v[216:219], v[44:47], v[88:91], v[216:219]
    s_add_u32 s6, s6, 147456
    v_mfma_f32_16x16x32_bf16 v[220:223], v[44:47], v[92:95], v[220:223]
    ds_read_b64_tr_b16 v[44:45], v3 offset:9344
    v_mfma_f32_16x16x32_bf16 v[224:227], v[56:59], v[80:83], v[224:227]
    ds_read_b64_tr_b16 v[46:47], v3 offset:11648
    v_mfma_f32_16x16x32_bf16 v[228:231], v[56:59], v[84:87], v[228:231]
    s_add_u32 m0, s8, 76992
    v_mfma_f32_16x16x32_bf16 v[232:235], v[56:59], v[88:91], v[232:235]
    buffer_load_dwordx4 v7, s[40:43], s6 offen lds
    v_mfma_f32_16x16x32_bf16 v[236:239], v[56:59], v[92:95], v[236:239]
    s_add_u32 m0, s8, 78016
    v_mfma_f32_16x16x32_bf16 v[240:243], v[60:63], v[80:83], v[240:243]
    buffer_load_dwordx4 v8, s[40:43], s6 offen lds
    v_mfma_f32_16x16x32_bf16 v[244:247], v[60:63], v[84:87], v[244:247]
    s_add_u32 m0, s8, 79040
    v_mfma_f32_16x16x32_bf16 v[248:251], v[60:63], v[88:91], v[248:251]
    buffer_load_dwordx4 v9, s[40:43], s6 offen lds
    v_mfma_f32_16x16x32_bf16 v[252:255], v[60:63], v[92:95], v[252:255]
    s_add_u32 s6, s6, 147456
    s_waitcnt vmcnt(6) lgkmcnt(0)
    s_barrier
    v_mfma_f32_16x16x32_bf16 v[96:99], v[16:19], v[64:67], v[96:99]
    v_add_u32 v4, 102656, v4
    v_mfma_f32_16x16x32_bf16 v[100:103], v[16:19], v[68:71], v[100:103]
    v_add_u32 v2, 102656, v2
    v_mfma_f32_16x16x32_bf16 v[104:107], v[16:19], v[72:75], v[104:107]
    v_add_u32 v3, 102656, v3
    v_mfma_f32_16x16x32_bf16 v[108:111], v[16:19], v[76:79], v[108:111]
    ds_read_b64_tr_b16 v[16:17], v2 offset:0
    ds_read_b64_tr_b16 v[18:19], v2 offset:2304
    v_mfma_f32_16x16x32_bf16 v[112:115], v[20:23], v[64:67], v[112:115]
    ds_read_b128 v[80:83], v4 offset:0
    v_mfma_f32_16x16x32_bf16 v[116:119], v[20:23], v[68:71], v[116:119]
    ds_read_b128 v[84:87], v4 offset:1024
    v_mfma_f32_16x16x32_bf16 v[120:123], v[20:23], v[72:75], v[120:123]
    ds_read_b128 v[88:91], v4 offset:2048
    v_mfma_f32_16x16x32_bf16 v[124:127], v[20:23], v[76:79], v[124:127]
    ds_read_b64_tr_b16 v[20:21], v2 offset:9248
    v_mfma_f32_16x16x32_bf16 v[128:131], v[24:27], v[64:67], v[128:131]
    ds_read_b64_tr_b16 v[22:23], v2 offset:11552
    v_mfma_f32_16x16x32_bf16 v[132:135], v[24:27], v[68:71], v[132:135]
    ds_read_b128 v[92:95], v4 offset:3072
    v_mfma_f32_16x16x32_bf16 v[136:139], v[24:27], v[72:75], v[136:139]
    ds_read_b64_tr_b16 v[56:57], v2 offset:128
    v_mfma_f32_16x16x32_bf16 v[140:143], v[24:27], v[76:79], v[140:143]
    ds_read_b64_tr_b16 v[24:25], v3 offset:32
    v_mfma_f32_16x16x32_bf16 v[144:147], v[28:31], v[64:67], v[144:147]
    ds_read_b64_tr_b16 v[26:27], v3 offset:2336
    v_mfma_f32_16x16x32_bf16 v[148:151], v[28:31], v[68:71], v[148:151]
    ds_read_b64_tr_b16 v[58:59], v2 offset:2432
    v_mfma_f32_16x16x32_bf16 v[152:155], v[28:31], v[72:75], v[152:155]
    ds_read_b64_tr_b16 v[60:61], v2 offset:9376
    v_mfma_f32_16x16x32_bf16 v[156:159], v[28:31], v[76:79], v[156:159]
    ds_read_b64_tr_b16 v[28:29], v3 offset:9280
    v_mfma_f32_16x16x32_bf16 v[160:163], v[32:35], v[64:67], v[160:163]
    ds_read_b64_tr_b16 v[30:31], v3 offset:11584
    v_mfma_f32_16x16x32_bf16 v[164:167], v[32:35], v[68:71], v[164:167]
    ds_read_b64_tr_b16 v[62:63], v2 offset:11680
    v_mfma_f32_16x16x32_bf16 v[168:171], v[32:35], v[72:75], v[168:171]
    s_add_u32 m0, s8, 0
    v_mfma_f32_16x16x32_bf16 v[172:175], v[32:35], v[76:79], v[172:175]
    ds_read_b64_tr_b16 v[32:33], v2 offset:64
    v_mfma_f32_16x16x32_bf16 v[176:179], v[36:39], v[64:67], v[176:179]
    ds_read_b64_tr_b16 v[34:35], v2 offset:2368
    v_mfma_f32_16x16x32_bf16 v[180:183], v[36:39], v[68:71], v[180:183]
    buffer_load_dwordx4 v7, s[40:43], s6 offen lds
    v_mfma_f32_16x16x32_bf16 v[184:187], v[36:39], v[72:75], v[184:187]
    s_add_u32 m0, s8, 1024
    v_mfma_f32_16x16x32_bf16 v[188:191], v[36:39], v[76:79], v[188:191]
    ds_read_b64_tr_b16 v[36:37], v2 offset:9312
    v_mfma_f32_16x16x32_bf16 v[192:195], v[40:43], v[64:67], v[192:195]
    ds_read_b64_tr_b16 v[38:39], v2 offset:11616
    v_mfma_f32_16x16x32_bf16 v[196:199], v[40:43], v[68:71], v[196:199]
    buffer_load_dwordx4 v8, s[40:43], s6 offen lds
    v_mfma_f32_16x16x32_bf16 v[200:203], v[40:43], v[72:75], v[200:203]
    s_add_u32 m0, s8, 2048
    v_mfma_f32_16x16x32_bf16 v[204:207], v[40:43], v[76:79], v[204:207]
    ds_read_b64_tr_b16 v[40:41], v3 offset:96
    v_mfma_f32_16x16x32_bf16 v[208:211], v[44:47], v[64:67], v[208:211]
    ds_read_b64_tr_b16 v[42:43], v3 offset:2400
    v_mfma_f32_16x16x32_bf16 v[212:215], v[44:47], v[68:71], v[212:215]
    buffer_load_dwordx4 v9, s[40:43], s6 offen lds
    v_mfma_f32_16x16x32_bf16 v[216:219], v[44:47], v[72:75], v[216:219]
    s_add_u32 s6, s6, 147456
    v_mfma_f32_16x16x32_bf16 v[220:223], v[44:47], v[76:79], v[220:223]
    ds_read_b64_tr_b16 v[44:45], v3 offset:9344
    v_mfma_f32_16x16x32_bf16 v[224:227], v[48:51], v[64:67], v[224:227]
    ds_read_b64_tr_b16 v[46:47], v3 offset:11648
    v_mfma_f32_16x16x32_bf16 v[228:231], v[48:51], v[68:71], v[228:231]
    s_add_u32 m0, s8, 25664
    v_mfma_f32_16x16x32_bf16 v[232:235], v[48:51], v[72:75], v[232:235]
    buffer_load_dwordx4 v7, s[40:43], s6 offen lds
    v_mfma_f32_16x16x32_bf16 v[236:239], v[48:51], v[76:79], v[236:239]
    s_add_u32 m0, s8, 26688
    v_mfma_f32_16x16x32_bf16 v[240:243], v[52:55], v[64:67], v[240:243]
    buffer_load_dwordx4 v8, s[40:43], s6 offen lds
    v_mfma_f32_16x16x32_bf16 v[244:247], v[52:55], v[68:71], v[244:247]
    s_add_u32 m0, s8, 27712
    v_mfma_f32_16x16x32_bf16 v[248:251], v[52:55], v[72:75], v[248:251]
    buffer_load_dwordx4 v9, s[40:43], s6 offen lds
    v_mfma_f32_16x16x32_bf16 v[252:255], v[52:55], v[76:79], v[252:255]
    s_add_u32 s6, s6, 147456
    s_waitcnt vmcnt(6) lgkmcnt(0)
    s_barrier
    v_mfma_f32_16x16x32_bf16 v[96:99], v[16:19], v[80:83], v[96:99]
    v_subrev_u32 v4, 51328, v4
    v_mfma_f32_16x16x32_bf16 v[100:103], v[16:19], v[84:87], v[100:103]
    v_subrev_u32 v2, 51328, v2
    v_mfma_f32_16x16x32_bf16 v[104:107], v[16:19], v[88:91], v[104:107]
    v_subrev_u32 v3, 51328, v3
    v_mfma_f32_16x16x32_bf16 v[108:111], v[16:19], v[92:95], v[108:111]
    ds_read_b64_tr_b16 v[16:17], v2 offset:0
    ds_read_b64_tr_b16 v[18:19], v2 offset:2304
    v_mfma_f32_16x16x32_bf16 v[112:115], v[20:23], v[80:83], v[112:115]
    ds_read_b128 v[64:67], v4 offset:0
    v_mfma_f32_16x16x32_bf16 v[116:119], v[20:23], v[84:87], v[116:119]
    ds_read_b128 v[68:71], v4 offset:1024
    v_mfma_f32_16x16x32_bf16 v[120:123], v[20:23], v[88:91], v[120:123]
    ds_read_b128 v[72:75], v4 offset:2048
    v_mfma_f32_16x16x32_bf16 v[124:127], v[20:23], v[92:95], v[124:127]
    ds_read_b64_tr_b16 v[20:21], v2 offset:9248
    v_mfma_f32_16x16x32_bf16 v[128:131], v[24:27], v[80:83], v[128:131]
    ds_read_b64_tr_b16 v[22:23], v2 offset:11552
    v_mfma_f32_16x16x32_bf16 v[132:135], v[24:27], v[84:87], v[132:135]
    ds_read_b128 v[76:79], v4 offset:3072
    v_mfma_f32_16x16x32_bf16 v[136:139], v[24:27], v[88:91], v[136:139]
    ds_read_b64_tr_b16 v[48:49], v2 offset:128
    v_mfma_f32_16x16x32_bf16 v[140:143], v[24:27], v[92:95], v[140:143]
    ds_read_b64_tr_b16 v[24:25], v3 offset:32
    v_mfma_f32_16x16x32_bf16 v[144:147], v[28:31], v[80:83], v[144:147]
    ds_read_b64_tr_b16 v[26:27], v3 offset:2336
    v_mfma_f32_16x16x32_bf16 v[148:151], v[28:31], v[84:87], v[148:151]
    ds_read_b64_tr_b16 v[50:51], v2 offset:2432
    v_mfma_f32_16x16x32_bf16 v[152:155], v[28:31], v[88:91], v[152:155]
    ds_read_b64_tr_b16 v[52:53], v2 offset:9376
    v_mfma_f32_16x16x32_bf16 v[156:159], v[28:31], v[92:95], v[156:159]
    ds_read_b64_tr_b16 v[28:29], v3 offset:9280
    v_mfma_f32_16x16x32_bf16 v[160:163], v[32:35], v[80:83], v[160:163]
    ds_read_b64_tr_b16 v[30:31], v3 offset:11584
    v_mfma_f32_16x16x32_bf16 v[164:167], v[32:35], v[84:87], v[164:167]
    ds_read_b64_tr_b16 v[54:55], v2 offset:11680
    v_mfma_f32_16x16x32_bf16 v[168:171], v[32:35], v[88:91], v[168:171]
    s_add_u32 m0, s11, 113856
    v_mfma_f32_16x16x32_bf16 v[172:175], v[32:35], v[92:95], v[172:175]
    ds_read_b64_tr_b16 v[32:33], v2 offset:64
    v_mfma_f32_16x16x32_bf16 v[176:179], v[36:39], v[80:83], v[176:179]
    ds_read_b64_tr_b16 v[34:35], v2 offset:2368
    v_mfma_f32_16x16x32_bf16 v[180:183], v[36:39], v[84:87], v[180:183]
    buffer_load_dwordx4 v11, s[48:51], s10 offen lds
    v_mfma_f32_16x16x32_bf16 v[184:187], v[36:39], v[88:91], v[184:187]
    s_add_u32 m0, s11, 114880
    v_mfma_f32_16x16x32_bf16 v[188:191], v[36:39], v[92:95], v[188:191]
    ds_read_b64_tr_b16 v[36:37], v2 offset:9312
    v_mfma_f32_16x16x32_bf16 v[192:195], v[40:43], v[80:83], v[192:195]
    ds_read_b64_tr_b16 v[38:39], v2 offset:11616
    v_mfma_f32_16x16x32_bf16 v[196:199], v[40:43], v[84:87], v[196:199]
    buffer_load_dwordx4 v12, s[48:51], s10 offen lds
    v_mfma_f32_16x16x32_bf16 v[200:203], v[40:43], v[88:91], v[200:203]
    s_add_u32 m0, s11, 115904
    v_mfma_f32_16x16x32_bf16 v[204:207], v[40:43], v[92:95], v[204:207]
    ds_read_b64_tr_b16 v[40:41], v3 offset:96
    v_mfma_f32_16x16x32_bf16 v[208:211], v[44:47], v[80:83], v[208:211]
    ds_read_b64_tr_b16 v[42:43], v3 offset:2400
    v_mfma_f32_16x16x32_bf16 v[212:215], v[44:47], v[84:87], v[212:215]
    buffer_load_dwordx4 v13, s[48:51], s10 offen lds
    v_mfma_f32_16x16x32_bf16 v[216:219], v[44:47], v[88:91], v[216:219]
    s_add_u32 s10, s10, 18432
    v_mfma_f32_16x16x32_bf16 v[220:223], v[44:47], v[92:95], v[220:223]
    ds_read_b64_tr_b16 v[44:45], v3 offset:9344
    v_mfma_f32_16x16x32_bf16 v[224:227], v[56:59], v[80:83], v[224:227]
    ds_read_b64_tr_b16 v[46:47], v3 offset:11648
    v_mfma_f32_16x16x32_bf16 v[228:231], v[56:59], v[84:87], v[228:231]
    s_add_u32 m0, s11, 132288
    v_mfma_f32_16x16x32_bf16 v[232:235], v[56:59], v[88:91], v[232:235]
    buffer_load_dwordx4 v11, s[48:51], s10 offen lds
    v_mfma_f32_16x16x32_bf16 v[236:239], v[56:59], v[92:95], v[236:239]
    s_add_u32 m0, s11, 133312
    v_mfma_f32_16x16x32_bf16 v[240:243], v[60:63], v[80:83], v[240:243]
    buffer_load_dwordx4 v12, s[48:51], s10 offen lds
    v_mfma_f32_16x16x32_bf16 v[244:247], v[60:63], v[84:87], v[244:247]
    s_add_u32 m0, s11, 134336
    v_mfma_f32_16x16x32_bf16 v[248:251], v[60:63], v[88:91], v[248:251]
    buffer_load_dwordx4 v13, s[48:51], s10 offen lds
    v_mfma_f32_16x16x32_bf16 v[252:255], v[60:63], v[92:95], v[252:255]
    s_add_u32 s10, s10, 18432
    s_waitcnt vmcnt(6) lgkmcnt(0)
    s_barrier
    v_mfma_f32_16x16x32_bf16 v[96:99], v[16:19], v[64:67], v[96:99]
    v_subrev_u32 v4, 51328, v4
    v_mfma_f32_16x16x32_bf16 v[100:103], v[16:19], v[68:71], v[100:103]
    v_subrev_u32 v2, 51328, v2
    v_mfma_f32_16x16x32_bf16 v[104:107], v[16:19], v[72:75], v[104:107]
    v_subrev_u32 v3, 51328, v3
    v_mfma_f32_16x16x32_bf16 v[108:111], v[16:19], v[76:79], v[108:111]
    ds_read_b64_tr_b16 v[16:17], v2 offset:0
    ds_read_b64_tr_b16 v[18:19], v2 offset:2304
    v_mfma_f32_16x16x32_bf16 v[112:115], v[20:23], v[64:67], v[112:115]
    ds_read_b128 v[80:83], v4 offset:0
    v_mfma_f32_16x16x32_bf16 v[116:119], v[20:23], v[68:71], v[116:119]
    ds_read_b128 v[84:87], v4 offset:1024
    v_mfma_f32_16x16x32_bf16 v[120:123], v[20:23], v[72:75], v[120:123]
    ds_read_b128 v[88:91], v4 offset:2048
    v_mfma_f32_16x16x32_bf16 v[124:127], v[20:23], v[76:79], v[124:127]
    ds_read_b64_tr_b16 v[20:21], v2 offset:9248
    v_mfma_f32_16x16x32_bf16 v[128:131], v[24:27], v[64:67], v[128:131]
    ds_read_b64_tr_b16 v[22:23], v2 offset:11552
    v_mfma_f32_16x16x32_bf16 v[132:135], v[24:27], v[68:71], v[132:135]
    ds_read_b128 v[92:95], v4 offset:3072
    v_mfma_f32_16x16x32_bf16 v[136:139], v[24:27], v[72:75], v[136:139]
    ds_read_b64_tr_b16 v[56:57], v2 offset:128
    v_mfma_f32_16x16x32_bf16 v[140:143], v[24:27], v[76:79], v[140:143]
    ds_read_b64_tr_b16 v[24:25], v3 offset:32
    v_mfma_f32_16x16x32_bf16 v[144:147], v[28:31], v[64:67], v[144:147]
    ds_read_b64_tr_b16 v[26:27], v3 offset:2336
    v_mfma_f32_16x16x32_bf16 v[148:151], v[28:31], v[68:71], v[148:151]
    ds_read_b64_tr_b16 v[58:59], v2 offset:2432
    v_mfma_f32_16x16x32_bf16 v[152:155], v[28:31], v[72:75], v[152:155]
    ds_read_b64_tr_b16 v[60:61], v2 offset:9376
    v_mfma_f32_16x16x32_bf16 v[156:159], v[28:31], v[76:79], v[156:159]
    ds_read_b64_tr_b16 v[28:29], v3 offset:9280
    v_mfma_f32_16x16x32_bf16 v[160:163], v[32:35], v[64:67], v[160:163]
    ds_read_b64_tr_b16 v[30:31], v3 offset:11584
    v_mfma_f32_16x16x32_bf16 v[164:167], v[32:35], v[68:71], v[164:167]
    ds_read_b64_tr_b16 v[62:63], v2 offset:11680
    v_mfma_f32_16x16x32_bf16 v[168:171], v[32:35], v[72:75], v[168:171]
    s_add_u32 m0, s11, 76992
    v_mfma_f32_16x16x32_bf16 v[172:175], v[32:35], v[76:79], v[172:175]
    ds_read_b64_tr_b16 v[32:33], v2 offset:64
    v_mfma_f32_16x16x32_bf16 v[176:179], v[36:39], v[64:67], v[176:179]
    ds_read_b64_tr_b16 v[34:35], v2 offset:2368
    v_mfma_f32_16x16x32_bf16 v[180:183], v[36:39], v[68:71], v[180:183]
    buffer_load_dwordx4 v11, s[48:51], s10 offen lds
    v_mfma_f32_16x16x32_bf16 v[184:187], v[36:39], v[72:75], v[184:187]
    s_add_u32 m0, s11, 78016
    v_mfma_f32_16x16x32_bf16 v[188:191], v[36:39], v[76:79], v[188:191]
    ds_read_b64_tr_b16 v[36:37], v2 offset:9312
    v_mfma_f32_16x16x32_bf16 v[192:195], v[40:43], v[64:67], v[192:195]
    ds_read_b64_tr_b16 v[38:39], v2 offset:11616
    v_mfma_f32_16x16x32_bf16 v[196:199], v[40:43], v[68:71], v[196:199]
    buffer_load_dwordx4 v12, s[48:51], s10 offen lds
    v_mfma_f32_16x16x32_bf16 v[200:203], v[40:43], v[72:75], v[200:203]
    s_add_u32 m0, s11, 79040
    v_mfma_f32_16x16x32_bf16 v[204:207], v[40:43], v[76:79], v[204:207]
    ds_read_b64_tr_b16 v[40:41], v3 offset:96
    v_mfma_f32_16x16x32_bf16 v[208:211], v[44:47], v[64:67], v[208:211]
    ds_read_b64_tr_b16 v[42:43], v3 offset:2400
    v_mfma_f32_16x16x32_bf16 v[212:215], v[44:47], v[68:71], v[212:215]
    buffer_load_dwordx4 v13, s[48:51], s10 offen lds
    v_mfma_f32_16x16x32_bf16 v[216:219], v[44:47], v[72:75], v[216:219]
    s_add_u32 s10, s10, 18432
    v_mfma_f32_16x16x32_bf16 v[220:223], v[44:47], v[76:79], v[220:223]
    ds_read_b64_tr_b16 v[44:45], v3 offset:9344
    v_mfma_f32_16x16x32_bf16 v[224:227], v[48:51], v[64:67], v[224:227]
    ds_read_b64_tr_b16 v[46:47], v3 offset:11648
    v_mfma_f32_16x16x32_bf16 v[228:231], v[48:51], v[68:71], v[228:231]
    s_add_u32 m0, s11, 95424
    v_mfma_f32_16x16x32_bf16 v[232:235], v[48:51], v[72:75], v[232:235]
    buffer_load_dwordx4 v11, s[48:51], s10 offen lds
    v_mfma_f32_16x16x32_bf16 v[236:239], v[48:51], v[76:79], v[236:239]
    s_add_u32 m0, s11, 96448
    v_mfma_f32_16x16x32_bf16 v[240:243], v[52:55], v[64:67], v[240:243]
    buffer_load_dwordx4 v12, s[48:51], s10 offen lds
    v_mfma_f32_16x16x32_bf16 v[244:247], v[52:55], v[68:71], v[244:247]
    s_add_u32 m0, s11, 97472
    v_mfma_f32_16x16x32_bf16 v[248:251], v[52:55], v[72:75], v[248:251]
    buffer_load_dwordx4 v13, s[48:51], s10 offen lds
    v_mfma_f32_16x16x32_bf16 v[252:255], v[52:55], v[76:79], v[252:255]
    s_add_u32 s10, s10, 18432
    s_waitcnt lgkmcnt(0)
    s_barrier
    v_mfma_f32_16x16x32_bf16 v[96:99], v[16:19], v[80:83], v[96:99]
    v_lshrrev_b32 v72, 5, v0
    v_bfe_u32 v73, v0, 2, 2
    v_bfe_u32 v74, v0, 4, 1
    v_and_b32 v75, 3, v0
    s_lshr_b32 s56, s3, 1
    v_mfma_f32_16x16x32_bf16 v[100:103], v[16:19], v[84:87], v[100:103]
    s_and_b32 s57, s3, 1
    s_lshl_b32 s58, s57, 11
    v_add_u32 v6, s58, v1
    v_add_u32 v7, 36864, v6
    v_and_b32 v76, 15, v0
    v_mfma_f32_16x16x32_bf16 v[104:107], v[16:19], v[88:91], v[104:107]
    v_lshl_add_u32 v77, v74, 5, v76
    v_lshlrev_b32 v77, 4, v77
    v_lshl_add_u32 v77, v72, 3, v77
    s_mul_i32 s59, s56, 20480
    s_add_u32 s59, s59, s58
    v_mfma_f32_16x16x32_bf16 v[108:111], v[16:19], v[92:95], v[108:111]
    v_add_u32 v8, s59, v77
    s_mul_i32 s58, s56, 9
    s_cmp_ge_u32 s56, 2
    s_cselect_b32 s59, 13, 0
    s_sub_u32 s13, s58, s59
    v_mfma_f32_16x16x32_bf16 v[112:115], v[20:23], v[80:83], v[112:115]
    v_lshl_add_u32 v76, v72, 2, v73
    v_mul_u32_u24 v76, 1152, v76
    v_lshl_add_u32 v76, v74, 5, v76
    v_lshl_add_u32 v76, v75, 3, v76
    v_lshrrev_b32 v77, 1, v73
    v_mfma_f32_16x16x32_bf16 v[116:119], v[20:23], v[84:87], v[116:119]
    s_and_b32 s58, s13, 1
    v_xor_b32 v77, s58, v77
    v_lshl_add_u32 v2, v77, 6, v76
    v_xor_b32 v77, 1, v77
    v_lshl_add_u32 v4, v77, 6, v76
    v_mfma_f32_16x16x32_bf16 v[120:123], v[20:23], v[88:91], v[120:123]
    s_lshr_b32 s58, s13, 1
    s_lshl_b32 s58, s58, 7
    s_add_u32 s58, s58, 76992
    v_add_u32 v2, s58, v2
    s_add_u32 s58, s13, 1
    v_mfma_f32_16x16x32_bf16 v[124:127], v[20:23], v[92:95], v[124:127]
    s_lshr_b32 s58, s58, 1
    s_lshl_b32 s58, s58, 7
    s_add_u32 s58, s58, 76992
    v_add_u32 v4, s58, v4
    v_add_u32 v3, 36864, v2
    v_mfma_f32_16x16x32_bf16 v[128:131], v[24:27], v[80:83], v[128:131]
    v_add_u32 v5, 36864, v4
    s_mul_i32 s58, s3, 1152
    s_add_u32 s58, s58, 153984
    v_add_u32 v14, s58, v1
    v_and_b32 v76, 31, v0
    v_mfma_f32_16x16x32_bf16 v[132:135], v[24:27], v[84:87], v[132:135]
    v_lshlrev_b32 v76, 2, v76
    s_add_u32 s58, s58, 1024
    v_add_u32 v15, s58, v76
    v_mfma_f32_16x16x32_bf16 v[136:139], v[24:27], v[88:91], v[136:139]
    v_mfma_f32_16x16x32_bf16 v[140:143], v[24:27], v[92:95], v[140:143]
    v_mfma_f32_16x16x32_bf16 v[144:147], v[28:31], v[80:83], v[144:147]
    v_mfma_f32_16x16x32_bf16 v[148:151], v[28:31], v[84:87], v[148:151]
    v_mfma_f32_16x16x32_bf16 v[152:155], v[28:31], v[88:91], v[152:155]
    v_mfma_f32_16x16x32_bf16 v[156:159], v[28:31], v[92:95], v[156:159]
    v_max_f32 v96, 0, v96
    v_max_f32 v97, 0, v97
    v_max_f32 v98, 0, v98
    v_max_f32 v99, 0, v99
    v_mul_f32 v96, v96, v112
    v_mfma_f32_16x16x32_bf16 v[160:163], v[32:35], v[80:83], v[160:163]
    v_mul_f32 v97, v97, v113
    v_mul_f32 v98, v98, v114
    v_mul_f32 v99, v99, v115
    v_cvt_pk_bf16_f32 v48, v96, v97
    v_cvt_pk_bf16_f32 v49, v98, v99
    v_mfma_f32_16x16x32_bf16 v[164:167], v[32:35], v[84:87], v[164:167]
    ds_write_b64 v8, v[48:49] offset:0
    v_max_f32 v100, 0, v100
    v_max_f32 v101, 0, v101
    v_max_f32 v102, 0, v102
    v_max_f32 v103, 0, v103
    v_mfma_f32_16x16x32_bf16 v[168:171], v[32:35], v[88:91], v[168:171]
    v_mul_f32 v100, v100, v116
    v_mul_f32 v101, v101, v117
    v_mul_f32 v102, v102, v118
    v_mul_f32 v103, v103, v119
    v_cvt_pk_bf16_f32 v50, v100, v101
    v_mfma_f32_16x16x32_bf16 v[172:175], v[32:35], v[92:95], v[172:175]
    v_cvt_pk_bf16_f32 v51, v102, v103
    ds_write_b64 v8, v[50:51] offset:256
    v_max_f32 v104, 0, v104
    v_max_f32 v105, 0, v105
    v_max_f32 v106, 0, v106
    v_mfma_f32_16x16x32_bf16 v[176:179], v[36:39], v[80:83], v[176:179]
    v_max_f32 v107, 0, v107
    v_mul_f32 v104, v104, v120
    v_mul_f32 v105, v105, v121
    v_mul_f32 v106, v106, v122
    v_mul_f32 v107, v107, v123
    v_mfma_f32_16x16x32_bf16 v[180:183], v[36:39], v[84:87], v[180:183]
    v_cvt_pk_bf16_f32 v52, v104, v105
    v_cvt_pk_bf16_f32 v53, v106, v107
    ds_write_b64 v8, v[52:53] offset:1024
    v_max_f32 v108, 0, v108
    v_max_f32 v109, 0, v109
    v_mfma_f32_16x16x32_bf16 v[184:187], v[36:39], v[88:91], v[184:187]
    v_max_f32 v110, 0, v110
    v_max_f32 v111, 0, v111
    v_mul_f32 v108, v108, v124
    v_mul_f32 v109, v109, v125
    v_mul_f32 v110, v110, v126
    v_mfma_f32_16x16x32_bf16 v[188:191], v[36:39], v[92:95], v[188:191]
    v_mul_f32 v111, v111, v127
    v_cvt_pk_bf16_f32 v54, v108, v109
    v_cvt_pk_bf16_f32 v55, v110, v111
    ds_write_b64 v8, v[54:55] offset:1280
    v_mfma_f32_16x16x32_bf16 v[192:195], v[40:43], v[80:83], v[192:195]
    v_max_f32 v128, 0, v128
    v_max_f32 v129, 0, v129
    v_max_f32 v130, 0, v130
    v_max_f32 v131, 0, v131
    v_mul_f32 v128, v128, v144
    v_mfma_f32_16x16x32_bf16 v[196:199], v[40:43], v[84:87], v[196:199]
    v_mul_f32 v129, v129, v145
    v_mul_f32 v130, v130, v146
    v_mul_f32 v131, v131, v147
    v_cvt_pk_bf16_f32 v48, v128, v129
    v_cvt_pk_bf16_f32 v49, v130, v131
    v_mfma_f32_16x16x32_bf16 v[200:203], v[40:43], v[88:91], v[200:203]
    ds_write_b64 v8, v[48:49] offset:4096
    v_max_f32 v132, 0, v132
    v_max_f32 v133, 0, v133
    v_max_f32 v134, 0, v134
    v_max_f32 v135, 0, v135
    v_mfma_f32_16x16x32_bf16 v[204:207], v[40:43], v[92:95], v[204:207]
    v_mul_f32 v132, v132, v148
    v_mul_f32 v133, v133, v149
    v_mul_f32 v134, v134, v150
    v_mul_f32 v135, v135, v151
    v_cvt_pk_bf16_f32 v50, v132, v133
    v_mfma_f32_16x16x32_bf16 v[208:211], v[44:47], v[80:83], v[208:211]
    v_cvt_pk_bf16_f32 v51, v134, v135
    ds_write_b64 v8, v[50:51] offset:4352
    v_max_f32 v136, 0, v136
    v_max_f32 v137, 0, v137
    v_max_f32 v138, 0, v138
    v_mfma_f32_16x16x32_bf16 v[212:215], v[44:47], v[84:87], v[212:215]
    v_max_f32 v139, 0, v139
    v_mul_f32 v136, v136, v152
    v_mul_f32 v137, v137, v153
    v_mul_f32 v138, v138, v154
    v_mul_f32 v139, v139, v155
    v_mfma_f32_16x16x32_bf16 v[216:219], v[44:47], v[88:91], v[216:219]
    v_cvt_pk_bf16_f32 v52, v136, v137
    v_cvt_pk_bf16_f32 v53, v138, v139
    ds_write_b64 v8, v[52:53] offset:5120
    v_max_f32 v140, 0, v140
    v_max_f32 v141, 0, v141
    v_mfma_f32_16x16x32_bf16 v[220:223], v[44:47], v[92:95], v[220:223]
    v_max_f32 v142, 0, v142
    v_max_f32 v143, 0, v143
    v_mul_f32 v140, v140, v156
    v_mul_f32 v141, v141, v157
    v_mul_f32 v142, v142, v158
    v_mfma_f32_16x16x32_bf16 v[224:227], v[56:59], v[80:83], v[224:227]
    v_mul_f32 v143, v143, v159
    v_cvt_pk_bf16_f32 v54, v140, v141
    v_cvt_pk_bf16_f32 v55, v142, v143
    ds_write_b64 v8, v[54:55] offset:5376
    v_mfma_f32_16x16x32_bf16 v[228:231], v[56:59], v[84:87], v[228:231]
    v_max_f32 v160, 0, v160
    v_max_f32 v161, 0, v161
    v_max_f32 v162, 0, v162
    v_max_f32 v163, 0, v163
    v_mul_f32 v160, v160, v176
    v_mfma_f32_16x16x32_bf16 v[232:235], v[56:59], v[88:91], v[232:235]
    v_mul_f32 v161, v161, v177
    v_mul_f32 v162, v162, v178
    v_mul_f32 v163, v163, v179
    v_cvt_pk_bf16_f32 v48, v160, v161
    v_cvt_pk_bf16_f32 v49, v162, v163
    v_mfma_f32_16x16x32_bf16 v[236:239], v[56:59], v[92:95], v[236:239]
    ds_write_b64 v8, v[48:49] offset:8192
    v_max_f32 v164, 0, v164
    v_max_f32 v165, 0, v165
    v_max_f32 v166, 0, v166
    v_max_f32 v167, 0, v167
    v_mfma_f32_16x16x32_bf16 v[240:243], v[60:63], v[80:83], v[240:243]
    v_mul_f32 v164, v164, v180
    v_mul_f32 v165, v165, v181
    v_mul_f32 v166, v166, v182
    v_mul_f32 v167, v167, v183
    v_cvt_pk_bf16_f32 v50, v164, v165
    v_mfma_f32_16x16x32_bf16 v[244:247], v[60:63], v[84:87], v[244:247]
    v_cvt_pk_bf16_f32 v51, v166, v167
    ds_write_b64 v8, v[50:51] offset:8448
    v_max_f32 v168, 0, v168
    v_max_f32 v169, 0, v169
    v_max_f32 v170, 0, v170
    v_mfma_f32_16x16x32_bf16 v[248:251], v[60:63], v[88:91], v[248:251]
    v_max_f32 v171, 0, v171
    v_mul_f32 v168, v168, v184
    v_mul_f32 v169, v169, v185
    v_mul_f32 v170, v170, v186
    v_mul_f32 v171, v171, v187
    v_mfma_f32_16x16x32_bf16 v[252:255], v[60:63], v[92:95], v[252:255]
    v_cvt_pk_bf16_f32 v52, v168, v169
    v_cvt_pk_bf16_f32 v53, v170, v171
    ds_write_b64 v8, v[52:53] offset:9216
    v_max_f32 v172, 0, v172
    v_max_f32 v173, 0, v173
    v_max_f32 v174, 0, v174
    v_max_f32 v175, 0, v175
    v_mul_f32 v172, v172, v188
    v_mul_f32 v173, v173, v189
    v_mul_f32 v174, v174, v190
    v_mul_f32 v175, v175, v191
    v_cvt_pk_bf16_f32 v54, v172, v173
    v_cvt_pk_bf16_f32 v55, v174, v175
    ds_write_b64 v8, v[54:55] offset:9472
    s_nop 7
    v_max_f32 v192, 0, v192
    v_max_f32 v193, 0, v193
    v_max_f32 v194, 0, v194
    v_max_f32 v195, 0, v195
    v_mul_f32 v192, v192, v208
    v_mul_f32 v193, v193, v209
    v_mul_f32 v194, v194, v210
    v_mul_f32 v195, v195, v211
    v_cvt_pk_bf16_f32 v48, v192, v193
    v_cvt_pk_bf16_f32 v49, v194, v195
    ds_write_b64 v8, v[48:49] offset:12288
    v_max_f32 v196, 0, v196
    v_max_f32 v197, 0, v197
    v_max_f32 v198, 0, v198
    v_max_f32 v199, 0, v199
    v_mul_f32 v196, v196, v212
    v_mul_f32 v197, v197, v213
    v_mul_f32 v198, v198, v214
    v_mul_f32 v199, v199, v215
    v_cvt_pk_bf16_f32 v50, v196, v197
    v_cvt_pk_bf16_f32 v51, v198, v199
    ds_write_b64 v8, v[50:51] offset:12544
    v_max_f32 v200, 0, v200
    v_max_f32 v201, 0, v201
    v_max_f32 v202, 0, v202
    v_max_f32 v203, 0, v203
    v_mul_f32 v200, v200, v216
    v_mul_f32 v201, v201, v217
    v_mul_f32 v202, v202, v218
    v_mul_f32 v203, v203, v219
    v_cvt_pk_bf16_f32 v52, v200, v201
    v_cvt_pk_bf16_f32 v53, v202, v203
    ds_write_b64 v8, v[52:53] offset:13312
    v_max_f32 v204, 0, v204
    v_max_f32 v205, 0, v205
    v_max_f32 v206, 0, v206
    v_max_f32 v207, 0, v207
    v_mul_f32 v204, v204, v220
    v_mul_f32 v205, v205, v221
    v_mul_f32 v206, v206, v222
    v_mul_f32 v207, v207, v223
    v_cvt_pk_bf16_f32 v54, v204, v205
    v_cvt_pk_bf16_f32 v55, v206, v207
    ds_write_b64 v8, v[54:55] offset:13568
    v_max_f32 v224, 0, v224
    v_max_f32 v225, 0, v225
    v_max_f32 v226, 0, v226
    v_max_f32 v227, 0, v227
    v_mul_f32 v224, v224, v240
    v_mul_f32 v225, v225, v241
    v_mul_f32 v226, v226, v242
    v_mul_f32 v227, v227, v243
    v_cvt_pk_bf16_f32 v48, v224, v225
    v_cvt_pk_bf16_f32 v49, v226, v227
    ds_write_b64 v8, v[48:49] offset:16384
    v_max_f32 v228, 0, v228
    v_max_f32 v229, 0, v229
    v_max_f32 v230, 0, v230
    v_max_f32 v231, 0, v231
    v_mul_f32 v228, v228, v244
    v_mul_f32 v229, v229, v245
    v_mul_f32 v230, v230, v246
    v_mul_f32 v231, v231, v247
    v_cvt_pk_bf16_f32 v50, v228, v229
    v_cvt_pk_bf16_f32 v51, v230, v231
    ds_write_b64 v8, v[50:51] offset:16640
    v_max_f32 v232, 0, v232
    v_max_f32 v233, 0, v233
    v_max_f32 v234, 0, v234
    v_max_f32 v235, 0, v235
    v_mul_f32 v232, v232, v248
    v_mul_f32 v233, v233, v249
    v_mul_f32 v234, v234, v250
    v_mul_f32 v235, v235, v251
    v_cvt_pk_bf16_f32 v52, v232, v233
    v_cvt_pk_bf16_f32 v53, v234, v235
    ds_write_b64 v8, v[52:53] offset:17408
    v_max_f32 v236, 0, v236
    v_max_f32 v237, 0, v237
    v_max_f32 v238, 0, v238
    v_max_f32 v239, 0, v239
    v_mul_f32 v236, v236, v252
    v_mul_f32 v237, v237, v253
    v_mul_f32 v238, v238, v254
    v_mul_f32 v239, v239, v255
    v_cvt_pk_bf16_f32 v54, v236, v237
    v_cvt_pk_bf16_f32 v55, v238, v239
    ds_write_b64 v8, v[54:55] offset:17664
    s_cmp_ge_u32 s3, 4
    s_cbranch_scc1 G2_4D
    s_waitcnt vmcnt(9) lgkmcnt(0)
    s_barrier
    ds_read_b128 v[36:39], v6 offset:0
    ds_read_b128 v[40:43], v6 offset:1024
    ds_read_b64_tr_b16 v[16:17], v3 offset:0
    ds_read_b64_tr_b16 v[18:19], v3 offset:9216
    ds_read_b64_tr_b16 v[20:21], v5 offset:0
    ds_read_b64_tr_b16 v[22:23], v5 offset:9216
    ds_read_b64_tr_b16 v[24:25], v3 offset:128
    ds_read_b64_tr_b16 v[26:27], v3 offset:9344
    ds_read_b64_tr_b16 v[28:29], v5 offset:128
    ds_read_b64_tr_b16 v[30:31], v5 offset:9344
    ds_read_b64_tr_b16 v[32:33], v3 offset:256
    ds_read_b64_tr_b16 v[34:35], v3 offset:9472
    ds_read_b128 v[88:91], v14
    ds_read_b32 v92, v15
    s_lshl_b32 s58, s3, 10
    s_add_u32 s59, s58, 2359296
    s_waitcnt vmcnt(6) lgkmcnt(0)
    s_barrier
    v_mfma_f32_32x32x16_bf16 v[96:111], v[16:19], v[36:39], 0
    ds_read_b128 v[64:67], v6 offset:4096
    ds_read_b128 v[68:71], v6 offset:5120
    v_mfma_f32_32x32x16_bf16 v[112:127], v[16:19], v[40:43], 0
    ds_read_b64_tr_b16 v[44:45], v3 offset:18432
    ds_read_b64_tr_b16 v[46:47], v3 offset:27648
    v_mfma_f32_32x32x16_bf16 v[128:143], v[20:23], v[36:39], 0
    ds_read_b64_tr_b16 v[48:49], v5 offset:18432
    ds_read_b64_tr_b16 v[50:51], v5 offset:27648
    v_mfma_f32_32x32x16_bf16 v[144:159], v[20:23], v[40:43], 0
    ds_read_b64_tr_b16 v[52:53], v3 offset:18560
    ds_read_b64_tr_b16 v[54:55], v3 offset:27776
    v_mfma_f32_32x32x16_bf16 v[160:175], v[24:27], v[36:39], 0
    ds_read_b64_tr_b16 v[56:57], v5 offset:18560
    ds_read_b64_tr_b16 v[58:59], v5 offset:27776
    v_mfma_f32_32x32x16_bf16 v[176:191], v[24:27], v[40:43], 0
    ds_read_b64_tr_b16 v[60:61], v3 offset:18688
    ds_read_b64_tr_b16 v[62:63], v3 offset:27904
    s_add_u32 m0, s11, 113856
    s_nop 0
    buffer_load_dwordx4 v11, s[48:51], s10 offen lds
    v_mfma_f32_32x32x16_bf16 v[192:207], v[28:31], v[36:39], 0
    s_add_u32 m0, s11, 114880
    s_nop 0
    buffer_load_dwordx4 v12, s[48:51], s10 offen lds
    v_mfma_f32_32x32x16_bf16 v[208:223], v[28:31], v[40:43], 0
    s_add_u32 m0, s11, 115904
    s_nop 0
    buffer_load_dwordx4 v13, s[48:51], s10 offen lds
    s_add_u32 s10, s10, 18432
    v_mfma_f32_32x32x16_bf16 v[224:239], v[32:35], v[36:39], 0
    v_mfma_f32_32x32x16_bf16 v[240:255], v[32:35], v[40:43], 0
    s_waitcnt vmcnt(6) lgkmcnt(0)
    s_barrier
    v_mfma_f32_32x32x16_bf16 v[96:111], v[44:47], v[64:67], v[96:111]
    ds_read_b128 v[36:39], v6 offset:8192
    ds_read_b128 v[40:43], v6 offset:9216
    v_mfma_f32_32x32x16_bf16 v[112:127], v[44:47], v[68:71], v[112:127]
    ds_read_b64_tr_b16 v[16:17], v2 offset:0
    ds_read_b64_tr_b16 v[18:19], v2 offset:9216
    v_mfma_f32_32x32x16_bf16 v[128:143], v[48:51], v[64:67], v[128:143]
    ds_read_b64_tr_b16 v[20:21], v4 offset:0
    ds_read_b64_tr_b16 v[22:23], v4 offset:9216
    v_mfma_f32_32x32x16_bf16 v[144:159], v[48:51], v[68:71], v[144:159]
    ds_read_b64_tr_b16 v[24:25], v2 offset:128
    ds_read_b64_tr_b16 v[26:27], v2 offset:9344
    v_mfma_f32_32x32x16_bf16 v[160:175], v[52:55], v[64:67], v[160:175]
    ds_read_b64_tr_b16 v[28:29], v4 offset:128
    ds_read_b64_tr_b16 v[30:31], v4 offset:9344
    v_mfma_f32_32x32x16_bf16 v[176:191], v[52:55], v[68:71], v[176:191]
    ds_read_b64_tr_b16 v[32:33], v2 offset:256
    ds_read_b64_tr_b16 v[34:35], v2 offset:9472
    s_add_u32 m0, s11, 132288
    s_nop 0
    buffer_load_dwordx4 v11, s[48:51], s10 offen lds
    v_mfma_f32_32x32x16_bf16 v[192:207], v[56:59], v[64:67], v[192:207]
    s_add_u32 m0, s11, 133312
    s_nop 0
    buffer_load_dwordx4 v12, s[48:51], s10 offen lds
    v_mfma_f32_32x32x16_bf16 v[208:223], v[56:59], v[68:71], v[208:223]
    s_add_u32 m0, s11, 134336
    s_nop 0
    buffer_load_dwordx4 v13, s[48:51], s10 offen lds
    s_add_u32 s10, s10, 18432
    v_mfma_f32_32x32x16_bf16 v[224:239], v[60:63], v[64:67], v[224:239]
    v_mfma_f32_32x32x16_bf16 v[240:255], v[60:63], v[68:71], v[240:255]
    s_waitcnt vmcnt(6) lgkmcnt(0)
    s_barrier
    v_mfma_f32_32x32x16_bf16 v[96:111], v[16:19], v[36:39], v[96:111]
    ds_read_b128 v[64:67], v6 offset:12288
    ds_read_b128 v[68:71], v6 offset:13312
    v_mfma_f32_32x32x16_bf16 v[112:127], v[16:19], v[40:43], v[112:127]
    ds_read_b64_tr_b16 v[44:45], v2 offset:18432
    ds_read_b64_tr_b16 v[46:47], v2 offset:27648
    v_mfma_f32_32x32x16_bf16 v[128:143], v[20:23], v[36:39], v[128:143]
    ds_read_b64_tr_b16 v[48:49], v4 offset:18432
    ds_read_b64_tr_b16 v[50:51], v4 offset:27648
    v_mfma_f32_32x32x16_bf16 v[144:159], v[20:23], v[40:43], v[144:159]
    ds_read_b64_tr_b16 v[52:53], v2 offset:18560
    ds_read_b64_tr_b16 v[54:55], v2 offset:27776
    v_mfma_f32_32x32x16_bf16 v[160:175], v[24:27], v[36:39], v[160:175]
    ds_read_b64_tr_b16 v[56:57], v4 offset:18560
    ds_read_b64_tr_b16 v[58:59], v4 offset:27776
    v_mfma_f32_32x32x16_bf16 v[176:191], v[24:27], v[40:43], v[176:191]
    ds_read_b64_tr_b16 v[60:61], v2 offset:18688
    ds_read_b64_tr_b16 v[62:63], v2 offset:27904
    s_add_u32 m0, s11, 76992
    s_nop 0
    buffer_load_dwordx4 v11, s[48:51], s10 offen lds
    v_mfma_f32_32x32x16_bf16 v[192:207], v[28:31], v[36:39], v[192:207]
    s_add_u32 m0, s11, 78016
    s_nop 0
    buffer_load_dwordx4 v12, s[48:51], s10 offen lds
    v_mfma_f32_32x32x16_bf16 v[208:223], v[28:31], v[40:43], v[208:223]
    s_add_u32 m0, s11, 79040
    s_nop 0
    buffer_load_dwordx4 v13, s[48:51], s10 offen lds
    s_add_u32 s10, s10, 18432
    v_mfma_f32_32x32x16_bf16 v[224:239], v[32:35], v[36:39], v[224:239]
    v_mfma_f32_32x32x16_bf16 v[240:255], v[32:35], v[40:43], v[240:255]
    s_waitcnt vmcnt(6) lgkmcnt(0)
    s_barrier
    v_mfma_f32_32x32x16_bf16 v[96:111], v[44:47], v[64:67], v[96:111]
    ds_read_b128 v[36:39], v6 offset:16384
    ds_read_b128 v[40:43], v6 offset:17408
    v_mfma_f32_32x32x16_bf16 v[112:127], v[44:47], v[68:71], v[112:127]
    ds_read_b64_tr_b16 v[16:17], v3 offset:0
    ds_read_b64_tr_b16 v[18:19], v3 offset:9216
    v_mfma_f32_32x32x16_bf16 v[128:143], v[48:51], v[64:67], v[128:143]
    ds_read_b64_tr_b16 v[20:21], v5 offset:0
    ds_read_b64_tr_b16 v[22:23], v5 offset:9216
    v_mfma_f32_32x32x16_bf16 v[144:159], v[48:51], v[68:71], v[144:159]
    ds_read_b64_tr_b16 v[24:25], v3 offset:128
    ds_read_b64_tr_b16 v[26:27], v3 offset:9344
    v_mfma_f32_32x32x16_bf16 v[160:175], v[52:55], v[64:67], v[160:175]
    ds_read_b64_tr_b16 v[28:29], v5 offset:128
    ds_read_b64_tr_b16 v[30:31], v5 offset:9344
    v_mfma_f32_32x32x16_bf16 v[176:191], v[52:55], v[68:71], v[176:191]
    ds_read_b64_tr_b16 v[32:33], v3 offset:256
    ds_read_b64_tr_b16 v[34:35], v3 offset:9472
    s_add_u32 m0, s11, 95424
    s_nop 0
    buffer_load_dwordx4 v11, s[48:51], s10 offen lds
    v_mfma_f32_32x32x16_bf16 v[192:207], v[56:59], v[64:67], v[192:207]
    s_add_u32 m0, s11, 96448
    s_nop 0
    buffer_load_dwordx4 v12, s[48:51], s10 offen lds
    v_mfma_f32_32x32x16_bf16 v[208:223], v[56:59], v[68:71], v[208:223]
    s_add_u32 m0, s11, 97472
    s_nop 0
    buffer_load_dwordx4 v13, s[48:51], s10 offen lds
    s_add_u32 s10, s10, 18432
    v_mfma_f32_32x32x16_bf16 v[224:239], v[60:63], v[64:67], v[224:239]
    v_mfma_f32_32x32x16_bf16 v[240:255], v[60:63], v[68:71], v[240:255]
    s_waitcnt vmcnt(6) lgkmcnt(0)
    s_barrier
    v_mfma_f32_32x32x16_bf16 v[96:111], v[16:19], v[36:39], v[96:111]
    ds_read_b128 v[64:67], v6 offset:20480
    ds_read_b128 v[68:71], v6 offset:21504
    v_mfma_f32_32x32x16_bf16 v[112:127], v[16:19], v[40:43], v[112:127]
    ds_read_b64_tr_b16 v[44:45], v3 offset:18432
    ds_read_b64_tr_b16 v[46:47], v3 offset:27648
    v_mfma_f32_32x32x16_bf16 v[128:143], v[20:23], v[36:39], v[128:143]
    ds_read_b64_tr_b16 v[48:49], v5 offset:18432
    ds_read_b64_tr_b16 v[50:51], v5 offset:27648
    v_mfma_f32_32x32x16_bf16 v[144:159], v[20:23], v[40:43], v[144:159]
    ds_read_b64_tr_b16 v[52:53], v3 offset:18560
    ds_read_b64_tr_b16 v[54:55], v3 offset:27776
    v_mfma_f32_32x32x16_bf16 v[160:175], v[24:27], v[36:39], v[160:175]
    ds_read_b64_tr_b16 v[56:57], v5 offset:18560
    ds_read_b64_tr_b16 v[58:59], v5 offset:27776
    v_mfma_f32_32x32x16_bf16 v[176:191], v[24:27], v[40:43], v[176:191]
    ds_read_b64_tr_b16 v[60:61], v3 offset:18688
    ds_read_b64_tr_b16 v[62:63], v3 offset:27904
    s_add_u32 m0, s11, 113856
    s_nop 0
    buffer_load_dwordx4 v11, s[48:51], s10 offen lds
    v_mfma_f32_32x32x16_bf16 v[192:207], v[28:31], v[36:39], v[192:207]
    s_add_u32 m0, s11, 114880
    s_nop 0
    buffer_load_dwordx4 v12, s[48:51], s10 offen lds
    v_mfma_f32_32x32x16_bf16 v[208:223], v[28:31], v[40:43], v[208:223]
    s_add_u32 m0, s11, 115904
    s_nop 0
    buffer_load_dwordx4 v13, s[48:51], s10 offen lds
    s_add_u32 s10, s10, 18432
    v_mfma_f32_32x32x16_bf16 v[224:239], v[32:35], v[36:39], v[224:239]
    v_mfma_f32_32x32x16_bf16 v[240:255], v[32:35], v[40:43], v[240:255]
    s_waitcnt vmcnt(6) lgkmcnt(0)
    s_barrier
    v_mfma_f32_32x32x16_bf16 v[96:111], v[44:47], v[64:67], v[96:111]
    ds_read_b128 v[36:39], v6 offset:24576
    ds_read_b128 v[40:43], v6 offset:25600
    v_mfma_f32_32x32x16_bf16 v[112:127], v[44:47], v[68:71], v[112:127]
    ds_read_b64_tr_b16 v[16:17], v2 offset:0
    ds_read_b64_tr_b16 v[18:19], v2 offset:9216
    v_mfma_f32_32x32x16_bf16 v[128:143], v[48:51], v[64:67], v[128:143]
    ds_read_b64_tr_b16 v[20:21], v4 offset:0
    ds_read_b64_tr_b16 v[22:23], v4 offset:9216
    v_mfma_f32_32x32x16_bf16 v[144:159], v[48:51], v[68:71], v[144:159]
    ds_read_b64_tr_b16 v[24:25], v2 offset:128
    ds_read_b64_tr_b16 v[26:27], v2 offset:9344
    v_mfma_f32_32x32x16_bf16 v[160:175], v[52:55], v[64:67], v[160:175]
    ds_read_b64_tr_b16 v[28:29], v4 offset:128
    ds_read_b64_tr_b16 v[30:31], v4 offset:9344
    v_mfma_f32_32x32x16_bf16 v[176:191], v[52:55], v[68:71], v[176:191]
    ds_read_b64_tr_b16 v[32:33], v2 offset:256
    ds_read_b64_tr_b16 v[34:35], v2 offset:9472
    s_add_u32 m0, s11, 132288
    s_nop 0
    buffer_load_dwordx4 v11, s[48:51], s10 offen lds
    v_mfma_f32_32x32x16_bf16 v[192:207], v[56:59], v[64:67], v[192:207]
    s_add_u32 m0, s11, 133312
    s_nop 0
    buffer_load_dwordx4 v12, s[48:51], s10 offen lds
    v_mfma_f32_32x32x16_bf16 v[208:223], v[56:59], v[68:71], v[208:223]
    s_add_u32 m0, s11, 134336
    s_nop 0
    buffer_load_dwordx4 v13, s[48:51], s10 offen lds
    s_add_u32 s10, s10, 18432
    v_mfma_f32_32x32x16_bf16 v[224:239], v[60:63], v[64:67], v[224:239]
    v_mfma_f32_32x32x16_bf16 v[240:255], v[60:63], v[68:71], v[240:255]
    s_waitcnt vmcnt(6) lgkmcnt(0)
    s_barrier
    v_mfma_f32_32x32x16_bf16 v[96:111], v[16:19], v[36:39], v[96:111]
    ds_read_b128 v[64:67], v6 offset:28672
    ds_read_b128 v[68:71], v6 offset:29696
    v_mfma_f32_32x32x16_bf16 v[112:127], v[16:19], v[40:43], v[112:127]
    ds_read_b64_tr_b16 v[44:45], v2 offset:18432
    ds_read_b64_tr_b16 v[46:47], v2 offset:27648
    v_mfma_f32_32x32x16_bf16 v[128:143], v[20:23], v[36:39], v[128:143]
    ds_read_b64_tr_b16 v[48:49], v4 offset:18432
    ds_read_b64_tr_b16 v[50:51], v4 offset:27648
    v_mfma_f32_32x32x16_bf16 v[144:159], v[20:23], v[40:43], v[144:159]
    ds_read_b64_tr_b16 v[52:53], v2 offset:18560
    ds_read_b64_tr_b16 v[54:55], v2 offset:27776
    v_mfma_f32_32x32x16_bf16 v[160:175], v[24:27], v[36:39], v[160:175]
    ds_read_b64_tr_b16 v[56:57], v4 offset:18560
    ds_read_b64_tr_b16 v[58:59], v4 offset:27776
    v_mfma_f32_32x32x16_bf16 v[176:191], v[24:27], v[40:43], v[176:191]
    ds_read_b64_tr_b16 v[60:61], v2 offset:18688
    ds_read_b64_tr_b16 v[62:63], v2 offset:27904
    s_add_u32 m0, s11, 76992
    s_nop 0
    buffer_load_dwordx4 v11, s[48:51], s10 offen lds
    v_mfma_f32_32x32x16_bf16 v[192:207], v[28:31], v[36:39], v[192:207]
    s_add_u32 m0, s11, 78016
    s_nop 0
    buffer_load_dwordx4 v12, s[48:51], s10 offen lds
    v_mfma_f32_32x32x16_bf16 v[208:223], v[28:31], v[40:43], v[208:223]
    s_add_u32 m0, s11, 79040
    s_nop 0
    buffer_load_dwordx4 v13, s[48:51], s10 offen lds
    s_add_u32 s10, s10, 18432
    v_mfma_f32_32x32x16_bf16 v[224:239], v[32:35], v[36:39], v[224:239]
    v_mfma_f32_32x32x16_bf16 v[240:255], v[32:35], v[40:43], v[240:255]
    s_waitcnt vmcnt(6) lgkmcnt(0)
    s_barrier
    v_mfma_f32_32x32x16_bf16 v[96:111], v[44:47], v[64:67], v[96:111]
    ds_read_b128 v[36:39], v6 offset:32768
    ds_read_b128 v[40:43], v6 offset:33792
    v_mfma_f32_32x32x16_bf16 v[112:127], v[44:47], v[68:71], v[112:127]
    ds_read_b64_tr_b16 v[16:17], v3 offset:0
    ds_read_b64_tr_b16 v[18:19], v3 offset:9216
    v_mfma_f32_32x32x16_bf16 v[128:143], v[48:51], v[64:67], v[128:143]
    ds_read_b64_tr_b16 v[20:21], v5 offset:0
    ds_read_b64_tr_b16 v[22:23], v5 offset:9216
    v_mfma_f32_32x32x16_bf16 v[144:159], v[48:51], v[68:71], v[144:159]
    ds_read_b64_tr_b16 v[24:25], v3 offset:128
    ds_read_b64_tr_b16 v[26:27], v3 offset:9344
    v_mfma_f32_32x32x16_bf16 v[160:175], v[52:55], v[64:67], v[160:175]
    ds_read_b64_tr_b16 v[28:29], v5 offset:128
    ds_read_b64_tr_b16 v[30:31], v5 offset:9344
    v_mfma_f32_32x32x16_bf16 v[176:191], v[52:55], v[68:71], v[176:191]
    ds_read_b64_tr_b16 v[32:33], v3 offset:256
    ds_read_b64_tr_b16 v[34:35], v3 offset:9472
    s_add_u32 m0, s11, 95424
    s_nop 0
    buffer_load_dwordx4 v11, s[48:51], s10 offen lds
    v_mfma_f32_32x32x16_bf16 v[192:207], v[56:59], v[64:67], v[192:207]
    s_add_u32 m0, s11, 96448
    s_nop 0
    buffer_load_dwordx4 v12, s[48:51], s10 offen lds
    v_mfma_f32_32x32x16_bf16 v[208:223], v[56:59], v[68:71], v[208:223]
    s_add_u32 m0, s11, 97472
    s_nop 0
    buffer_load_dwordx4 v13, s[48:51], s10 offen lds
    s_add_u32 s10, s10, 18432
    v_mfma_f32_32x32x16_bf16 v[224:239], v[60:63], v[64:67], v[224:239]
    v_mfma_f32_32x32x16_bf16 v[240:255], v[60:63], v[68:71], v[240:255]
    s_waitcnt vmcnt(6) lgkmcnt(0)
    s_barrier
    v_mfma_f32_32x32x16_bf16 v[96:111], v[16:19], v[36:39], v[96:111]
    ds_read_b128 v[64:67], v7 offset:0
    ds_read_b128 v[68:71], v7 offset:1024
    v_mfma_f32_32x32x16_bf16 v[112:127], v[16:19], v[40:43], v[112:127]
    ds_read_b64_tr_b16 v[44:45], v3 offset:18432
    ds_read_b64_tr_b16 v[46:47], v3 offset:27648
    v_mfma_f32_32x32x16_bf16 v[128:143], v[20:23], v[36:39], v[128:143]
    ds_read_b64_tr_b16 v[48:49], v5 offset:18432
    ds_read_b64_tr_b16 v[50:51], v5 offset:27648
    v_mfma_f32_32x32x16_bf16 v[144:159], v[20:23], v[40:43], v[144:159]
    ds_read_b64_tr_b16 v[52:53], v3 offset:18560
    ds_read_b64_tr_b16 v[54:55], v3 offset:27776
    v_mfma_f32_32x32x16_bf16 v[160:175], v[24:27], v[36:39], v[160:175]
    ds_read_b64_tr_b16 v[56:57], v5 offset:18560
    ds_read_b64_tr_b16 v[58:59], v5 offset:27776
    v_mfma_f32_32x32x16_bf16 v[176:191], v[24:27], v[40:43], v[176:191]
    ds_read_b64_tr_b16 v[60:61], v3 offset:18688
    ds_read_b64_tr_b16 v[62:63], v3 offset:27904
    s_add_u32 m0, s11, 113856
    s_nop 0
    buffer_load_dwordx4 v11, s[48:51], s10 offen lds
    v_mfma_f32_32x32x16_bf16 v[192:207], v[28:31], v[36:39], v[192:207]
    s_add_u32 m0, s11, 114880
    s_nop 0
    buffer_load_dwordx4 v12, s[48:51], s10 offen lds
    v_mfma_f32_32x32x16_bf16 v[208:223], v[28:31], v[40:43], v[208:223]
    s_add_u32 m0, s11, 115904
    s_nop 0
    buffer_load_dwordx4 v13, s[48:51], s10 offen lds
    s_add_u32 s10, s10, 18432
    v_mfma_f32_32x32x16_bf16 v[224:239], v[32:35], v[36:39], v[224:239]
    v_mfma_f32_32x32x16_bf16 v[240:255], v[32:35], v[40:43], v[240:255]
    s_waitcnt vmcnt(6) lgkmcnt(0)
    s_barrier
    v_mfma_f32_32x32x16_bf16 v[96:111], v[44:47], v[64:67], v[96:111]
    ds_read_b128 v[36:39], v7 offset:4096
    ds_read_b128 v[40:43], v7 offset:5120
    v_mfma_f32_32x32x16_bf16 v[112:127], v[44:47], v[68:71], v[112:127]
    ds_read_b64_tr_b16 v[16:17], v2 offset:0
    ds_read_b64_tr_b16 v[18:19], v2 offset:9216
    v_mfma_f32_32x32x16_bf16 v[128:143], v[48:51], v[64:67], v[128:143]
    ds_read_b64_tr_b16 v[20:21], v4 offset:0
    ds_read_b64_tr_b16 v[22:23], v4 offset:9216
    v_mfma_f32_32x32x16_bf16 v[144:159], v[48:51], v[68:71], v[144:159]
    ds_read_b64_tr_b16 v[24:25], v2 offset:128
    ds_read_b64_tr_b16 v[26:27], v2 offset:9344
    v_mfma_f32_32x32x16_bf16 v[160:175], v[52:55], v[64:67], v[160:175]
    ds_read_b64_tr_b16 v[28:29], v4 offset:128
    ds_read_b64_tr_b16 v[30:31], v4 offset:9344
    v_mfma_f32_32x32x16_bf16 v[176:191], v[52:55], v[68:71], v[176:191]
    ds_read_b64_tr_b16 v[32:33], v2 offset:256
    ds_read_b64_tr_b16 v[34:35], v2 offset:9472
    s_add_u32 m0, s11, 132288
    s_nop 0
    buffer_load_dwordx4 v11, s[48:51], s10 offen lds
    v_mfma_f32_32x32x16_bf16 v[192:207], v[56:59], v[64:67], v[192:207]
    s_add_u32 m0, s11, 133312
    s_nop 0
    buffer_load_dwordx4 v12, s[48:51], s10 offen lds
    v_mfma_f32_32x32x16_bf16 v[208:223], v[56:59], v[68:71], v[208:223]
    s_add_u32 m0, s11, 134336
    s_nop 0
    buffer_load_dwordx4 v13, s[48:51], s10 offen lds
    s_add_u32 s10, s10, 18432
    v_mfma_f32_32x32x16_bf16 v[224:239], v[60:63], v[64:67], v[224:239]
    v_mfma_f32_32x32x16_bf16 v[240:255], v[60:63], v[68:71], v[240:255]
    s_waitcnt vmcnt(6) lgkmcnt(0)
    s_barrier
    v_mfma_f32_32x32x16_bf16 v[96:111], v[16:19], v[36:39], v[96:111]
    ds_read_b128 v[64:67], v7 offset:8192
    ds_read_b128 v[68:71], v7 offset:9216
    v_mfma_f32_32x32x16_bf16 v[112:127], v[16:19], v[40:43], v[112:127]
    ds_read_b64_tr_b16 v[44:45], v2 offset:18432
    ds_read_b64_tr_b16 v[46:47], v2 offset:27648
    v_mfma_f32_32x32x16_bf16 v[128:143], v[20:23], v[36:39], v[128:143]
    ds_read_b64_tr_b16 v[48:49], v4 offset:18432
    ds_read_b64_tr_b16 v[50:51], v4 offset:27648
    v_mfma_f32_32x32x16_bf16 v[144:159], v[20:23], v[40:43], v[144:159]
    ds_read_b64_tr_b16 v[52:53], v2 offset:18560
    ds_read_b64_tr_b16 v[54:55], v2 offset:27776
    v_mfma_f32_32x32x16_bf16 v[160:175], v[24:27], v[36:39], v[160:175]
    ds_read_b64_tr_b16 v[56:57], v4 offset:18560
    ds_read_b64_tr_b16 v[58:59], v4 offset:27776
    v_mfma_f32_32x32x16_bf16 v[176:191], v[24:27], v[40:43], v[176:191]
    ds_read_b64_tr_b16 v[60:61], v2 offset:18688
    ds_read_b64_tr_b16 v[62:63], v2 offset:27904
    s_add_u32 m0, s11, 76992
    s_nop 0
    buffer_load_dwordx4 v11, s[48:51], s10 offen lds
    v_mfma_f32_32x32x16_bf16 v[192:207], v[28:31], v[36:39], v[192:207]
    s_add_u32 m0, s11, 78016
    s_nop 0
    buffer_load_dwordx4 v12, s[48:51], s10 offen lds
    v_mfma_f32_32x32x16_bf16 v[208:223], v[28:31], v[40:43], v[208:223]
    s_add_u32 m0, s11, 79040
    s_nop 0
    buffer_load_dwordx4 v13, s[48:51], s10 offen lds
    s_add_u32 s10, s10, 18432
    v_mfma_f32_32x32x16_bf16 v[224:239], v[32:35], v[36:39], v[224:239]
    v_mfma_f32_32x32x16_bf16 v[240:255], v[32:35], v[40:43], v[240:255]
    s_waitcnt vmcnt(6) lgkmcnt(0)
    s_barrier
    v_mfma_f32_32x32x16_bf16 v[96:111], v[44:47], v[64:67], v[96:111]
    ds_read_b128 v[36:39], v7 offset:12288
    ds_read_b128 v[40:43], v7 offset:13312
    v_mfma_f32_32x32x16_bf16 v[112:127], v[44:47], v[68:71], v[112:127]
    ds_read_b64_tr_b16 v[16:17], v3 offset:0
    ds_read_b64_tr_b16 v[18:19], v3 offset:9216
    v_mfma_f32_32x32x16_bf16 v[128:143], v[48:51], v[64:67], v[128:143]
    ds_read_b64_tr_b16 v[20:21], v5 offset:0
    ds_read_b64_tr_b16 v[22:23], v5 offset:9216
    v_mfma_f32_32x32x16_bf16 v[144:159], v[48:51], v[68:71], v[144:159]
    ds_read_b64_tr_b16 v[24:25], v3 offset:128
    ds_read_b64_tr_b16 v[26:27], v3 offset:9344
    v_mfma_f32_32x32x16_bf16 v[160:175], v[52:55], v[64:67], v[160:175]
    ds_read_b64_tr_b16 v[28:29], v5 offset:128
    ds_read_b64_tr_b16 v[30:31], v5 offset:9344
    v_mfma_f32_32x32x16_bf16 v[176:191], v[52:55], v[68:71], v[176:191]
    ds_read_b64_tr_b16 v[32:33], v3 offset:256
    ds_read_b64_tr_b16 v[34:35], v3 offset:9472
    s_add_u32 m0, s11, 95424
    s_nop 0
    buffer_load_dwordx4 v11, s[48:51], s10 offen lds
    v_mfma_f32_32x32x16_bf16 v[192:207], v[56:59], v[64:67], v[192:207]
    s_add_u32 m0, s11, 96448
    s_nop 0
    buffer_load_dwordx4 v12, s[48:51], s10 offen lds
    v_mfma_f32_32x32x16_bf16 v[208:223], v[56:59], v[68:71], v[208:223]
    s_add_u32 m0, s11, 97472
    s_nop 0
    buffer_load_dwordx4 v13, s[48:51], s10 offen lds
    s_add_u32 s10, s10, 18432
    v_mfma_f32_32x32x16_bf16 v[224:239], v[60:63], v[64:67], v[224:239]
    v_mfma_f32_32x32x16_bf16 v[240:255], v[60:63], v[68:71], v[240:255]
    s_waitcnt vmcnt(6) lgkmcnt(0)
    s_barrier
    v_mfma_f32_32x32x16_bf16 v[96:111], v[16:19], v[36:39], v[96:111]
    ds_read_b128 v[64:67], v7 offset:16384
    ds_read_b128 v[68:71], v7 offset:17408
    v_mfma_f32_32x32x16_bf16 v[112:127], v[16:19], v[40:43], v[112:127]
    ds_read_b64_tr_b16 v[44:45], v3 offset:18432
    ds_read_b64_tr_b16 v[46:47], v3 offset:27648
    v_mfma_f32_32x32x16_bf16 v[128:143], v[20:23], v[36:39], v[128:143]
    ds_read_b64_tr_b16 v[48:49], v5 offset:18432
    ds_read_b64_tr_b16 v[50:51], v5 offset:27648
    v_mfma_f32_32x32x16_bf16 v[144:159], v[20:23], v[40:43], v[144:159]
    ds_read_b64_tr_b16 v[52:53], v3 offset:18560
    ds_read_b64_tr_b16 v[54:55], v3 offset:27776
    v_mfma_f32_32x32x16_bf16 v[160:175], v[24:27], v[36:39], v[160:175]
    ds_read_b64_tr_b16 v[56:57], v5 offset:18560
    ds_read_b64_tr_b16 v[58:59], v5 offset:27776
    v_mfma_f32_32x32x16_bf16 v[176:191], v[24:27], v[40:43], v[176:191]
    ds_read_b64_tr_b16 v[60:61], v3 offset:18688
    ds_read_b64_tr_b16 v[62:63], v3 offset:27904
    s_add_u32 m0, s11, 113856
    s_nop 0
    buffer_load_dwordx4 v11, s[48:51], s10 offen lds
    v_mfma_f32_32x32x16_bf16 v[192:207], v[28:31], v[36:39], v[192:207]
    s_add_u32 m0, s11, 114880
    s_nop 0
    buffer_load_dwordx4 v12, s[48:51], s10 offen lds
    v_mfma_f32_32x32x16_bf16 v[208:223], v[28:31], v[40:43], v[208:223]
    s_add_u32 m0, s11, 115904
    s_nop 0
    buffer_load_dwordx4 v13, s[48:51], s10 offen lds
    s_add_u32 s10, s10, 18432
    v_mfma_f32_32x32x16_bf16 v[224:239], v[32:35], v[36:39], v[224:239]
    v_mfma_f32_32x32x16_bf16 v[240:255], v[32:35], v[40:43], v[240:255]
    s_waitcnt vmcnt(6) lgkmcnt(0)
    s_barrier
    v_mfma_f32_32x32x16_bf16 v[96:111], v[44:47], v[64:67], v[96:111]
    ds_read_b128 v[36:39], v7 offset:20480
    ds_read_b128 v[40:43], v7 offset:21504
    v_mfma_f32_32x32x16_bf16 v[112:127], v[44:47], v[68:71], v[112:127]
    ds_read_b64_tr_b16 v[16:17], v2 offset:0
    ds_read_b64_tr_b16 v[18:19], v2 offset:9216
    v_mfma_f32_32x32x16_bf16 v[128:143], v[48:51], v[64:67], v[128:143]
    ds_read_b64_tr_b16 v[20:21], v4 offset:0
    ds_read_b64_tr_b16 v[22:23], v4 offset:9216
    v_mfma_f32_32x32x16_bf16 v[144:159], v[48:51], v[68:71], v[144:159]
    ds_read_b64_tr_b16 v[24:25], v2 offset:128
    ds_read_b64_tr_b16 v[26:27], v2 offset:9344
    v_mfma_f32_32x32x16_bf16 v[160:175], v[52:55], v[64:67], v[160:175]
    ds_read_b64_tr_b16 v[28:29], v4 offset:128
    ds_read_b64_tr_b16 v[30:31], v4 offset:9344
    v_mfma_f32_32x32x16_bf16 v[176:191], v[52:55], v[68:71], v[176:191]
    ds_read_b64_tr_b16 v[32:33], v2 offset:256
    ds_read_b64_tr_b16 v[34:35], v2 offset:9472
    s_add_u32 m0, s11, 132288
    s_nop 0
    buffer_load_dwordx4 v11, s[48:51], s10 offen lds
    v_mfma_f32_32x32x16_bf16 v[192:207], v[56:59], v[64:67], v[192:207]
    s_add_u32 m0, s11, 133312
    s_nop 0
    buffer_load_dwordx4 v12, s[48:51], s10 offen lds
    v_mfma_f32_32x32x16_bf16 v[208:223], v[56:59], v[68:71], v[208:223]
    s_add_u32 m0, s11, 134336
    s_nop 0
    buffer_load_dwordx4 v13, s[48:51], s10 offen lds
    s_add_u32 s10, s10, 18432
    v_mfma_f32_32x32x16_bf16 v[224:239], v[60:63], v[64:67], v[224:239]
    v_mfma_f32_32x32x16_bf16 v[240:255], v[60:63], v[68:71], v[240:255]
    s_waitcnt vmcnt(6) lgkmcnt(0)
    s_barrier
    v_mfma_f32_32x32x16_bf16 v[96:111], v[16:19], v[36:39], v[96:111]
    ds_read_b128 v[64:67], v7 offset:24576
    ds_read_b128 v[68:71], v7 offset:25600
    v_mfma_f32_32x32x16_bf16 v[112:127], v[16:19], v[40:43], v[112:127]
    ds_read_b64_tr_b16 v[44:45], v2 offset:18432
    ds_read_b64_tr_b16 v[46:47], v2 offset:27648
    v_mfma_f32_32x32x16_bf16 v[128:143], v[20:23], v[36:39], v[128:143]
    ds_read_b64_tr_b16 v[48:49], v4 offset:18432
    ds_read_b64_tr_b16 v[50:51], v4 offset:27648
    v_mfma_f32_32x32x16_bf16 v[144:159], v[20:23], v[40:43], v[144:159]
    ds_read_b64_tr_b16 v[52:53], v2 offset:18560
    ds_read_b64_tr_b16 v[54:55], v2 offset:27776
    v_mfma_f32_32x32x16_bf16 v[160:175], v[24:27], v[36:39], v[160:175]
    ds_read_b64_tr_b16 v[56:57], v4 offset:18560
    ds_read_b64_tr_b16 v[58:59], v4 offset:27776
    v_mfma_f32_32x32x16_bf16 v[176:191], v[24:27], v[40:43], v[176:191]
    ds_read_b64_tr_b16 v[60:61], v2 offset:18688
    ds_read_b64_tr_b16 v[62:63], v2 offset:27904
    s_add_u32 m0, s58, 73728
    s_add_u32 s57, s59, 73728
    buffer_load_dwordx4 v1, s[44:47], s57 offen sc1 lds
    v_mfma_f32_32x32x16_bf16 v[192:207], v[28:31], v[36:39], v[192:207]
    s_add_u32 m0, s58, 79872
    s_add_u32 s57, s59, 79872
    buffer_load_dwordx4 v1, s[44:47], s57 offen sc1 lds
    v_mfma_f32_32x32x16_bf16 v[208:223], v[28:31], v[40:43], v[208:223]
    s_add_u32 m0, s58, 86016
    s_add_u32 s57, s59, 86016
    buffer_load_dwordx4 v1, s[44:47], s57 offen sc1 lds
    v_mfma_f32_32x32x16_bf16 v[224:239], v[32:35], v[36:39], v[224:239]
    v_mfma_f32_32x32x16_bf16 v[240:255], v[32:35], v[40:43], v[240:255]
    s_waitcnt vmcnt(6) lgkmcnt(0)
    s_barrier
    v_mfma_f32_32x32x16_bf16 v[96:111], v[44:47], v[64:67], v[96:111]
    ds_read_b128 v[36:39], v7 offset:28672
    ds_read_b128 v[40:43], v7 offset:29696
    v_mfma_f32_32x32x16_bf16 v[112:127], v[44:47], v[68:71], v[112:127]
    ds_read_b64_tr_b16 v[16:17], v3 offset:0
    ds_read_b64_tr_b16 v[18:19], v3 offset:9216
    v_mfma_f32_32x32x16_bf16 v[128:143], v[48:51], v[64:67], v[128:143]
    ds_read_b64_tr_b16 v[20:21], v5 offset:0
    ds_read_b64_tr_b16 v[22:23], v5 offset:9216
    v_mfma_f32_32x32x16_bf16 v[144:159], v[48:51], v[68:71], v[144:159]
    ds_read_b64_tr_b16 v[24:25], v3 offset:128
    ds_read_b64_tr_b16 v[26:27], v3 offset:9344
    v_mfma_f32_32x32x16_bf16 v[160:175], v[52:55], v[64:67], v[160:175]
    ds_read_b64_tr_b16 v[28:29], v5 offset:128
    ds_read_b64_tr_b16 v[30:31], v5 offset:9344
    v_mfma_f32_32x32x16_bf16 v[176:191], v[52:55], v[68:71], v[176:191]
    ds_read_b64_tr_b16 v[32:33], v3 offset:256
    ds_read_b64_tr_b16 v[34:35], v3 offset:9472
    s_add_u32 m0, s58, 92160
    s_add_u32 s57, s59, 92160
    buffer_load_dwordx4 v1, s[44:47], s57 offen sc1 lds
    v_mfma_f32_32x32x16_bf16 v[192:207], v[56:59], v[64:67], v[192:207]
    s_add_u32 m0, s58, 98304
    s_add_u32 s57, s59, 98304
    buffer_load_dwordx4 v1, s[44:47], s57 offen sc1 lds
    v_mfma_f32_32x32x16_bf16 v[208:223], v[56:59], v[68:71], v[208:223]
    s_add_u32 m0, s58, 104448
    s_add_u32 s57, s59, 104448
    buffer_load_dwordx4 v1, s[44:47], s57 offen sc1 lds
    v_mfma_f32_32x32x16_bf16 v[224:239], v[60:63], v[64:67], v[224:239]
    v_mfma_f32_32x32x16_bf16 v[240:255], v[60:63], v[68:71], v[240:255]
    s_waitcnt vmcnt(6) lgkmcnt(0)
    s_barrier
    v_mfma_f32_32x32x16_bf16 v[96:111], v[16:19], v[36:39], v[96:111]
    ds_read_b128 v[64:67], v7 offset:32768
    ds_read_b128 v[68:71], v7 offset:33792
    v_mfma_f32_32x32x16_bf16 v[112:127], v[16:19], v[40:43], v[112:127]
    ds_read_b64_tr_b16 v[44:45], v3 offset:18432
    ds_read_b64_tr_b16 v[46:47], v3 offset:27648
    v_mfma_f32_32x32x16_bf16 v[128:143], v[20:23], v[36:39], v[128:143]
    ds_read_b64_tr_b16 v[48:49], v5 offset:18432
    ds_read_b64_tr_b16 v[50:51], v5 offset:27648
    v_mfma_f32_32x32x16_bf16 v[144:159], v[20:23], v[40:43], v[144:159]
    ds_read_b64_tr_b16 v[52:53], v3 offset:18560
    ds_read_b64_tr_b16 v[54:55], v3 offset:27776
    v_mfma_f32_32x32x16_bf16 v[160:175], v[24:27], v[36:39], v[160:175]
    ds_read_b64_tr_b16 v[56:57], v5 offset:18560
    ds_read_b64_tr_b16 v[58:59], v5 offset:27776
    v_mfma_f32_32x32x16_bf16 v[176:191], v[24:27], v[40:43], v[176:191]
    ds_read_b64_tr_b16 v[60:61], v3 offset:18688
    ds_read_b64_tr_b16 v[62:63], v3 offset:27904
    s_add_u32 m0, s58, 110592
    s_add_u32 s57, s59, 110592
    buffer_load_dwordx4 v1, s[44:47], s57 offen sc1 lds
    v_mfma_f32_32x32x16_bf16 v[192:207], v[28:31], v[36:39], v[192:207]
    s_add_u32 m0, s58, 116736
    s_add_u32 s57, s59, 116736
    buffer_load_dwordx4 v1, s[44:47], s57 offen sc1 lds
    v_mfma_f32_32x32x16_bf16 v[208:223], v[28:31], v[40:43], v[208:223]
    s_add_u32 m0, s58, 122880
    s_add_u32 s57, s59, 122880
    buffer_load_dwordx4 v1, s[44:47], s57 offen sc1 lds
    v_mfma_f32_32x32x16_bf16 v[224:239], v[32:35], v[36:39], v[224:239]
    v_mfma_f32_32x32x16_bf16 v[240:255], v[32:35], v[40:43], v[240:255]
    s_waitcnt lgkmcnt(0)
    s_barrier
    v_mfma_f32_32x32x16_bf16 v[96:111], v[44:47], v[64:67], v[96:111]
    v_mfma_f32_32x32x16_bf16 v[112:127], v[44:47], v[68:71], v[112:127]
    v_mfma_f32_32x32x16_bf16 v[128:143], v[48:51], v[64:67], v[128:143]
    v_mfma_f32_32x32x16_bf16 v[144:159], v[48:51], v[68:71], v[144:159]
    v_mfma_f32_32x32x16_bf16 v[160:175], v[52:55], v[64:67], v[160:175]
    v_mfma_f32_32x32x16_bf16 v[176:191], v[52:55], v[68:71], v[176:191]
    s_add_u32 m0, s58, 129024
    s_add_u32 s57, s59, 129024
    buffer_load_dwordx4 v1, s[44:47], s57 offen sc1 lds
    v_mfma_f32_32x32x16_bf16 v[192:207], v[56:59], v[64:67], v[192:207]
    s_add_u32 m0, s58, 135168
    s_add_u32 s57, s59, 135168
    buffer_load_dwordx4 v1, s[44:47], s57 offen sc1 lds
    v_mfma_f32_32x32x16_bf16 v[208:223], v[56:59], v[68:71], v[208:223]
    s_add_u32 m0, s58, 141312
    s_add_u32 s57, s59, 141312
    buffer_load_dwordx4 v1, s[44:47], s57 offen sc1 lds
    v_mfma_f32_32x32x16_bf16 v[224:239], v[60:63], v[64:67], v[224:239]
    s_add_u32 m0, s58, 147456
    s_add_u32 s57, s59, 147456
    buffer_load_dwordx4 v1, s[44:47], s57 offen sc1 lds
    v_mfma_f32_32x32x16_bf16 v[240:255], v[60:63], v[68:71], v[240:255]
    s_branch ATT
G2_4D:
    s_waitcnt vmcnt(9) lgkmcnt(0)
    s_barrier
    ds_read_b128 v[36:39], v6 offset:0
    ds_read_b128 v[40:43], v6 offset:1024
    ds_read_b64_tr_b16 v[16:17], v3 offset:0
    ds_read_b64_tr_b16 v[18:19], v3 offset:9216
    ds_read_b64_tr_b16 v[20:21], v5 offset:0
    ds_read_b64_tr_b16 v[22:23], v5 offset:9216
    ds_read_b64_tr_b16 v[24:25], v3 offset:128
    ds_read_b64_tr_b16 v[26:27], v3 offset:9344
    ds_read_b64_tr_b16 v[28:29], v5 offset:128
    ds_read_b64_tr_b16 v[30:31], v5 offset:9344
    ds_read_b128 v[88:91], v14
    ds_read_b32 v92, v15
    s_lshl_b32 s58, s3, 10
    s_add_u32 s59, s58, 2359296
    s_waitcnt vmcnt(6) lgkmcnt(0)
    s_barrier
    v_mfma_f32_32x32x16_bf16 v[96:111], v[16:19], v[36:39], 0
    ds_read_b128 v[64:67], v6 offset:4096
    ds_read_b128 v[68:71], v6 offset:5120
    v_mfma_f32_32x32x16_bf16 v[112:127], v[16:19], v[40:43], 0
    ds_read_b64_tr_b16 v[44:45], v3 offset:18432
    ds_read_b64_tr_b16 v[46:47], v3 offset:27648
    v_mfma_f32_32x32x16_bf16 v[128:143], v[20:23], v[36:39], 0
    ds_read_b64_tr_b16 v[48:49], v5 offset:18432
    ds_read_b64_tr_b16 v[50:51], v5 offset:27648
    v_mfma_f32_32x32x16_bf16 v[144:159], v[20:23], v[40:43], 0
    ds_read_b64_tr_b16 v[52:53], v3 offset:18560
    ds_read_b64_tr_b16 v[54:55], v3 offset:27776
    v_mfma_f32_32x32x16_bf16 v[160:175], v[24:27], v[36:39], 0
    ds_read_b64_tr_b16 v[56:57], v5 offset:18560
    ds_read_b64_tr_b16 v[58:59], v5 offset:27776
    v_mfma_f32_32x32x16_bf16 v[176:191], v[24:27], v[40:43], 0
    s_add_u32 m0, s11, 113856
    s_nop 0
    buffer_load_dwordx4 v11, s[48:51], s10 offen lds
    v_mfma_f32_32x32x16_bf16 v[192:207], v[28:31], v[36:39], 0
    s_add_u32 m0, s11, 114880
    s_nop 0
    buffer_load_dwordx4 v12, s[48:51], s10 offen lds
    v_mfma_f32_32x32x16_bf16 v[208:223], v[28:31], v[40:43], 0
    s_add_u32 m0, s11, 115904
    s_nop 0
    buffer_load_dwordx4 v13, s[48:51], s10 offen lds
    s_add_u32 s10, s10, 18432
    s_waitcnt vmcnt(6) lgkmcnt(0)
    s_barrier
    v_mfma_f32_32x32x16_bf16 v[96:111], v[44:47], v[64:67], v[96:111]
    ds_read_b128 v[36:39], v6 offset:8192
    ds_read_b128 v[40:43], v6 offset:9216
    v_mfma_f32_32x32x16_bf16 v[112:127], v[44:47], v[68:71], v[112:127]
    ds_read_b64_tr_b16 v[16:17], v2 offset:0
    ds_read_b64_tr_b16 v[18:19], v2 offset:9216
    v_mfma_f32_32x32x16_bf16 v[128:143], v[48:51], v[64:67], v[128:143]
    ds_read_b64_tr_b16 v[20:21], v4 offset:0
    ds_read_b64_tr_b16 v[22:23], v4 offset:9216
    v_mfma_f32_32x32x16_bf16 v[144:159], v[48:51], v[68:71], v[144:159]
    ds_read_b64_tr_b16 v[24:25], v2 offset:128
    ds_read_b64_tr_b16 v[26:27], v2 offset:9344
    v_mfma_f32_32x32x16_bf16 v[160:175], v[52:55], v[64:67], v[160:175]
    ds_read_b64_tr_b16 v[28:29], v4 offset:128
    ds_read_b64_tr_b16 v[30:31], v4 offset:9344
    v_mfma_f32_32x32x16_bf16 v[176:191], v[52:55], v[68:71], v[176:191]
    s_add_u32 m0, s11, 132288
    s_nop 0
    buffer_load_dwordx4 v11, s[48:51], s10 offen lds
    v_mfma_f32_32x32x16_bf16 v[192:207], v[56:59], v[64:67], v[192:207]
    s_add_u32 m0, s11, 133312
    s_nop 0
    buffer_load_dwordx4 v12, s[48:51], s10 offen lds
    v_mfma_f32_32x32x16_bf16 v[208:223], v[56:59], v[68:71], v[208:223]
    s_add_u32 m0, s11, 134336
    s_nop 0
    buffer_load_dwordx4 v13, s[48:51], s10 offen lds
    s_add_u32 s10, s10, 18432
    s_waitcnt vmcnt(6) lgkmcnt(0)
    s_barrier
    v_mfma_f32_32x32x16_bf16 v[96:111], v[16:19], v[36:39], v[96:111]
    ds_read_b128 v[64:67], v6 offset:12288
    ds_read_b128 v[68:71], v6 offset:13312
    v_mfma_f32_32x32x16_bf16 v[112:127], v[16:19], v[40:43], v[112:127]
    ds_read_b64_tr_b16 v[44:45], v2 offset:18432
    ds_read_b64_tr_b16 v[46:47], v2 offset:27648
    v_mfma_f32_32x32x16_bf16 v[128:143], v[20:23], v[36:39], v[128:143]
    ds_read_b64_tr_b16 v[48:49], v4 offset:18432
    ds_read_b64_tr_b16 v[50:51], v4 offset:27648
    v_mfma_f32_32x32x16_bf16 v[144:159], v[20:23], v[40:43], v[144:159]
    ds_read_b64_tr_b16 v[52:53], v2 offset:18560
    ds_read_b64_tr_b16 v[54:55], v2 offset:27776
    v_mfma_f32_32x32x16_bf16 v[160:175], v[24:27], v[36:39], v[160:175]
    ds_read_b64_tr_b16 v[56:57], v4 offset:18560
    ds_read_b64_tr_b16 v[58:59], v4 offset:27776
    v_mfma_f32_32x32x16_bf16 v[176:191], v[24:27], v[40:43], v[176:191]
    s_add_u32 m0, s11, 76992
    s_nop 0
    buffer_load_dwordx4 v11, s[48:51], s10 offen lds
    v_mfma_f32_32x32x16_bf16 v[192:207], v[28:31], v[36:39], v[192:207]
    s_add_u32 m0, s11, 78016
    s_nop 0
    buffer_load_dwordx4 v12, s[48:51], s10 offen lds
    v_mfma_f32_32x32x16_bf16 v[208:223], v[28:31], v[40:43], v[208:223]
    s_add_u32 m0, s11, 79040
    s_nop 0
    buffer_load_dwordx4 v13, s[48:51], s10 offen lds
    s_add_u32 s10, s10, 18432
    s_waitcnt vmcnt(6) lgkmcnt(0)
    s_barrier
    v_mfma_f32_32x32x16_bf16 v[96:111], v[44:47], v[64:67], v[96:111]
    ds_read_b128 v[36:39], v6 offset:16384
    ds_read_b128 v[40:43], v6 offset:17408
    v_mfma_f32_32x32x16_bf16 v[112:127], v[44:47], v[68:71], v[112:127]
    ds_read_b64_tr_b16 v[16:17], v3 offset:0
    ds_read_b64_tr_b16 v[18:19], v3 offset:9216
    v_mfma_f32_32x32x16_bf16 v[128:143], v[48:51], v[64:67], v[128:143]
    ds_read_b64_tr_b16 v[20:21], v5 offset:0
    ds_read_b64_tr_b16 v[22:23], v5 offset:9216
    v_mfma_f32_32x32x16_bf16 v[144:159], v[48:51], v[68:71], v[144:159]
    ds_read_b64_tr_b16 v[24:25], v3 offset:128
    ds_read_b64_tr_b16 v[26:27], v3 offset:9344
    v_mfma_f32_32x32x16_bf16 v[160:175], v[52:55], v[64:67], v[160:175]
    ds_read_b64_tr_b16 v[28:29], v5 offset:128
    ds_read_b64_tr_b16 v[30:31], v5 offset:9344
    v_mfma_f32_32x32x16_bf16 v[176:191], v[52:55], v[68:71], v[176:191]
    s_add_u32 m0, s11, 95424
    s_nop 0
    buffer_load_dwordx4 v11, s[48:51], s10 offen lds
    v_mfma_f32_32x32x16_bf16 v[192:207], v[56:59], v[64:67], v[192:207]
    s_add_u32 m0, s11, 96448
    s_nop 0
    buffer_load_dwordx4 v12, s[48:51], s10 offen lds
    v_mfma_f32_32x32x16_bf16 v[208:223], v[56:59], v[68:71], v[208:223]
    s_add_u32 m0, s11, 97472
    s_nop 0
    buffer_load_dwordx4 v13, s[48:51], s10 offen lds
    s_add_u32 s10, s10, 18432
    s_waitcnt vmcnt(6) lgkmcnt(0)
    s_barrier
    v_mfma_f32_32x32x16_bf16 v[96:111], v[16:19], v[36:39], v[96:111]
    ds_read_b128 v[64:67], v6 offset:20480
    ds_read_b128 v[68:71], v6 offset:21504
    v_mfma_f32_32x32x16_bf16 v[112:127], v[16:19], v[40:43], v[112:127]
    ds_read_b64_tr_b16 v[44:45], v3 offset:18432
    ds_read_b64_tr_b16 v[46:47], v3 offset:27648
    v_mfma_f32_32x32x16_bf16 v[128:143], v[20:23], v[36:39], v[128:143]
    ds_read_b64_tr_b16 v[48:49], v5 offset:18432
    ds_read_b64_tr_b16 v[50:51], v5 offset:27648
    v_mfma_f32_32x32x16_bf16 v[144:159], v[20:23], v[40:43], v[144:159]
    ds_read_b64_tr_b16 v[52:53], v3 offset:18560
    ds_read_b64_tr_b16 v[54:55], v3 offset:27776
    v_mfma_f32_32x32x16_bf16 v[160:175], v[24:27], v[36:39], v[160:175]
    ds_read_b64_tr_b16 v[56:57], v5 offset:18560
    ds_read_b64_tr_b16 v[58:59], v5 offset:27776
    v_mfma_f32_32x32x16_bf16 v[176:191], v[24:27], v[40:43], v[176:191]
    s_add_u32 m0, s11, 113856
    s_nop 0
    buffer_load_dwordx4 v11, s[48:51], s10 offen lds
    v_mfma_f32_32x32x16_bf16 v[192:207], v[28:31], v[36:39], v[192:207]
    s_add_u32 m0, s11, 114880
    s_nop 0
    buffer_load_dwordx4 v12, s[48:51], s10 offen lds
    v_mfma_f32_32x32x16_bf16 v[208:223], v[28:31], v[40:43], v[208:223]
    s_add_u32 m0, s11, 115904
    s_nop 0
    buffer_load_dwordx4 v13, s[48:51], s10 offen lds
    s_add_u32 s10, s10, 18432
    s_waitcnt vmcnt(6) lgkmcnt(0)
    s_barrier
    v_mfma_f32_32x32x16_bf16 v[96:111], v[44:47], v[64:67], v[96:111]
    ds_read_b128 v[36:39], v6 offset:24576
    ds_read_b128 v[40:43], v6 offset:25600
    v_mfma_f32_32x32x16_bf16 v[112:127], v[44:47], v[68:71], v[112:127]
    ds_read_b64_tr_b16 v[16:17], v2 offset:0
    ds_read_b64_tr_b16 v[18:19], v2 offset:9216
    v_mfma_f32_32x32x16_bf16 v[128:143], v[48:51], v[64:67], v[128:143]
    ds_read_b64_tr_b16 v[20:21], v4 offset:0
    ds_read_b64_tr_b16 v[22:23], v4 offset:9216
    v_mfma_f32_32x32x16_bf16 v[144:159], v[48:51], v[68:71], v[144:159]
    ds_read_b64_tr_b16 v[24:25], v2 offset:128
    ds_read_b64_tr_b16 v[26:27], v2 offset:9344
    v_mfma_f32_32x32x16_bf16 v[160:175], v[52:55], v[64:67], v[160:175]
    ds_read_b64_tr_b16 v[28:29], v4 offset:128
    ds_read_b64_tr_b16 v[30:31], v4 offset:9344
    v_mfma_f32_32x32x16_bf16 v[176:191], v[52:55], v[68:71], v[176:191]
    s_add_u32 m0, s11, 132288
    s_nop 0
    buffer_load_dwordx4 v11, s[48:51], s10 offen lds
    v_mfma_f32_32x32x16_bf16 v[192:207], v[56:59], v[64:67], v[192:207]
    s_add_u32 m0, s11, 133312
    s_nop 0
    buffer_load_dwordx4 v12, s[48:51], s10 offen lds
    v_mfma_f32_32x32x16_bf16 v[208:223], v[56:59], v[68:71], v[208:223]
    s_add_u32 m0, s11, 134336
    s_nop 0
    buffer_load_dwordx4 v13, s[48:51], s10 offen lds
    s_add_u32 s10, s10, 18432
    s_waitcnt vmcnt(6) lgkmcnt(0)
    s_barrier
    v_mfma_f32_32x32x16_bf16 v[96:111], v[16:19], v[36:39], v[96:111]
    ds_read_b128 v[64:67], v6 offset:28672
    ds_read_b128 v[68:71], v6 offset:29696
    v_mfma_f32_32x32x16_bf16 v[112:127], v[16:19], v[40:43], v[112:127]
    ds_read_b64_tr_b16 v[44:45], v2 offset:18432
    ds_read_b64_tr_b16 v[46:47], v2 offset:27648
    v_mfma_f32_32x32x16_bf16 v[128:143], v[20:23], v[36:39], v[128:143]
    ds_read_b64_tr_b16 v[48:49], v4 offset:18432
    ds_read_b64_tr_b16 v[50:51], v4 offset:27648
    v_mfma_f32_32x32x16_bf16 v[144:159], v[20:23], v[40:43], v[144:159]
    ds_read_b64_tr_b16 v[52:53], v2 offset:18560
    ds_read_b64_tr_b16 v[54:55], v2 offset:27776
    v_mfma_f32_32x32x16_bf16 v[160:175], v[24:27], v[36:39], v[160:175]
    ds_read_b64_tr_b16 v[56:57], v4 offset:18560
    ds_read_b64_tr_b16 v[58:59], v4 offset:27776
    v_mfma_f32_32x32x16_bf16 v[176:191], v[24:27], v[40:43], v[176:191]
    s_add_u32 m0, s11, 76992
    s_nop 0
    buffer_load_dwordx4 v11, s[48:51], s10 offen lds
    v_mfma_f32_32x32x16_bf16 v[192:207], v[28:31], v[36:39], v[192:207]
    s_add_u32 m0, s11, 78016
    s_nop 0
    buffer_load_dwordx4 v12, s[48:51], s10 offen lds
    v_mfma_f32_32x32x16_bf16 v[208:223], v[28:31], v[40:43], v[208:223]
    s_add_u32 m0, s11, 79040
    s_nop 0
    buffer_load_dwordx4 v13, s[48:51], s10 offen lds
    s_add_u32 s10, s10, 18432
    s_waitcnt vmcnt(6) lgkmcnt(0)
    s_barrier
    v_mfma_f32_32x32x16_bf16 v[96:111], v[44:47], v[64:67], v[96:111]
    ds_read_b128 v[36:39], v6 offset:32768
    ds_read_b128 v[40:43], v6 offset:33792
    v_mfma_f32_32x32x16_bf16 v[112:127], v[44:47], v[68:71], v[112:127]
    ds_read_b64_tr_b16 v[16:17], v3 offset:0
    ds_read_b64_tr_b16 v[18:19], v3 offset:9216
    v_mfma_f32_32x32x16_bf16 v[128:143], v[48:51], v[64:67], v[128:143]
    ds_read_b64_tr_b16 v[20:21], v5 offset:0
    ds_read_b64_tr_b16 v[22:23], v5 offset:9216
    v_mfma_f32_32x32x16_bf16 v[144:159], v[48:51], v[68:71], v[144:159]
    ds_read_b64_tr_b16 v[24:25], v3 offset:128
    ds_read_b64_tr_b16 v[26:27], v3 offset:9344
    v_mfma_f32_32x32x16_bf16 v[160:175], v[52:55], v[64:67], v[160:175]
    ds_read_b64_tr_b16 v[28:29], v5 offset:128
    ds_read_b64_tr_b16 v[30:31], v5 offset:9344
    v_mfma_f32_32x32x16_bf16 v[176:191], v[52:55], v[68:71], v[176:191]
    s_add_u32 m0, s11, 95424
    s_nop 0
    buffer_load_dwordx4 v11, s[48:51], s10 offen lds
    v_mfma_f32_32x32x16_bf16 v[192:207], v[56:59], v[64:67], v[192:207]
    s_add_u32 m0, s11, 96448
    s_nop 0
    buffer_load_dwordx4 v12, s[48:51], s10 offen lds
    v_mfma_f32_32x32x16_bf16 v[208:223], v[56:59], v[68:71], v[208:223]
    s_add_u32 m0, s11, 97472
    s_nop 0
    buffer_load_dwordx4 v13, s[48:51], s10 offen lds
    s_add_u32 s10, s10, 18432
    s_waitcnt vmcnt(6) lgkmcnt(0)
    s_barrier
    v_mfma_f32_32x32x16_bf16 v[96:111], v[16:19], v[36:39], v[96:111]
    ds_read_b128 v[64:67], v7 offset:0
    ds_read_b128 v[68:71], v7 offset:1024
    v_mfma_f32_32x32x16_bf16 v[112:127], v[16:19], v[40:43], v[112:127]
    ds_read_b64_tr_b16 v[44:45], v3 offset:18432
    ds_read_b64_tr_b16 v[46:47], v3 offset:27648
    v_mfma_f32_32x32x16_bf16 v[128:143], v[20:23], v[36:39], v[128:143]
    ds_read_b64_tr_b16 v[48:49], v5 offset:18432
    ds_read_b64_tr_b16 v[50:51], v5 offset:27648
    v_mfma_f32_32x32x16_bf16 v[144:159], v[20:23], v[40:43], v[144:159]
    ds_read_b64_tr_b16 v[52:53], v3 offset:18560
    ds_read_b64_tr_b16 v[54:55], v3 offset:27776
    v_mfma_f32_32x32x16_bf16 v[160:175], v[24:27], v[36:39], v[160:175]
    ds_read_b64_tr_b16 v[56:57], v5 offset:18560
    ds_read_b64_tr_b16 v[58:59], v5 offset:27776
    v_mfma_f32_32x32x16_bf16 v[176:191], v[24:27], v[40:43], v[176:191]
    s_add_u32 m0, s11, 113856
    s_nop 0
    buffer_load_dwordx4 v11, s[48:51], s10 offen lds
    v_mfma_f32_32x32x16_bf16 v[192:207], v[28:31], v[36:39], v[192:207]
    s_add_u32 m0, s11, 114880
    s_nop 0
    buffer_load_dwordx4 v12, s[48:51], s10 offen lds
    v_mfma_f32_32x32x16_bf16 v[208:223], v[28:31], v[40:43], v[208:223]
    s_add_u32 m0, s11, 115904
    s_nop 0
    buffer_load_dwordx4 v13, s[48:51], s10 offen lds
    s_add_u32 s10, s10, 18432
    s_waitcnt vmcnt(6) lgkmcnt(0)
    s_barrier
    v_mfma_f32_32x32x16_bf16 v[96:111], v[44:47], v[64:67], v[96:111]
    ds_read_b128 v[36:39], v7 offset:4096
    ds_read_b128 v[40:43], v7 offset:5120
    v_mfma_f32_32x32x16_bf16 v[112:127], v[44:47], v[68:71], v[112:127]
    ds_read_b64_tr_b16 v[16:17], v2 offset:0
    ds_read_b64_tr_b16 v[18:19], v2 offset:9216
    v_mfma_f32_32x32x16_bf16 v[128:143], v[48:51], v[64:67], v[128:143]
    ds_read_b64_tr_b16 v[20:21], v4 offset:0
    ds_read_b64_tr_b16 v[22:23], v4 offset:9216
    v_mfma_f32_32x32x16_bf16 v[144:159], v[48:51], v[68:71], v[144:159]
    ds_read_b64_tr_b16 v[24:25], v2 offset:128
    ds_read_b64_tr_b16 v[26:27], v2 offset:9344
    v_mfma_f32_32x32x16_bf16 v[160:175], v[52:55], v[64:67], v[160:175]
    ds_read_b64_tr_b16 v[28:29], v4 offset:128
    ds_read_b64_tr_b16 v[30:31], v4 offset:9344
    v_mfma_f32_32x32x16_bf16 v[176:191], v[52:55], v[68:71], v[176:191]
    s_add_u32 m0, s11, 132288
    s_nop 0
    buffer_load_dwordx4 v11, s[48:51], s10 offen lds
    v_mfma_f32_32x32x16_bf16 v[192:207], v[56:59], v[64:67], v[192:207]
    s_add_u32 m0, s11, 133312
    s_nop 0
    buffer_load_dwordx4 v12, s[48:51], s10 offen lds
    v_mfma_f32_32x32x16_bf16 v[208:223], v[56:59], v[68:71], v[208:223]
    s_add_u32 m0, s11, 134336
    s_nop 0
    buffer_load_dwordx4 v13, s[48:51], s10 offen lds
    s_add_u32 s10, s10, 18432
    s_waitcnt vmcnt(6) lgkmcnt(0)
    s_barrier
    v_mfma_f32_32x32x16_bf16 v[96:111], v[16:19], v[36:39], v[96:111]
    ds_read_b128 v[64:67], v7 offset:8192
    ds_read_b128 v[68:71], v7 offset:9216
    v_mfma_f32_32x32x16_bf16 v[112:127], v[16:19], v[40:43], v[112:127]
    ds_read_b64_tr_b16 v[44:45], v2 offset:18432
    ds_read_b64_tr_b16 v[46:47], v2 offset:27648
    v_mfma_f32_32x32x16_bf16 v[128:143], v[20:23], v[36:39], v[128:143]
    ds_read_b64_tr_b16 v[48:49], v4 offset:18432
    ds_read_b64_tr_b16 v[50:51], v4 offset:27648
    v_mfma_f32_32x32x16_bf16 v[144:159], v[20:23], v[40:43], v[144:159]
    ds_read_b64_tr_b16 v[52:53], v2 offset:18560
    ds_read_b64_tr_b16 v[54:55], v2 offset:27776
    v_mfma_f32_32x32x16_bf16 v[160:175], v[24:27], v[36:39], v[160:175]
    ds_read_b64_tr_b16 v[56:57], v4 offset:18560
    ds_read_b64_tr_b16 v[58:59], v4 offset:27776
    v_mfma_f32_32x32x16_bf16 v[176:191], v[24:27], v[40:43], v[176:191]
    s_add_u32 m0, s11, 76992
    s_nop 0
    buffer_load_dwordx4 v11, s[48:51], s10 offen lds
    v_mfma_f32_32x32x16_bf16 v[192:207], v[28:31], v[36:39], v[192:207]
    s_add_u32 m0, s11, 78016
    s_nop 0
    buffer_load_dwordx4 v12, s[48:51], s10 offen lds
    v_mfma_f32_32x32x16_bf16 v[208:223], v[28:31], v[40:43], v[208:223]
    s_add_u32 m0, s11, 79040
    s_nop 0
    buffer_load_dwordx4 v13, s[48:51], s10 offen lds
    s_add_u32 s10, s10, 18432
    s_waitcnt vmcnt(6) lgkmcnt(0)
    s_barrier
    v_mfma_f32_32x32x16_bf16 v[96:111], v[44:47], v[64:67], v[96:111]
    ds_read_b128 v[36:39], v7 offset:12288
    ds_read_b128 v[40:43], v7 offset:13312
    v_mfma_f32_32x32x16_bf16 v[112:127], v[44:47], v[68:71], v[112:127]
    ds_read_b64_tr_b16 v[16:17], v3 offset:0
    ds_read_b64_tr_b16 v[18:19], v3 offset:9216
    v_mfma_f32_32x32x16_bf16 v[128:143], v[48:51], v[64:67], v[128:143]
    ds_read_b64_tr_b16 v[20:21], v5 offset:0
    ds_read_b64_tr_b16 v[22:23], v5 offset:9216
    v_mfma_f32_32x32x16_bf16 v[144:159], v[48:51], v[68:71], v[144:159]
    ds_read_b64_tr_b16 v[24:25], v3 offset:128
    ds_read_b64_tr_b16 v[26:27], v3 offset:9344
    v_mfma_f32_32x32x16_bf16 v[160:175], v[52:55], v[64:67], v[160:175]
    ds_read_b64_tr_b16 v[28:29], v5 offset:128
    ds_read_b64_tr_b16 v[30:31], v5 offset:9344
    v_mfma_f32_32x32x16_bf16 v[176:191], v[52:55], v[68:71], v[176:191]
    s_add_u32 m0, s11, 95424
    s_nop 0
    buffer_load_dwordx4 v11, s[48:51], s10 offen lds
    v_mfma_f32_32x32x16_bf16 v[192:207], v[56:59], v[64:67], v[192:207]
    s_add_u32 m0, s11, 96448
    s_nop 0
    buffer_load_dwordx4 v12, s[48:51], s10 offen lds
    v_mfma_f32_32x32x16_bf16 v[208:223], v[56:59], v[68:71], v[208:223]
    s_add_u32 m0, s11, 97472
    s_nop 0
    buffer_load_dwordx4 v13, s[48:51], s10 offen lds
    s_add_u32 s10, s10, 18432
    s_waitcnt vmcnt(6) lgkmcnt(0)
    s_barrier
    v_mfma_f32_32x32x16_bf16 v[96:111], v[16:19], v[36:39], v[96:111]
    ds_read_b128 v[64:67], v7 offset:16384
    ds_read_b128 v[68:71], v7 offset:17408
    v_mfma_f32_32x32x16_bf16 v[112:127], v[16:19], v[40:43], v[112:127]
    ds_read_b64_tr_b16 v[44:45], v3 offset:18432
    ds_read_b64_tr_b16 v[46:47], v3 offset:27648
    v_mfma_f32_32x32x16_bf16 v[128:143], v[20:23], v[36:39], v[128:143]
    ds_read_b64_tr_b16 v[48:49], v5 offset:18432
    ds_read_b64_tr_b16 v[50:51], v5 offset:27648
    v_mfma_f32_32x32x16_bf16 v[144:159], v[20:23], v[40:43], v[144:159]
    ds_read_b64_tr_b16 v[52:53], v3 offset:18560
    ds_read_b64_tr_b16 v[54:55], v3 offset:27776
    v_mfma_f32_32x32x16_bf16 v[160:175], v[24:27], v[36:39], v[160:175]
    ds_read_b64_tr_b16 v[56:57], v5 offset:18560
    ds_read_b64_tr_b16 v[58:59], v5 offset:27776
    v_mfma_f32_32x32x16_bf16 v[176:191], v[24:27], v[40:43], v[176:191]
    s_add_u32 m0, s11, 113856
    s_nop 0
    buffer_load_dwordx4 v11, s[48:51], s10 offen lds
    v_mfma_f32_32x32x16_bf16 v[192:207], v[28:31], v[36:39], v[192:207]
    s_add_u32 m0, s11, 114880
    s_nop 0
    buffer_load_dwordx4 v12, s[48:51], s10 offen lds
    v_mfma_f32_32x32x16_bf16 v[208:223], v[28:31], v[40:43], v[208:223]
    s_add_u32 m0, s11, 115904
    s_nop 0
    buffer_load_dwordx4 v13, s[48:51], s10 offen lds
    s_add_u32 s10, s10, 18432
    s_waitcnt vmcnt(6) lgkmcnt(0)
    s_barrier
    v_mfma_f32_32x32x16_bf16 v[96:111], v[44:47], v[64:67], v[96:111]
    ds_read_b128 v[36:39], v7 offset:20480
    ds_read_b128 v[40:43], v7 offset:21504
    v_mfma_f32_32x32x16_bf16 v[112:127], v[44:47], v[68:71], v[112:127]
    ds_read_b64_tr_b16 v[16:17], v2 offset:0
    ds_read_b64_tr_b16 v[18:19], v2 offset:9216
    v_mfma_f32_32x32x16_bf16 v[128:143], v[48:51], v[64:67], v[128:143]
    ds_read_b64_tr_b16 v[20:21], v4 offset:0
    ds_read_b64_tr_b16 v[22:23], v4 offset:9216
    v_mfma_f32_32x32x16_bf16 v[144:159], v[48:51], v[68:71], v[144:159]
    ds_read_b64_tr_b16 v[24:25], v2 offset:128
    ds_read_b64_tr_b16 v[26:27], v2 offset:9344
    v_mfma_f32_32x32x16_bf16 v[160:175], v[52:55], v[64:67], v[160:175]
    ds_read_b64_tr_b16 v[28:29], v4 offset:128
    ds_read_b64_tr_b16 v[30:31], v4 offset:9344
    v_mfma_f32_32x32x16_bf16 v[176:191], v[52:55], v[68:71], v[176:191]
    s_add_u32 m0, s11, 132288
    s_nop 0
    buffer_load_dwordx4 v11, s[48:51], s10 offen lds
    v_mfma_f32_32x32x16_bf16 v[192:207], v[56:59], v[64:67], v[192:207]
    s_add_u32 m0, s11, 133312
    s_nop 0
    buffer_load_dwordx4 v12, s[48:51], s10 offen lds
    v_mfma_f32_32x32x16_bf16 v[208:223], v[56:59], v[68:71], v[208:223]
    s_add_u32 m0, s11, 134336
    s_nop 0
    buffer_load_dwordx4 v13, s[48:51], s10 offen lds
    s_add_u32 s10, s10, 18432
    s_waitcnt vmcnt(6) lgkmcnt(0)
    s_barrier
    v_mfma_f32_32x32x16_bf16 v[96:111], v[16:19], v[36:39], v[96:111]
    ds_read_b128 v[64:67], v7 offset:24576
    ds_read_b128 v[68:71], v7 offset:25600
    v_mfma_f32_32x32x16_bf16 v[112:127], v[16:19], v[40:43], v[112:127]
    ds_read_b64_tr_b16 v[44:45], v2 offset:18432
    ds_read_b64_tr_b16 v[46:47], v2 offset:27648
    v_mfma_f32_32x32x16_bf16 v[128:143], v[20:23], v[36:39], v[128:143]
    ds_read_b64_tr_b16 v[48:49], v4 offset:18432
    ds_read_b64_tr_b16 v[50:51], v4 offset:27648
    v_mfma_f32_32x32x16_bf16 v[144:159], v[20:23], v[40:43], v[144:159]
    ds_read_b64_tr_b16 v[52:53], v2 offset:18560
    ds_read_b64_tr_b16 v[54:55], v2 offset:27776
    v_mfma_f32_32x32x16_bf16 v[160:175], v[24:27], v[36:39], v[160:175]
    ds_read_b64_tr_b16 v[56:57], v4 offset:18560
    ds_read_b64_tr_b16 v[58:59], v4 offset:27776
    v_mfma_f32_32x32x16_bf16 v[176:191], v[24:27], v[40:43], v[176:191]
    s_add_u32 m0, s58, 73728
    s_add_u32 s57, s59, 73728
    buffer_load_dwordx4 v1, s[44:47], s57 offen sc1 lds
    v_mfma_f32_32x32x16_bf16 v[192:207], v[28:31], v[36:39], v[192:207]
    s_add_u32 m0, s58, 79872
    s_add_u32 s57, s59, 79872
    buffer_load_dwordx4 v1, s[44:47], s57 offen sc1 lds
    v_mfma_f32_32x32x16_bf16 v[208:223], v[28:31], v[40:43], v[208:223]
    s_add_u32 m0, s58, 86016
    s_add_u32 s57, s59, 86016
    buffer_load_dwordx4 v1, s[44:47], s57 offen sc1 lds
    s_waitcnt vmcnt(6) lgkmcnt(0)
    s_barrier
    v_mfma_f32_32x32x16_bf16 v[96:111], v[44:47], v[64:67], v[96:111]
    ds_read_b128 v[36:39], v7 offset:28672
    ds_read_b128 v[40:43], v7 offset:29696
    v_mfma_f32_32x32x16_bf16 v[112:127], v[44:47], v[68:71], v[112:127]
    ds_read_b64_tr_b16 v[16:17], v3 offset:0
    ds_read_b64_tr_b16 v[18:19], v3 offset:9216
    v_mfma_f32_32x32x16_bf16 v[128:143], v[48:51], v[64:67], v[128:143]
    ds_read_b64_tr_b16 v[20:21], v5 offset:0
    ds_read_b64_tr_b16 v[22:23], v5 offset:9216
    v_mfma_f32_32x32x16_bf16 v[144:159], v[48:51], v[68:71], v[144:159]
    ds_read_b64_tr_b16 v[24:25], v3 offset:128
    ds_read_b64_tr_b16 v[26:27], v3 offset:9344
    v_mfma_f32_32x32x16_bf16 v[160:175], v[52:55], v[64:67], v[160:175]
    ds_read_b64_tr_b16 v[28:29], v5 offset:128
    ds_read_b64_tr_b16 v[30:31], v5 offset:9344
    v_mfma_f32_32x32x16_bf16 v[176:191], v[52:55], v[68:71], v[176:191]
    s_add_u32 m0, s58, 92160
    s_add_u32 s57, s59, 92160
    buffer_load_dwordx4 v1, s[44:47], s57 offen sc1 lds
    v_mfma_f32_32x32x16_bf16 v[192:207], v[56:59], v[64:67], v[192:207]
    s_add_u32 m0, s58, 98304
    s_add_u32 s57, s59, 98304
    buffer_load_dwordx4 v1, s[44:47], s57 offen sc1 lds
    v_mfma_f32_32x32x16_bf16 v[208:223], v[56:59], v[68:71], v[208:223]
    s_add_u32 m0, s58, 104448
    s_add_u32 s57, s59, 104448
    buffer_load_dwordx4 v1, s[44:47], s57 offen sc1 lds
    s_waitcnt vmcnt(6) lgkmcnt(0)
    s_barrier
    v_mfma_f32_32x32x16_bf16 v[96:111], v[16:19], v[36:39], v[96:111]
    ds_read_b128 v[64:67], v7 offset:32768
    ds_read_b128 v[68:71], v7 offset:33792
    v_mfma_f32_32x32x16_bf16 v[112:127], v[16:19], v[40:43], v[112:127]
    ds_read_b64_tr_b16 v[44:45], v3 offset:18432
    ds_read_b64_tr_b16 v[46:47], v3 offset:27648
    v_mfma_f32_32x32x16_bf16 v[128:143], v[20:23], v[36:39], v[128:143]
    ds_read_b64_tr_b16 v[48:49], v5 offset:18432
    ds_read_b64_tr_b16 v[50:51], v5 offset:27648
    v_mfma_f32_32x32x16_bf16 v[144:159], v[20:23], v[40:43], v[144:159]
    ds_read_b64_tr_b16 v[52:53], v3 offset:18560
    ds_read_b64_tr_b16 v[54:55], v3 offset:27776
    v_mfma_f32_32x32x16_bf16 v[160:175], v[24:27], v[36:39], v[160:175]
    ds_read_b64_tr_b16 v[56:57], v5 offset:18560
    ds_read_b64_tr_b16 v[58:59], v5 offset:27776
    v_mfma_f32_32x32x16_bf16 v[176:191], v[24:27], v[40:43], v[176:191]
    s_add_u32 m0, s58, 110592
    s_add_u32 s57, s59, 110592
    buffer_load_dwordx4 v1, s[44:47], s57 offen sc1 lds
    v_mfma_f32_32x32x16_bf16 v[192:207], v[28:31], v[36:39], v[192:207]
    s_add_u32 m0, s58, 116736
    s_add_u32 s57, s59, 116736
    buffer_load_dwordx4 v1, s[44:47], s57 offen sc1 lds
    v_mfma_f32_32x32x16_bf16 v[208:223], v[28:31], v[40:43], v[208:223]
    s_add_u32 m0, s58, 122880
    s_add_u32 s57, s59, 122880
    buffer_load_dwordx4 v1, s[44:47], s57 offen sc1 lds
    s_waitcnt lgkmcnt(0)
    s_barrier
    v_mfma_f32_32x32x16_bf16 v[96:111], v[44:47], v[64:67], v[96:111]
    v_mfma_f32_32x32x16_bf16 v[112:127], v[44:47], v[68:71], v[112:127]
    v_mfma_f32_32x32x16_bf16 v[128:143], v[48:51], v[64:67], v[128:143]
    v_mfma_f32_32x32x16_bf16 v[144:159], v[48:51], v[68:71], v[144:159]
    v_mfma_f32_32x32x16_bf16 v[160:175], v[52:55], v[64:67], v[160:175]
    s_add_u32 m0, s58, 129024
    s_add_u32 s57, s59, 129024
    buffer_load_dwordx4 v1, s[44:47], s57 offen sc1 lds
    v_mfma_f32_32x32x16_bf16 v[176:191], v[52:55], v[68:71], v[176:191]
    s_add_u32 m0, s58, 135168
    s_add_u32 s57, s59, 135168
    buffer_load_dwordx4 v1, s[44:47], s57 offen sc1 lds
    v_mfma_f32_32x32x16_bf16 v[192:207], v[56:59], v[64:67], v[192:207]
    s_add_u32 m0, s58, 141312
    s_add_u32 s57, s59, 141312
    buffer_load_dwordx4 v1, s[44:47], s57 offen sc1 lds
    v_mfma_f32_32x32x16_bf16 v[208:223], v[56:59], v[68:71], v[208:223]
    s_add_u32 m0, s58, 147456
    s_add_u32 s57, s59, 147456
    buffer_load_dwordx4 v1, s[44:47], s57 offen sc1 lds
    s_branch ATT
PRO_B:
    s_sub_u32 s15, s3, 6
    v_and_b32 v100, 7, v0
    v_lshrrev_b32 v101, 3, v0
    v_mul_u32_u24 v102, 1168, v100
    v_lshl_add_u32 v102, v101, 4, v102
    s_mul_i32 s56, s15, 512
    s_add_u32 s56, s56, 153984
    v_add_u32 v102, s56, v102
    ds_read_b128 v[128:131], v102 offset:0
    ds_read_b128 v[132:135], v102 offset:128
    ds_read_b128 v[136:139], v102 offset:256
    ds_read_b128 v[140:143], v102 offset:384
    ds_read_b128 v[144:147], v102 offset:512
    v_lshlrev_b32 v103, 8, v101
    v_lshl_add_u32 v103, v100, 4, v103
    s_lshr_b32 s56, s5, 1
    s_lshl_b32 s57, s4, 3
    s_add_u32 s56, s56, s57
    s_mul_i32 s56, s56, 18432
    s_and_b32 s57, s5, 1
    s_lshl_b32 s57, s57, 7
    s_add_u32 s56, s56, s57
    s_lshl_b32 s57, s15, 13
    s_add_u32 s56, s56, s57
    s_waitcnt vmcnt(0)
    v_readfirstlane_b32 s76, v124
    v_readfirstlane_b32 s77, v125
    s_waitcnt lgkmcnt(4)
    buffer_store_dwordx4 v[128:131], v103, s[44:47], s56 offen sc1
    s_add_u32 s56, s56, 2048
    s_waitcnt lgkmcnt(3)
    buffer_store_dwordx4 v[132:135], v103, s[44:47], s56 offen sc1
    s_add_u32 s56, s56, 2048
    s_waitcnt lgkmcnt(2)
    buffer_store_dwordx4 v[136:139], v103, s[44:47], s56 offen sc1
    s_add_u32 s56, s56, 2048
    s_waitcnt lgkmcnt(1)
    buffer_store_dwordx4 v[140:143], v103, s[44:47], s56 offen sc1
    s_add_u32 s56, s56, 2048
    s_waitcnt lgkmcnt(0)
    buffer_store_dwordx4 v[144:147], v103, s[44:47], s56 offen sc1
    s_mul_i32 s76, s76, 0x9e3779b1
    s_add_u32 s76, s76, 0x7f4a7c15
    s_mul_i32 s77, s77, 0x85ebca6b
    s_add_u32 s77, s77, 0x2545f491
    v_mov_b32 v104, s76
    v_mov_b32 v105, s77
    s_lshl_b32 s58, s4, 8
    s_add_u32 s58, s58, 5545984
    s_lshl_b32 s57, s5, 1
    s_add_u32 s57, s57, s15
    s_lshl_b32 s57, s57, 3
    s_add_u32 s57, s57, s58
    s_mov_b32 s40, s18
    s_mov_b32 s41, s19
    s_mov_b32 s42, 663552
    s_mov_b32 s43, 0x20000
    s_cmp_ge_u32 s5, 3
    s_cselect_b32 s48, s22, s20
    s_cselect_b32 s49, s23, s21
    s_mov_b32 s50, 20736
    s_mov_b32 s51, 0x20000
    s_cselect_b32 s59, 3, 0
    s_sub_u32 s14, s5, s59
    s_min_u32 s14, s14, 2
    s_lshl_b32 s14, s14, 4
    s_lshl_b32 s8, s15, 10
    s_add_u32 s8, s8, 18464
    s_lshl_b32 s9, s15, 11
    s_add_u32 s9, s9, 21536
    s_mul_i32 s6, s5, 72
    s_mul_i32 s59, s15, 36
    s_add_u32 s6, s6, s59
    v_lshrrev_b32 v106, 2, v0
    v_and_b32 v107, 3, v0
    v_lshlrev_b32 v107, 4, v107
    v_lshrrev_b32 v109, 5, v0
    v_lshlrev_b32 v109, 5, v109
    v_xor_b32 v109, v109, v107
    v_mul_u32_u24 v7, 1152, v106
    v_add_u32 v7, v7, v109
    v_mul_u32_u24 v8, 36, v106
    v_add_u32 v8, v8, v107
    v_mov_b32 v108, 0x7fff0000
    v_cmp_eq_u32 vcc, 48, v109
    s_nop 1
    v_cndmask_b32 v7, v7, v108, vcc
    v_cmp_lt_u32 vcc, 0, v107
    s_nop 1
    v_cndmask_b32 v8, v8, v108, vcc
    s_cmp_ge_u32 s5, 6
    s_cselect_b32 s50, 0, 20736
    s_lshl_b32 s7, s4, 3
    s_lshl_b32 s59, s15, 1
    s_add_u32 s7, s7, s59
    s_mul_i32 s7, s7, 18432
    v_mov_b32 v9, v1
    v_add_u32 v10, 18432, v1
    s_waitcnt vmcnt(0)
    s_mov_b32 exec_lo, 1
    s_mov_b32 exec_hi, 0
    buffer_store_dwordx2 v[104:105], off, s[44:47], s57 sc1
    s_mov_b64 exec, -1
    s_barrier
    s_add_u32 m0, s8, 102656
    s_nop 0
    buffer_load_dwordx4 v7, s[40:43], s6 offen lds
    s_add_u32 s6, s6, 18432
    s_mov_b32 m0, 123168
    s_nop 0
    buffer_load_dwordx4 v8, s[48:51], s14 offen lds
    s_add_u32 s14, s14, 576
    s_add_u32 m0, s8, 128320
    s_nop 0
    buffer_load_dwordx4 v7, s[40:43], s6 offen lds
    s_add_u32 s6, s6, 18432
    s_mov_b32 m0, 148832
    s_nop 0
    buffer_load_dwordx4 v8, s[48:51], s14 offen lds
    s_add_u32 s14, s14, 576
    s_add_u32 m0, s8, 51328
    s_nop 0
    buffer_load_dwordx4 v7, s[40:43], s6 offen lds
    s_add_u32 s6, s6, 18432
    s_mov_b32 m0, 71840
    s_nop 0
    buffer_load_dwordx4 v8, s[48:51], s14 offen lds
    s_add_u32 s14, s14, 576
    s_add_u32 m0, s8, 76992
    s_nop 0
    buffer_load_dwordx4 v7, s[40:43], s6 offen lds
    s_add_u32 s6, s6, 18432
    s_mov_b32 m0, 97504
    s_nop 0
    buffer_load_dwordx4 v8, s[48:51], s14 offen lds
    s_add_u32 s14, s14, 576
    v_lshrrev_b32 v112, 5, v0
    v_bfe_u32 v113, v0, 2, 2
    v_bfe_u32 v114, v0, 4, 1
    v_and_b32 v115, 3, v0
    s_lshr_b32 s56, s3, 1
    s_and_b32 s57, s3, 1
    v_lshl_add_u32 v116, v114, 3, v113
    v_mul_u32_u24 v117, 25664, v112
    v_add_u32 v117, 102656, v117
    v_mul_u32_u24 v2, 576, v116
    v_add_u32 v2, v2, v117
    v_lshl_add_u32 v2, v115, 3, v2
    s_mul_i32 s58, s56, 160
    v_add_u32 v2, s58, v2
    v_lshlrev_b32 v118, 5, v114
    v_sub_u32 v119, 0, v118
    s_and_b32 s58, s56, 1
    s_cmp_eq_u32 s58, 0
    s_cselect_b64 s[74:75], -1, 0
    v_cndmask_b32 v5, v119, v118, s[74:75]
    v_sub_u32 v3, v2, v5
    v_add_u32 v2, v2, v5
    v_lshl_add_u32 v117, v116, 6, v117
    v_add_u32 v5, v117, v118
    v_lshl_add_u32 v5, v115, 3, v5
    v_add_u32 v5, 18464, v5
    v_xor_b32 v118, 32, v118
    v_and_b32 v119, 1, v115
    v_lshl_add_u32 v118, v119, 10, v118
    v_add_u32 v118, 18464, v118
    v_lshlrev_b32 v119, 3, v119
    v_add_u32 v119, 20512, v119
    v_cmp_gt_u32 vcc, 2, v115
    s_nop 1
    v_cndmask_b32 v118, v119, v118, vcc
    v_add_u32 v6, v117, v118
    s_mul_i32 s58, s57, 25664
    s_add_u32 s58, s58, 124192
    v_add_u32 v4, s58, v1
    v_lshrrev_b32 v110, 5, v0
    v_bfe_u32 v111, v0, 2, 3
    v_and_b32 v112, 3, v111
    v_lshl_add_u32 v112, v110, 2, v112
    v_lshrrev_b32 v113, 2, v111
    v_lshl_add_u32 v112, v113, 3, v112
    v_lshrrev_b32 v113, 1, v111
    v_lshl_add_u32 v113, v110, 2, v113
    v_mul_u32_u24 v113, 18, v113
    v_and_b32 v114, 1, v111
    v_add3_u32 v113, v113, v114, 16
    v_mul_u32_u24 v112, 1152, v112
    v_mul_u32_u24 v113, 1152, v113
    v_add_u32 v112, v112, v107
    v_add_u32 v113, v113, v107
    s_mov_b32 s64, s24
    s_mov_b32 s65, s25
    s_mov_b32 s66, 663552
    s_mov_b32 s67, 0x20000
    s_lshl_b32 s69, s15, 11
    s_add_u32 s69, s69, 153984
    v_bfe_u32 v114, v0, 2, 2
    v_lshl_add_u32 v114, v110, 3, v114
    v_lshlrev_b32 v114, 6, v114
    v_bfe_u32 v115, v0, 4, 1
    v_lshl_add_u32 v114, v115, 5, v114
    v_and_b32 v115, 3, v0
    v_lshl_add_u32 v114, v115, 3, v114
    v_add_u32 v13, s69, v114
    s_lshl_b32 s57, s2, 1
    s_add_u32 s57, s57, s15
    s_mul_i32 s58, s57, 1821
    s_lshr_b32 s58, s58, 16
    s_mul_i32 s59, s58, 36
    s_sub_u32 s59, s57, s59
    s_mul_i32 s60, s58, 72
    s_add_u32 s60, s60, s59
    s_lshl_b32 s60, s60, 9
    s_add_u32 s60, s60, 4882432
    s_lshl_b32 s58, s58, 6
    s_mul_i32 s62, s59, 20736
    s_sub_u32 s57, s59, 32
    s_mul_i32 s57, s57, 165888
    s_cmp_ge_u32 s59, 32
    s_cselect_b32 s62, s57, s62
    s_cselect_b64 s[74:75], -1, 0
    s_add_u32 s62, s62, s58
    v_cndmask_b32 v11, v112, v113, s[74:75]
    s_lshl_b32 s57, s2, 1
    s_add_u32 s57, s57, s15
    s_add_u32 s57, s57, 512
    s_min_u32 s57, s57, 647
    s_mul_i32 s58, s57, 1821
    s_lshr_b32 s58, s58, 16
    s_mul_i32 s59, s58, 36
    s_sub_u32 s59, s57, s59
    s_mul_i32 s61, s58, 72
    s_add_u32 s61, s61, s59
    s_lshl_b32 s61, s61, 9
    s_add_u32 s61, s61, 4882432
    s_cmp_ge_u32 s2, 68
    s_cselect_b32 s61, 0x7f000000, s61
    s_lshl_b32 s58, s58, 6
    s_mul_i32 s63, s59, 20736
    s_sub_u32 s57, s59, 32
    s_mul_i32 s57, s57, 165888
    s_cmp_ge_u32 s59, 32
    s_cselect_b32 s63, s57, s63
    s_cselect_b64 s[74:75], -1, 0
    s_add_u32 s63, s63, s58
    v_cndmask_b32 v12, v112, v113, s[74:75]
    v_and_b32 v106, 7, v0
    v_lshlrev_b32 v106, 3, v106
    v_bfe_u32 v108, v0, 3, 1
    v_lshl_add_u32 v106, v108, 7, v106
    s_lshl_b32 s58, s4, 8
    s_lshl_b32 s59, s15, 6
    s_add_u32 s58, s58, s59
    s_add_u32 s58, s58, 5545984
    s_mov_b32 s68, 0
XPOLL:
    buffer_load_dwordx2 v[128:129], v106, s[44:47], s58 offen sc1
    s_waitcnt vmcnt(0)
    v_cmp_eq_u32 vcc, s76, v128
    v_cmp_eq_u32 s[74:75], s77, v129
    s_nop 3
    s_and_b64 vcc, vcc, s[74:75]
    s_cmp_eq_u64 vcc, -1
    s_cbranch_scc1 XPOLL_OK
    s_sleep 2
    s_add_u32 s68, s68, 1
    s_cmp_lt_u32 s68, 0x8000
    s_cbranch_scc1 XPOLL
XPOLL_OK:
    s_add_u32 m0, s9, 102656
    s_nop 0
    buffer_load_dwordx4 v9, s[44:47], s7 offen sc1 lds
    s_add_u32 m0, s9, 103680
    s_nop 0
    buffer_load_dwordx4 v10, s[44:47], s7 offen sc1 lds
    s_add_u32 s7, s7, 73728
    s_add_u32 m0, s9, 128320
    s_nop 0
    buffer_load_dwordx4 v9, s[44:47], s7 offen sc1 lds
    s_add_u32 m0, s9, 129344
    s_nop 0
    buffer_load_dwordx4 v10, s[44:47], s7 offen sc1 lds
    s_sub_u32 s7, s7, 72704
    s_add_u32 m0, s9, 51328
    s_nop 0
    buffer_load_dwordx4 v9, s[44:47], s7 offen sc1 lds
    s_add_u32 m0, s9, 52352
    s_nop 0
    buffer_load_dwordx4 v10, s[44:47], s7 offen sc1 lds
    s_add_u32 s7, s7, 73728
    s_add_u32 m0, s9, 76992
    s_nop 0
    buffer_load_dwordx4 v9, s[44:47], s7 offen sc1 lds
    s_add_u32 m0, s9, 78016
    s_nop 0
    buffer_load_dwordx4 v10, s[44:47], s7 offen sc1 lds
    s_sub_u32 s7, s7, 72704
    s_waitcnt vmcnt(4)
    s_barrier
    ds_read_b128 v[64:67], v4 offset:0
    ds_read_b128 v[68:71], v4 offset:1024
    ds_read_b128 v[72:75], v4 offset:2048
    ds_read_b128 v[76:79], v4 offset:3072
    ds_read_b64_tr_b16 v[16:17], v2 offset:0
    ds_read_b64_tr_b16 v[18:19], v2 offset:2304
    ds_read_b64_tr_b16 v[20:21], v2 offset:9248
    ds_read_b64_tr_b16 v[22:23], v2 offset:11552
    ds_read_b64_tr_b16 v[24:25], v3 offset:32
    ds_read_b64_tr_b16 v[26:27], v3 offset:2336
    ds_read_b64_tr_b16 v[28:29], v3 offset:9280
    ds_read_b64_tr_b16 v[30:31], v3 offset:11584
    ds_read_b64_tr_b16 v[32:33], v2 offset:64
    ds_read_b64_tr_b16 v[34:35], v2 offset:2368
    ds_read_b64_tr_b16 v[36:37], v2 offset:9312
    ds_read_b64_tr_b16 v[38:39], v2 offset:11616
    ds_read_b64_tr_b16 v[40:41], v5 offset:0
    ds_read_b64_tr_b16 v[42:43], v5 offset:256
    ds_read_b64_tr_b16 v[44:45], v5 offset:1024
    ds_read_b64_tr_b16 v[46:47], v5 offset:1280
    ds_read_b64_tr_b16 v[48:49], v6 offset:0
    ds_read_b64_tr_b16 v[50:51], v6 offset:256
    s_waitcnt vmcnt(0) lgkmcnt(0)
    s_barrier
    v_mfma_f32_16x16x32_bf16 v[96:99], v[16:19], v[64:67], 0
    v_subrev_u32 v4, 51328, v4
    v_subrev_u32 v6, 51328, v6
    v_mfma_f32_16x16x32_bf16 v[100:103], v[16:19], v[68:71], 0
    v_subrev_u32 v2, 51328, v2
    v_subrev_u32 v3, 51328, v3
    v_mfma_f32_16x16x32_bf16 v[104:107], v[16:19], v[72:75], 0
    v_subrev_u32 v5, 51328, v5
    ds_read_b128 v[80:83], v4 offset:0
    v_mfma_f32_16x16x32_bf16 v[108:111], v[16:19], v[76:79], 0
    ds_read_b64_tr_b16 v[16:17], v2 offset:0
    ds_read_b64_tr_b16 v[18:19], v2 offset:2304
    v_mfma_f32_16x16x32_bf16 v[112:115], v[20:23], v[64:67], 0
    ds_read_b128 v[84:87], v4 offset:1024
    ds_read_b128 v[88:91], v4 offset:2048
    v_mfma_f32_16x16x32_bf16 v[116:119], v[20:23], v[68:71], 0
    ds_read_b128 v[92:95], v4 offset:3072
    ds_read_b64_tr_b16 v[56:57], v6 offset:0
    v_mfma_f32_16x16x32_bf16 v[120:123], v[20:23], v[72:75], 0
    ds_read_b64_tr_b16 v[58:59], v6 offset:256
    s_add_u32 m0, s8, 0
    v_mfma_f32_16x16x32_bf16 v[124:127], v[20:23], v[76:79], 0
    ds_read_b64_tr_b16 v[20:21], v2 offset:9248
    ds_read_b64_tr_b16 v[22:23], v2 offset:11552
    v_mfma_f32_16x16x32_bf16 v[128:131], v[24:27], v[64:67], 0
    buffer_load_dwordx4 v7, s[40:43], s6 offen lds
    s_add_u32 s6, s6, 18432
    v_mfma_f32_16x16x32_bf16 v[132:135], v[24:27], v[68:71], 0
    s_mov_b32 m0, 20512
    v_mfma_f32_16x16x32_bf16 v[136:139], v[24:27], v[72:75], 0
    buffer_load_dwordx4 v8, s[48:51], s14 offen lds
    s_add_u32 s14, s14, 576
    v_mfma_f32_16x16x32_bf16 v[140:143], v[24:27], v[76:79], 0
    ds_read_b64_tr_b16 v[24:25], v3 offset:32
    ds_read_b64_tr_b16 v[26:27], v3 offset:2336
    v_mfma_f32_16x16x32_bf16 v[144:147], v[28:31], v[64:67], 0
    s_add_u32 m0, s9, 0
    v_mfma_f32_16x16x32_bf16 v[148:151], v[28:31], v[68:71], 0
    buffer_load_dwordx4 v9, s[44:47], s7 offen sc1 lds
    s_add_u32 m0, s9, 1024
    v_mfma_f32_16x16x32_bf16 v[152:155], v[28:31], v[72:75], 0
    buffer_load_dwordx4 v10, s[44:47], s7 offen sc1 lds
    s_add_u32 s7, s7, 73728
    v_mfma_f32_16x16x32_bf16 v[156:159], v[28:31], v[76:79], 0
    ds_read_b64_tr_b16 v[28:29], v3 offset:9280
    ds_read_b64_tr_b16 v[30:31], v3 offset:11584
    s_add_u32 m0, s8, 25664
    v_mfma_f32_16x16x32_bf16 v[160:163], v[32:35], v[64:67], 0
    buffer_load_dwordx4 v7, s[40:43], s6 offen lds
    s_add_u32 s6, s6, 18432
    v_mfma_f32_16x16x32_bf16 v[164:167], v[32:35], v[68:71], 0
    s_mov_b32 m0, 46176
    v_mfma_f32_16x16x32_bf16 v[168:171], v[32:35], v[72:75], 0
    buffer_load_dwordx4 v8, s[48:51], s14 offen lds
    s_add_u32 s14, s14, 576
    v_mfma_f32_16x16x32_bf16 v[172:175], v[32:35], v[76:79], 0
    ds_read_b64_tr_b16 v[32:33], v2 offset:64
    ds_read_b64_tr_b16 v[34:35], v2 offset:2368
    s_add_u32 m0, s9, 25664
    v_mfma_f32_16x16x32_bf16 v[176:179], v[36:39], v[64:67], 0
    buffer_load_dwordx4 v9, s[44:47], s7 offen sc1 lds
    s_add_u32 m0, s9, 26688
    v_mfma_f32_16x16x32_bf16 v[180:183], v[36:39], v[68:71], 0
    buffer_load_dwordx4 v10, s[44:47], s7 offen sc1 lds
    s_sub_u32 s7, s7, 72704
    v_mfma_f32_16x16x32_bf16 v[184:187], v[36:39], v[72:75], 0
    s_add_u32 m0, s8, 102656
    v_mfma_f32_16x16x32_bf16 v[188:191], v[36:39], v[76:79], 0
    ds_read_b64_tr_b16 v[36:37], v2 offset:9312
    ds_read_b64_tr_b16 v[38:39], v2 offset:11616
    buffer_load_dwordx4 v7, s[40:43], s6 offen lds
    v_mfma_f32_16x16x32_bf16 v[192:195], v[40:43], v[64:67], 0
    s_add_u32 s6, s6, 18432
    s_mov_b32 m0, 123168
    v_mfma_f32_16x16x32_bf16 v[196:199], v[40:43], v[68:71], 0
    buffer_load_dwordx4 v8, s[48:51], s14 offen lds
    s_add_u32 s14, s14, 576
    v_mfma_f32_16x16x32_bf16 v[200:203], v[40:43], v[72:75], 0
    s_add_u32 m0, s9, 102656
    v_mfma_f32_16x16x32_bf16 v[204:207], v[40:43], v[76:79], 0
    ds_read_b64_tr_b16 v[40:41], v5 offset:0
    ds_read_b64_tr_b16 v[42:43], v5 offset:256
    buffer_load_dwordx4 v9, s[44:47], s7 offen sc1 lds
    v_mfma_f32_16x16x32_bf16 v[208:211], v[44:47], v[64:67], 0
    s_add_u32 m0, s9, 103680
    v_mfma_f32_16x16x32_bf16 v[212:215], v[44:47], v[68:71], 0
    buffer_load_dwordx4 v10, s[44:47], s7 offen sc1 lds
    s_add_u32 s7, s7, 73728
    v_mfma_f32_16x16x32_bf16 v[216:219], v[44:47], v[72:75], 0
    s_add_u32 m0, s8, 128320
    v_mfma_f32_16x16x32_bf16 v[220:223], v[44:47], v[76:79], 0
    ds_read_b64_tr_b16 v[44:45], v5 offset:1024
    ds_read_b64_tr_b16 v[46:47], v5 offset:1280
    buffer_load_dwordx4 v7, s[40:43], s6 offen lds
    v_mfma_f32_16x16x32_bf16 v[224:227], v[48:51], v[64:67], 0
    s_add_u32 s6, s6, 18432
    s_mov_b32 m0, 148832
    v_mfma_f32_16x16x32_bf16 v[228:231], v[48:51], v[68:71], 0
    buffer_load_dwordx4 v8, s[48:51], s14 offen lds
    s_add_u32 s14, s14, 576
    s_add_u32 m0, s9, 128320
    v_mfma_f32_16x16x32_bf16 v[232:235], v[48:51], v[72:75], 0
    buffer_load_dwordx4 v9, s[44:47], s7 offen sc1 lds
    s_add_u32 m0, s9, 129344
    v_mfma_f32_16x16x32_bf16 v[236:239], v[48:51], v[76:79], 0
    buffer_load_dwordx4 v10, s[44:47], s7 offen sc1 lds
    s_sub_u32 s7, s7, 72704
    s_mov_b32 s12, 2
G1B:
    s_waitcnt vmcnt(8) lgkmcnt(0)
    s_barrier
    v_mfma_f32_16x16x32_bf16 v[96:99], v[16:19], v[80:83], v[96:99]
    v_subrev_u32 v4, 51328, v4
    v_subrev_u32 v6, 51328, v6
    v_mfma_f32_16x16x32_bf16 v[100:103], v[16:19], v[84:87], v[100:103]
    v_subrev_u32 v2, 51328, v2
    v_subrev_u32 v3, 51328, v3
    v_mfma_f32_16x16x32_bf16 v[104:107], v[16:19], v[88:91], v[104:107]
    v_subrev_u32 v5, 51328, v5
    ds_read_b128 v[64:67], v4 offset:0
    v_mfma_f32_16x16x32_bf16 v[108:111], v[16:19], v[92:95], v[108:111]
    ds_read_b64_tr_b16 v[16:17], v2 offset:0
    ds_read_b64_tr_b16 v[18:19], v2 offset:2304
    v_mfma_f32_16x16x32_bf16 v[112:115], v[20:23], v[80:83], v[112:115]
    ds_read_b128 v[68:71], v4 offset:1024
    ds_read_b128 v[72:75], v4 offset:2048
    v_mfma_f32_16x16x32_bf16 v[116:119], v[20:23], v[84:87], v[116:119]
    ds_read_b128 v[76:79], v4 offset:3072
    ds_read_b64_tr_b16 v[48:49], v6 offset:0
    v_mfma_f32_16x16x32_bf16 v[120:123], v[20:23], v[88:91], v[120:123]
    ds_read_b64_tr_b16 v[50:51], v6 offset:256
    s_add_u32 m0, s8, 51328
    v_mfma_f32_16x16x32_bf16 v[124:127], v[20:23], v[92:95], v[124:127]
    ds_read_b64_tr_b16 v[20:21], v2 offset:9248
    ds_read_b64_tr_b16 v[22:23], v2 offset:11552
    v_mfma_f32_16x16x32_bf16 v[128:131], v[24:27], v[80:83], v[128:131]
    buffer_load_dwordx4 v7, s[40:43], s6 offen lds
    s_add_u32 s6, s6, 18432
    v_mfma_f32_16x16x32_bf16 v[132:135], v[24:27], v[84:87], v[132:135]
    s_mov_b32 m0, 71840
    v_mfma_f32_16x16x32_bf16 v[136:139], v[24:27], v[88:91], v[136:139]
    buffer_load_dwordx4 v8, s[48:51], s14 offen lds
    s_add_u32 s14, s14, 576
    v_mfma_f32_16x16x32_bf16 v[140:143], v[24:27], v[92:95], v[140:143]
    ds_read_b64_tr_b16 v[24:25], v3 offset:32
    ds_read_b64_tr_b16 v[26:27], v3 offset:2336
    v_mfma_f32_16x16x32_bf16 v[144:147], v[28:31], v[80:83], v[144:147]
    s_add_u32 m0, s9, 51328
    v_mfma_f32_16x16x32_bf16 v[148:151], v[28:31], v[84:87], v[148:151]
    buffer_load_dwordx4 v9, s[44:47], s7 offen sc1 lds
    v_mfma_f32_16x16x32_bf16 v[152:155], v[28:31], v[88:91], v[152:155]
    s_add_u32 m0, s9, 52352
    v_mfma_f32_16x16x32_bf16 v[156:159], v[28:31], v[92:95], v[156:159]
    ds_read_b64_tr_b16 v[28:29], v3 offset:9280
    ds_read_b64_tr_b16 v[30:31], v3 offset:11584
    v_mfma_f32_16x16x32_bf16 v[160:163], v[32:35], v[80:83], v[160:163]
    buffer_load_dwordx4 v10, s[44:47], s7 offen sc1 lds
    v_mfma_f32_16x16x32_bf16 v[164:167], v[32:35], v[84:87], v[164:167]
    s_add_u32 s7, s7, 73728
    v_mfma_f32_16x16x32_bf16 v[168:171], v[32:35], v[88:91], v[168:171]
    s_add_u32 m0, s8, 76992
    v_mfma_f32_16x16x32_bf16 v[172:175], v[32:35], v[92:95], v[172:175]
    ds_read_b64_tr_b16 v[32:33], v2 offset:64
    ds_read_b64_tr_b16 v[34:35], v2 offset:2368
    v_mfma_f32_16x16x32_bf16 v[176:179], v[36:39], v[80:83], v[176:179]
    buffer_load_dwordx4 v7, s[40:43], s6 offen lds
    v_mfma_f32_16x16x32_bf16 v[180:183], v[36:39], v[84:87], v[180:183]
    s_add_u32 s6, s6, 18432
    v_mfma_f32_16x16x32_bf16 v[184:187], v[36:39], v[88:91], v[184:187]
    s_mov_b32 m0, 97504
    v_mfma_f32_16x16x32_bf16 v[188:191], v[36:39], v[92:95], v[188:191]
    ds_read_b64_tr_b16 v[36:37], v2 offset:9312
    v_mfma_f32_16x16x32_bf16 v[192:195], v[40:43], v[80:83], v[192:195]
    ds_read_b64_tr_b16 v[38:39], v2 offset:11616
    v_mfma_f32_16x16x32_bf16 v[196:199], v[40:43], v[84:87], v[196:199]
    buffer_load_dwordx4 v8, s[48:51], s14 offen lds
    v_mfma_f32_16x16x32_bf16 v[200:203], v[40:43], v[88:91], v[200:203]
    s_add_u32 s14, s14, 576
    v_mfma_f32_16x16x32_bf16 v[204:207], v[40:43], v[92:95], v[204:207]
    ds_read_b64_tr_b16 v[40:41], v5 offset:0
    v_mfma_f32_16x16x32_bf16 v[208:211], v[44:47], v[80:83], v[208:211]
    ds_read_b64_tr_b16 v[42:43], v5 offset:256
    v_mfma_f32_16x16x32_bf16 v[212:215], v[44:47], v[84:87], v[212:215]
    s_add_u32 m0, s9, 76992
    v_mfma_f32_16x16x32_bf16 v[216:219], v[44:47], v[88:91], v[216:219]
    buffer_load_dwordx4 v9, s[44:47], s7 offen sc1 lds
    v_mfma_f32_16x16x32_bf16 v[220:223], v[44:47], v[92:95], v[220:223]
    ds_read_b64_tr_b16 v[44:45], v5 offset:1024
    v_mfma_f32_16x16x32_bf16 v[224:227], v[56:59], v[80:83], v[224:227]
    ds_read_b64_tr_b16 v[46:47], v5 offset:1280
    v_mfma_f32_16x16x32_bf16 v[228:231], v[56:59], v[84:87], v[228:231]
    s_add_u32 m0, s9, 78016
    v_mfma_f32_16x16x32_bf16 v[232:235], v[56:59], v[88:91], v[232:235]
    buffer_load_dwordx4 v10, s[44:47], s7 offen sc1 lds
    v_mfma_f32_16x16x32_bf16 v[236:239], v[56:59], v[92:95], v[236:239]
    s_sub_u32 s7, s7, 72704
    s_waitcnt vmcnt(8) lgkmcnt(0)
    s_barrier
    v_mfma_f32_16x16x32_bf16 v[96:99], v[16:19], v[64:67], v[96:99]
    v_add_u32 v4, 102656, v4
    v_add_u32 v6, 102656, v6
    v_mfma_f32_16x16x32_bf16 v[100:103], v[16:19], v[68:71], v[100:103]
    v_add_u32 v2, 102656, v2
    v_add_u32 v3, 102656, v3
    v_mfma_f32_16x16x32_bf16 v[104:107], v[16:19], v[72:75], v[104:107]
    v_add_u32 v5, 102656, v5
    ds_read_b128 v[80:83], v4 offset:0
    v_mfma_f32_16x16x32_bf16 v[108:111], v[16:19], v[76:79], v[108:111]
    ds_read_b64_tr_b16 v[16:17], v2 offset:0
    ds_read_b64_tr_b16 v[18:19], v2 offset:2304
    v_mfma_f32_16x16x32_bf16 v[112:115], v[20:23], v[64:67], v[112:115]
    ds_read_b128 v[84:87], v4 offset:1024
    ds_read_b128 v[88:91], v4 offset:2048
    v_mfma_f32_16x16x32_bf16 v[116:119], v[20:23], v[68:71], v[116:119]
    ds_read_b128 v[92:95], v4 offset:3072
    ds_read_b64_tr_b16 v[56:57], v6 offset:0
    v_mfma_f32_16x16x32_bf16 v[120:123], v[20:23], v[72:75], v[120:123]
    ds_read_b64_tr_b16 v[58:59], v6 offset:256
    s_add_u32 m0, s8, 0
    v_mfma_f32_16x16x32_bf16 v[124:127], v[20:23], v[76:79], v[124:127]
    ds_read_b64_tr_b16 v[20:21], v2 offset:9248
    ds_read_b64_tr_b16 v[22:23], v2 offset:11552
    v_mfma_f32_16x16x32_bf16 v[128:131], v[24:27], v[64:67], v[128:131]
    buffer_load_dwordx4 v7, s[40:43], s6 offen lds
    s_add_u32 s6, s6, 18432
    v_mfma_f32_16x16x32_bf16 v[132:135], v[24:27], v[68:71], v[132:135]
    s_mov_b32 m0, 20512
    v_mfma_f32_16x16x32_bf16 v[136:139], v[24:27], v[72:75], v[136:139]
    buffer_load_dwordx4 v8, s[48:51], s14 offen lds
    s_add_u32 s14, s14, 576
    v_mfma_f32_16x16x32_bf16 v[140:143], v[24:27], v[76:79], v[140:143]
    ds_read_b64_tr_b16 v[24:25], v3 offset:32
    ds_read_b64_tr_b16 v[26:27], v3 offset:2336
    v_mfma_f32_16x16x32_bf16 v[144:147], v[28:31], v[64:67], v[144:147]
    s_add_u32 m0, s9, 0
    v_mfma_f32_16x16x32_bf16 v[148:151], v[28:31], v[68:71], v[148:151]
    buffer_load_dwordx4 v9, s[44:47], s7 offen sc1 lds
    v_mfma_f32_16x16x32_bf16 v[152:155], v[28:31], v[72:75], v[152:155]
    s_add_u32 m0, s9, 1024
    v_mfma_f32_16x16x32_bf16 v[156:159], v[28:31], v[76:79], v[156:159]
    ds_read_b64_tr_b16 v[28:29], v3 offset:9280
    ds_read_b64_tr_b16 v[30:31], v3 offset:11584
    v_mfma_f32_16x16x32_bf16 v[160:163], v[32:35], v[64:67], v[160:163]
    buffer_load_dwordx4 v10, s[44:47], s7 offen sc1 lds
    v_mfma_f32_16x16x32_bf16 v[164:167], v[32:35], v[68:71], v[164:167]
    s_add_u32 s7, s7, 73728
    v_mfma_f32_16x16x32_bf16 v[168:171], v[32:35], v[72:75], v[168:171]
    s_add_u32 m0, s8, 25664
    v_mfma_f32_16x16x32_bf16 v[172:175], v[32:35], v[76:79], v[172:175]
    ds_read_b64_tr_b16 v[32:33], v2 offset:64
    ds_read_b64_tr_b16 v[34:35], v2 offset:2368
    v_mfma_f32_16x16x32_bf16 v[176:179], v[36:39], v[64:67], v[176:179]
    buffer_load_dwordx4 v7, s[40:43], s6 offen lds
    v_mfma_f32_16x16x32_bf16 v[180:183], v[36:39], v[68:71], v[180:183]
    s_add_u32 s6, s6, 18432
    v_mfma_f32_16x16x32_bf16 v[184:187], v[36:39], v[72:75], v[184:187]
    s_mov_b32 m0, 46176
    v_mfma_f32_16x16x32_bf16 v[188:191], v[36:39], v[76:79], v[188:191]
    ds_read_b64_tr_b16 v[36:37], v2 offset:9312
    v_mfma_f32_16x16x32_bf16 v[192:195], v[40:43], v[64:67], v[192:195]
    ds_read_b64_tr_b16 v[38:39], v2 offset:11616
    v_mfma_f32_16x16x32_bf16 v[196:199], v[40:43], v[68:71], v[196:199]
    buffer_load_dwordx4 v8, s[48:51], s14 offen lds
    v_mfma_f32_16x16x32_bf16 v[200:203], v[40:43], v[72:75], v[200:203]
    s_add_u32 s14, s14, 576
    v_mfma_f32_16x16x32_bf16 v[204:207], v[40:43], v[76:79], v[204:207]
    ds_read_b64_tr_b16 v[40:41], v5 offset:0
    v_mfma_f32_16x16x32_bf16 v[208:211], v[44:47], v[64:67], v[208:211]
    ds_read_b64_tr_b16 v[42:43], v5 offset:256
    v_mfma_f32_16x16x32_bf16 v[212:215], v[44:47], v[68:71], v[212:215]
    s_add_u32 m0, s9, 25664
    v_mfma_f32_16x16x32_bf16 v[216:219], v[44:47], v[72:75], v[216:219]
    buffer_load_dwordx4 v9, s[44:47], s7 offen sc1 lds
    v_mfma_f32_16x16x32_bf16 v[220:223], v[44:47], v[76:79], v[220:223]
    ds_read_b64_tr_b16 v[44:45], v5 offset:1024
    v_mfma_f32_16x16x32_bf16 v[224:227], v[48:51], v[64:67], v[224:227]
    ds_read_b64_tr_b16 v[46:47], v5 offset:1280
    v_mfma_f32_16x16x32_bf16 v[228:231], v[48:51], v[68:71], v[228:231]
    s_add_u32 m0, s9, 26688
    v_mfma_f32_16x16x32_bf16 v[232:235], v[48:51], v[72:75], v[232:235]
    buffer_load_dwordx4 v10, s[44:47], s7 offen sc1 lds
    v_mfma_f32_16x16x32_bf16 v[236:239], v[48:51], v[76:79], v[236:239]
    s_sub_u32 s7, s7, 72704
    s_waitcnt vmcnt(8) lgkmcnt(0)
    s_barrier
    v_mfma_f32_16x16x32_bf16 v[96:99], v[16:19], v[80:83], v[96:99]
    v_subrev_u32 v4, 51328, v4
    v_subrev_u32 v6, 51328, v6
    v_mfma_f32_16x16x32_bf16 v[100:103], v[16:19], v[84:87], v[100:103]
    v_subrev_u32 v2, 51328, v2
    v_subrev_u32 v3, 51328, v3
    v_mfma_f32_16x16x32_bf16 v[104:107], v[16:19], v[88:91], v[104:107]
    v_subrev_u32 v5, 51328, v5
    ds_read_b128 v[64:67], v4 offset:0
    v_mfma_f32_16x16x32_bf16 v[108:111], v[16:19], v[92:95], v[108:111]
    ds_read_b64_tr_b16 v[16:17], v2 offset:0
    ds_read_b64_tr_b16 v[18:19], v2 offset:2304
    v_mfma_f32_16x16x32_bf16 v[112:115], v[20:23], v[80:83], v[112:115]
    ds_read_b128 v[68:71], v4 offset:1024
    ds_read_b128 v[72:75], v4 offset:2048
    v_mfma_f32_16x16x32_bf16 v[116:119], v[20:23], v[84:87], v[116:119]
    ds_read_b128 v[76:79], v4 offset:3072
    ds_read_b64_tr_b16 v[48:49], v6 offset:0
    v_mfma_f32_16x16x32_bf16 v[120:123], v[20:23], v[88:91], v[120:123]
    ds_read_b64_tr_b16 v[50:51], v6 offset:256
    s_add_u32 m0, s8, 102656
    v_mfma_f32_16x16x32_bf16 v[124:127], v[20:23], v[92:95], v[124:127]
    ds_read_b64_tr_b16 v[20:21], v2 offset:9248
    ds_read_b64_tr_b16 v[22:23], v2 offset:11552
    v_mfma_f32_16x16x32_bf16 v[128:131], v[24:27], v[80:83], v[128:131]
    buffer_load_dwordx4 v7, s[40:43], s6 offen lds
    s_add_u32 s6, s6, 18432
    v_mfma_f32_16x16x32_bf16 v[132:135], v[24:27], v[84:87], v[132:135]
    s_mov_b32 m0, 123168
    v_mfma_f32_16x16x32_bf16 v[136:139], v[24:27], v[88:91], v[136:139]
    buffer_load_dwordx4 v8, s[48:51], s14 offen lds
    s_add_u32 s14, s14, 576
    v_mfma_f32_16x16x32_bf16 v[140:143], v[24:27], v[92:95], v[140:143]
    ds_read_b64_tr_b16 v[24:25], v3 offset:32
    ds_read_b64_tr_b16 v[26:27], v3 offset:2336
    v_mfma_f32_16x16x32_bf16 v[144:147], v[28:31], v[80:83], v[144:147]
    s_add_u32 m0, s9, 102656
    v_mfma_f32_16x16x32_bf16 v[148:151], v[28:31], v[84:87], v[148:151]
    buffer_load_dwordx4 v9, s[44:47], s7 offen sc1 lds
    v_mfma_f32_16x16x32_bf16 v[152:155], v[28:31], v[88:91], v[152:155]
    s_add_u32 m0, s9, 103680
    v_mfma_f32_16x16x32_bf16 v[156:159], v[28:31], v[92:95], v[156:159]
    ds_read_b64_tr_b16 v[28:29], v3 offset:9280
    ds_read_b64_tr_b16 v[30:31], v3 offset:11584
    v_mfma_f32_16x16x32_bf16 v[160:163], v[32:35], v[80:83], v[160:163]
    buffer_load_dwordx4 v10, s[44:47], s7 offen sc1 lds
    v_mfma_f32_16x16x32_bf16 v[164:167], v[32:35], v[84:87], v[164:167]
    s_add_u32 s7, s7, 73728
    v_mfma_f32_16x16x32_bf16 v[168:171], v[32:35], v[88:91], v[168:171]
    s_add_u32 m0, s8, 128320
    v_mfma_f32_16x16x32_bf16 v[172:175], v[32:35], v[92:95], v[172:175]
    ds_read_b64_tr_b16 v[32:33], v2 offset:64
    ds_read_b64_tr_b16 v[34:35], v2 offset:2368
    v_mfma_f32_16x16x32_bf16 v[176:179], v[36:39], v[80:83], v[176:179]
    buffer_load_dwordx4 v7, s[40:43], s6 offen lds
    v_mfma_f32_16x16x32_bf16 v[180:183], v[36:39], v[84:87], v[180:183]
    s_add_u32 s6, s6, 18432
    v_mfma_f32_16x16x32_bf16 v[184:187], v[36:39], v[88:91], v[184:187]
    s_mov_b32 m0, 148832
    v_mfma_f32_16x16x32_bf16 v[188:191], v[36:39], v[92:95], v[188:191]
    ds_read_b64_tr_b16 v[36:37], v2 offset:9312
    v_mfma_f32_16x16x32_bf16 v[192:195], v[40:43], v[80:83], v[192:195]
    ds_read_b64_tr_b16 v[38:39], v2 offset:11616
    v_mfma_f32_16x16x32_bf16 v[196:199], v[40:43], v[84:87], v[196:199]
    buffer_load_dwordx4 v8, s[48:51], s14 offen lds
    v_mfma_f32_16x16x32_bf16 v[200:203], v[40:43], v[88:91], v[200:203]
    s_add_u32 s14, s14, 576
    v_mfma_f32_16x16x32_bf16 v[204:207], v[40:43], v[92:95], v[204:207]
    ds_read_b64_tr_b16 v[40:41], v5 offset:0
    v_mfma_f32_16x16x32_bf16 v[208:211], v[44:47], v[80:83], v[208:211]
    ds_read_b64_tr_b16 v[42:43], v5 offset:256
    v_mfma_f32_16x16x32_bf16 v[212:215], v[44:47], v[84:87], v[212:215]
    s_add_u32 m0, s9, 128320
    v_mfma_f32_16x16x32_bf16 v[216:219], v[44:47], v[88:91], v[216:219]
    buffer_load_dwordx4 v9, s[44:47], s7 offen sc1 lds
    v_mfma_f32_16x16x32_bf16 v[220:223], v[44:47], v[92:95], v[220:223]
    ds_read_b64_tr_b16 v[44:45], v5 offset:1024
    v_mfma_f32_16x16x32_bf16 v[224:227], v[56:59], v[80:83], v[224:227]
    ds_read_b64_tr_b16 v[46:47], v5 offset:1280
    v_mfma_f32_16x16x32_bf16 v[228:231], v[56:59], v[84:87], v[228:231]
    s_add_u32 m0, s9, 129344
    v_mfma_f32_16x16x32_bf16 v[232:235], v[56:59], v[88:91], v[232:235]
    buffer_load_dwordx4 v10, s[44:47], s7 offen sc1 lds
    v_mfma_f32_16x16x32_bf16 v[236:239], v[56:59], v[92:95], v[236:239]
    s_sub_u32 s7, s7, 72704
    s_waitcnt vmcnt(8) lgkmcnt(0)
    s_barrier
    v_mfma_f32_16x16x32_bf16 v[96:99], v[16:19], v[64:67], v[96:99]
    v_subrev_u32 v4, 51328, v4
    v_subrev_u32 v6, 51328, v6
    v_mfma_f32_16x16x32_bf16 v[100:103], v[16:19], v[68:71], v[100:103]
    v_subrev_u32 v2, 51328, v2
    v_subrev_u32 v3, 51328, v3
    v_mfma_f32_16x16x32_bf16 v[104:107], v[16:19], v[72:75], v[104:107]
    v_subrev_u32 v5, 51328, v5
    ds_read_b128 v[80:83], v4 offset:0
    v_mfma_f32_16x16x32_bf16 v[108:111], v[16:19], v[76:79], v[108:111]
    ds_read_b64_tr_b16 v[16:17], v2 offset:0
    ds_read_b64_tr_b16 v[18:19], v2 offset:2304
    v_mfma_f32_16x16x32_bf16 v[112:115], v[20:23], v[64:67], v[112:115]
    ds_read_b128 v[84:87], v4 offset:1024
    ds_read_b128 v[88:91], v4 offset:2048
    v_mfma_f32_16x16x32_bf16 v[116:119], v[20:23], v[68:71], v[116:119]
    ds_read_b128 v[92:95], v4 offset:3072
    ds_read_b64_tr_b16 v[56:57], v6 offset:0
    v_mfma_f32_16x16x32_bf16 v[120:123], v[20:23], v[72:75], v[120:123]
    ds_read_b64_tr_b16 v[58:59], v6 offset:256
    s_add_u32 m0, s8, 51328
    v_mfma_f32_16x16x32_bf16 v[124:127], v[20:23], v[76:79], v[124:127]
    ds_read_b64_tr_b16 v[20:21], v2 offset:9248
    ds_read_b64_tr_b16 v[22:23], v2 offset:11552
    v_mfma_f32_16x16x32_bf16 v[128:131], v[24:27], v[64:67], v[128:131]
    buffer_load_dwordx4 v7, s[40:43], s6 offen lds
    s_add_u32 s6, s6, 18432
    v_mfma_f32_16x16x32_bf16 v[132:135], v[24:27], v[68:71], v[132:135]
    s_mov_b32 m0, 71840
    v_mfma_f32_16x16x32_bf16 v[136:139], v[24:27], v[72:75], v[136:139]
    buffer_load_dwordx4 v8, s[48:51], s14 offen lds
    s_add_u32 s14, s14, 576
    v_mfma_f32_16x16x32_bf16 v[140:143], v[24:27], v[76:79], v[140:143]
    ds_read_b64_tr_b16 v[24:25], v3 offset:32
    ds_read_b64_tr_b16 v[26:27], v3 offset:2336
    v_mfma_f32_16x16x32_bf16 v[144:147], v[28:31], v[64:67], v[144:147]
    s_add_u32 m0, s9, 51328
    v_mfma_f32_16x16x32_bf16 v[148:151], v[28:31], v[68:71], v[148:151]
    buffer_load_dwordx4 v9, s[44:47], s7 offen sc1 lds
    v_mfma_f32_16x16x32_bf16 v[152:155], v[28:31], v[72:75], v[152:155]
    s_add_u32 m0, s9, 52352
    v_mfma_f32_16x16x32_bf16 v[156:159], v[28:31], v[76:79], v[156:159]
    ds_read_b64_tr_b16 v[28:29], v3 offset:9280
    ds_read_b64_tr_b16 v[30:31], v3 offset:11584
    v_mfma_f32_16x16x32_bf16 v[160:163], v[32:35], v[64:67], v[160:163]
    buffer_load_dwordx4 v10, s[44:47], s7 offen sc1 lds
    v_mfma_f32_16x16x32_bf16 v[164:167], v[32:35], v[68:71], v[164:167]
    s_add_u32 s7, s7, 73728
    v_mfma_f32_16x16x32_bf16 v[168:171], v[32:35], v[72:75], v[168:171]
    s_add_u32 m0, s8, 76992
    v_mfma_f32_16x16x32_bf16 v[172:175], v[32:35], v[76:79], v[172:175]
    ds_read_b64_tr_b16 v[32:33], v2 offset:64
    ds_read_b64_tr_b16 v[34:35], v2 offset:2368
    v_mfma_f32_16x16x32_bf16 v[176:179], v[36:39], v[64:67], v[176:179]
    buffer_load_dwordx4 v7, s[40:43], s6 offen lds
    v_mfma_f32_16x16x32_bf16 v[180:183], v[36:39], v[68:71], v[180:183]
    s_add_u32 s6, s6, 18432
    v_mfma_f32_16x16x32_bf16 v[184:187], v[36:39], v[72:75], v[184:187]
    s_mov_b32 m0, 97504
    v_mfma_f32_16x16x32_bf16 v[188:191], v[36:39], v[76:79], v[188:191]
    ds_read_b64_tr_b16 v[36:37], v2 offset:9312
    v_mfma_f32_16x16x32_bf16 v[192:195], v[40:43], v[64:67], v[192:195]
    ds_read_b64_tr_b16 v[38:39], v2 offset:11616
    v_mfma_f32_16x16x32_bf16 v[196:199], v[40:43], v[68:71], v[196:199]
    buffer_load_dwordx4 v8, s[48:51], s14 offen lds
    v_mfma_f32_16x16x32_bf16 v[200:203], v[40:43], v[72:75], v[200:203]
    s_add_u32 s14, s14, 576
    v_mfma_f32_16x16x32_bf16 v[204:207], v[40:43], v[76:79], v[204:207]
    ds_read_b64_tr_b16 v[40:41], v5 offset:0
    v_mfma_f32_16x16x32_bf16 v[208:211], v[44:47], v[64:67], v[208:211]
    ds_read_b64_tr_b16 v[42:43], v5 offset:256
    v_mfma_f32_16x16x32_bf16 v[212:215], v[44:47], v[68:71], v[212:215]
    s_add_u32 m0, s9, 76992
    v_mfma_f32_16x16x32_bf16 v[216:219], v[44:47], v[72:75], v[216:219]
    buffer_load_dwordx4 v9, s[44:47], s7 offen sc1 lds
    v_mfma_f32_16x16x32_bf16 v[220:223], v[44:47], v[76:79], v[220:223]
    ds_read_b64_tr_b16 v[44:45], v5 offset:1024
    v_mfma_f32_16x16x32_bf16 v[224:227], v[48:51], v[64:67], v[224:227]
    ds_read_b64_tr_b16 v[46:47], v5 offset:1280
    v_mfma_f32_16x16x32_bf16 v[228:231], v[48:51], v[68:71], v[228:231]
    s_add_u32 m0, s9, 78016
    v_mfma_f32_16x16x32_bf16 v[232:235], v[48:51], v[72:75], v[232:235]
    buffer_load_dwordx4 v10, s[44:47], s7 offen sc1 lds
    v_mfma_f32_16x16x32_bf16 v[236:239], v[48:51], v[76:79], v[236:239]
    s_sub_u32 s7, s7, 72704
    s_waitcnt vmcnt(8) lgkmcnt(0)
    s_barrier
    v_mfma_f32_16x16x32_bf16 v[96:99], v[16:19], v[80:83], v[96:99]
    v_add_u32 v4, 102656, v4
    v_add_u32 v6, 102656, v6
    v_mfma_f32_16x16x32_bf16 v[100:103], v[16:19], v[84:87], v[100:103]
    v_add_u32 v2, 102656, v2
    v_add_u32 v3, 102656, v3
    v_mfma_f32_16x16x32_bf16 v[104:107], v[16:19], v[88:91], v[104:107]
    v_add_u32 v5, 102656, v5
    ds_read_b128 v[64:67], v4 offset:0
    v_mfma_f32_16x16x32_bf16 v[108:111], v[16:19], v[92:95], v[108:111]
    ds_read_b64_tr_b16 v[16:17], v2 offset:0
    ds_read_b64_tr_b16 v[18:19], v2 offset:2304
    v_mfma_f32_16x16x32_bf16 v[112:115], v[20:23], v[80:83], v[112:115]
    ds_read_b128 v[68:71], v4 offset:1024
    ds_read_b128 v[72:75], v4 offset:2048
    v_mfma_f32_16x16x32_bf16 v[116:119], v[20:23], v[84:87], v[116:119]
    ds_read_b128 v[76:79], v4 offset:3072
    ds_read_b64_tr_b16 v[48:49], v6 offset:0
    v_mfma_f32_16x16x32_bf16 v[120:123], v[20:23], v[88:91], v[120:123]
    ds_read_b64_tr_b16 v[50:51], v6 offset:256
    s_add_u32 m0, s8, 0
    v_mfma_f32_16x16x32_bf16 v[124:127], v[20:23], v[92:95], v[124:127]
    ds_read_b64_tr_b16 v[20:21], v2 offset:9248
    ds_read_b64_tr_b16 v[22:23], v2 offset:11552
    v_mfma_f32_16x16x32_bf16 v[128:131], v[24:27], v[80:83], v[128:131]
    buffer_load_dwordx4 v7, s[40:43], s6 offen lds
    s_add_u32 s6, s6, 18432
    v_mfma_f32_16x16x32_bf16 v[132:135], v[24:27], v[84:87], v[132:135]
    s_mov_b32 m0, 20512
    v_mfma_f32_16x16x32_bf16 v[136:139], v[24:27], v[88:91], v[136:139]
    buffer_load_dwordx4 v8, s[48:51], s14 offen lds
    s_add_u32 s14, s14, 576
    v_mfma_f32_16x16x32_bf16 v[140:143], v[24:27], v[92:95], v[140:143]
    ds_read_b64_tr_b16 v[24:25], v3 offset:32
    ds_read_b64_tr_b16 v[26:27], v3 offset:2336
    v_mfma_f32_16x16x32_bf16 v[144:147], v[28:31], v[80:83], v[144:147]
    s_add_u32 m0, s9, 0
    v_mfma_f32_16x16x32_bf16 v[148:151], v[28:31], v[84:87], v[148:151]
    buffer_load_dwordx4 v9, s[44:47], s7 offen sc1 lds
    v_mfma_f32_16x16x32_bf16 v[152:155], v[28:31], v[88:91], v[152:155]
    s_add_u32 m0, s9, 1024
    v_mfma_f32_16x16x32_bf16 v[156:159], v[28:31], v[92:95], v[156:159]
    ds_read_b64_tr_b16 v[28:29], v3 offset:9280
    ds_read_b64_tr_b16 v[30:31], v3 offset:11584
    v_mfma_f32_16x16x32_bf16 v[160:163], v[32:35], v[80:83], v[160:163]
    buffer_load_dwordx4 v10, s[44:47], s7 offen sc1 lds
    v_mfma_f32_16x16x32_bf16 v[164:167], v[32:35], v[84:87], v[164:167]
    s_add_u32 s7, s7, 73728
    v_mfma_f32_16x16x32_bf16 v[168:171], v[32:35], v[88:91], v[168:171]
    s_add_u32 m0, s8, 25664
    v_mfma_f32_16x16x32_bf16 v[172:175], v[32:35], v[92:95], v[172:175]
    ds_read_b64_tr_b16 v[32:33], v2 offset:64
    ds_read_b64_tr_b16 v[34:35], v2 offset:2368
    v_mfma_f32_16x16x32_bf16 v[176:179], v[36:39], v[80:83], v[176:179]
    buffer_load_dwordx4 v7, s[40:43], s6 offen lds
    v_mfma_f32_16x16x32_bf16 v[180:183], v[36:39], v[84:87], v[180:183]
    s_add_u32 s6, s6, 18432
    v_mfma_f32_16x16x32_bf16 v[184:187], v[36:39], v[88:91], v[184:187]
    s_mov_b32 m0, 46176
    v_mfma_f32_16x16x32_bf16 v[188:191], v[36:39], v[92:95], v[188:191]
    ds_read_b64_tr_b16 v[36:37], v2 offset:9312
    v_mfma_f32_16x16x32_bf16 v[192:195], v[40:43], v[80:83], v[192:195]
    ds_read_b64_tr_b16 v[38:39], v2 offset:11616
    v_mfma_f32_16x16x32_bf16 v[196:199], v[40:43], v[84:87], v[196:199]
    buffer_load_dwordx4 v8, s[48:51], s14 offen lds
    v_mfma_f32_16x16x32_bf16 v[200:203], v[40:43], v[88:91], v[200:203]
    s_add_u32 s14, s14, 576
    v_mfma_f32_16x16x32_bf16 v[204:207], v[40:43], v[92:95], v[204:207]
    ds_read_b64_tr_b16 v[40:41], v5 offset:0
    v_mfma_f32_16x16x32_bf16 v[208:211], v[44:47], v[80:83], v[208:211]
    ds_read_b64_tr_b16 v[42:43], v5 offset:256
    v_mfma_f32_16x16x32_bf16 v[212:215], v[44:47], v[84:87], v[212:215]
    s_add_u32 m0, s9, 25664
    v_mfma_f32_16x16x32_bf16 v[216:219], v[44:47], v[88:91], v[216:219]
    buffer_load_dwordx4 v9, s[44:47], s7 offen sc1 lds
    v_mfma_f32_16x16x32_bf16 v[220:223], v[44:47], v[92:95], v[220:223]
    ds_read_b64_tr_b16 v[44:45], v5 offset:1024
    v_mfma_f32_16x16x32_bf16 v[224:227], v[56:59], v[80:83], v[224:227]
    ds_read_b64_tr_b16 v[46:47], v5 offset:1280
    v_mfma_f32_16x16x32_bf16 v[228:231], v[56:59], v[84:87], v[228:231]
    s_add_u32 m0, s9, 26688
    v_mfma_f32_16x16x32_bf16 v[232:235], v[56:59], v[88:91], v[232:235]
    buffer_load_dwordx4 v10, s[44:47], s7 offen sc1 lds
    v_mfma_f32_16x16x32_bf16 v[236:239], v[56:59], v[92:95], v[236:239]
    s_sub_u32 s7, s7, 72704
    s_waitcnt vmcnt(8) lgkmcnt(0)
    s_barrier
    v_mfma_f32_16x16x32_bf16 v[96:99], v[16:19], v[64:67], v[96:99]
    v_subrev_u32 v4, 51328, v4
    v_subrev_u32 v6, 51328, v6
    v_mfma_f32_16x16x32_bf16 v[100:103], v[16:19], v[68:71], v[100:103]
    v_subrev_u32 v2, 51328, v2
    v_subrev_u32 v3, 51328, v3
    v_mfma_f32_16x16x32_bf16 v[104:107], v[16:19], v[72:75], v[104:107]
    v_subrev_u32 v5, 51328, v5
    ds_read_b128 v[80:83], v4 offset:0
    v_mfma_f32_16x16x32_bf16 v[108:111], v[16:19], v[76:79], v[108:111]
    ds_read_b64_tr_b16 v[16:17], v2 offset:0
    ds_read_b64_tr_b16 v[18:19], v2 offset:2304
    v_mfma_f32_16x16x32_bf16 v[112:115], v[20:23], v[64:67], v[112:115]
    ds_read_b128 v[84:87], v4 offset:1024
    ds_read_b128 v[88:91], v4 offset:2048
    v_mfma_f32_16x16x32_bf16 v[116:119], v[20:23], v[68:71], v[116:119]
    ds_read_b128 v[92:95], v4 offset:3072
    ds_read_b64_tr_b16 v[56:57], v6 offset:0
    v_mfma_f32_16x16x32_bf16 v[120:123], v[20:23], v[72:75], v[120:123]
    ds_read_b64_tr_b16 v[58:59], v6 offset:256
    s_add_u32 m0, s8, 102656
    v_mfma_f32_16x16x32_bf16 v[124:127], v[20:23], v[76:79], v[124:127]
    ds_read_b64_tr_b16 v[20:21], v2 offset:9248
    ds_read_b64_tr_b16 v[22:23], v2 offset:11552
    v_mfma_f32_16x16x32_bf16 v[128:131], v[24:27], v[64:67], v[128:131]
    buffer_load_dwordx4 v7, s[40:43], s6 offen lds
    s_add_u32 s6, s6, 18432
    v_mfma_f32_16x16x32_bf16 v[132:135], v[24:27], v[68:71], v[132:135]
    s_mov_b32 m0, 123168
    v_mfma_f32_16x16x32_bf16 v[136:139], v[24:27], v[72:75], v[136:139]
    buffer_load_dwordx4 v8, s[48:51], s14 offen lds
    s_add_u32 s14, s14, 576
    v_mfma_f32_16x16x32_bf16 v[140:143], v[24:27], v[76:79], v[140:143]
    ds_read_b64_tr_b16 v[24:25], v3 offset:32
    ds_read_b64_tr_b16 v[26:27], v3 offset:2336
    v_mfma_f32_16x16x32_bf16 v[144:147], v[28:31], v[64:67], v[144:147]
    s_add_u32 m0, s9, 102656
    v_mfma_f32_16x16x32_bf16 v[148:151], v[28:31], v[68:71], v[148:151]
    buffer_load_dwordx4 v9, s[44:47], s7 offen sc1 lds
    v_mfma_f32_16x16x32_bf16 v[152:155], v[28:31], v[72:75], v[152:155]
    s_add_u32 m0, s9, 103680
    v_mfma_f32_16x16x32_bf16 v[156:159], v[28:31], v[76:79], v[156:159]
    ds_read_b64_tr_b16 v[28:29], v3 offset:9280
    ds_read_b64_tr_b16 v[30:31], v3 offset:11584
    v_mfma_f32_16x16x32_bf16 v[160:163], v[32:35], v[64:67], v[160:163]
    buffer_load_dwordx4 v10, s[44:47], s7 offen sc1 lds
    v_mfma_f32_16x16x32_bf16 v[164:167], v[32:35], v[68:71], v[164:167]
    s_add_u32 s7, s7, 73728
    v_mfma_f32_16x16x32_bf16 v[168:171], v[32:35], v[72:75], v[168:171]
    s_add_u32 m0, s8, 128320
    v_mfma_f32_16x16x32_bf16 v[172:175], v[32:35], v[76:79], v[172:175]
    ds_read_b64_tr_b16 v[32:33], v2 offset:64
    ds_read_b64_tr_b16 v[34:35], v2 offset:2368
    v_mfma_f32_16x16x32_bf16 v[176:179], v[36:39], v[64:67], v[176:179]
    buffer_load_dwordx4 v7, s[40:43], s6 offen lds
    v_mfma_f32_16x16x32_bf16 v[180:183], v[36:39], v[68:71], v[180:183]
    s_add_u32 s6, s6, 18432
    v_mfma_f32_16x16x32_bf16 v[184:187], v[36:39], v[72:75], v[184:187]
    s_mov_b32 m0, 148832
    v_mfma_f32_16x16x32_bf16 v[188:191], v[36:39], v[76:79], v[188:191]
    ds_read_b64_tr_b16 v[36:37], v2 offset:9312
    v_mfma_f32_16x16x32_bf16 v[192:195], v[40:43], v[64:67], v[192:195]
    ds_read_b64_tr_b16 v[38:39], v2 offset:11616
    v_mfma_f32_16x16x32_bf16 v[196:199], v[40:43], v[68:71], v[196:199]
    buffer_load_dwordx4 v8, s[48:51], s14 offen lds
    v_mfma_f32_16x16x32_bf16 v[200:203], v[40:43], v[72:75], v[200:203]
    s_add_u32 s14, s14, 576
    v_mfma_f32_16x16x32_bf16 v[204:207], v[40:43], v[76:79], v[204:207]
    ds_read_b64_tr_b16 v[40:41], v5 offset:0
    v_mfma_f32_16x16x32_bf16 v[208:211], v[44:47], v[64:67], v[208:211]
    ds_read_b64_tr_b16 v[42:43], v5 offset:256
    v_mfma_f32_16x16x32_bf16 v[212:215], v[44:47], v[68:71], v[212:215]
    s_add_u32 m0, s9, 128320
    v_mfma_f32_16x16x32_bf16 v[216:219], v[44:47], v[72:75], v[216:219]
    buffer_load_dwordx4 v9, s[44:47], s7 offen sc1 lds
    v_mfma_f32_16x16x32_bf16 v[220:223], v[44:47], v[76:79], v[220:223]
    ds_read_b64_tr_b16 v[44:45], v5 offset:1024
    v_mfma_f32_16x16x32_bf16 v[224:227], v[48:51], v[64:67], v[224:227]
    ds_read_b64_tr_b16 v[46:47], v5 offset:1280
    v_mfma_f32_16x16x32_bf16 v[228:231], v[48:51], v[68:71], v[228:231]
    s_add_u32 m0, s9, 129344
    v_mfma_f32_16x16x32_bf16 v[232:235], v[48:51], v[72:75], v[232:235]
    buffer_load_dwordx4 v10, s[44:47], s7 offen sc1 lds
    v_mfma_f32_16x16x32_bf16 v[236:239], v[48:51], v[76:79], v[236:239]
    s_sub_u32 s7, s7, 72704
    s_sub_u32 s12, s12, 1
    s_cmp_lg_u32 s12, 0
    s_cbranch_scc1 G1B
    s_waitcnt vmcnt(8) lgkmcnt(0)
    s_barrier
    v_mfma_f32_16x16x32_bf16 v[96:99], v[16:19], v[80:83], v[96:99]
    v_subrev_u32 v4, 51328, v4
    v_subrev_u32 v6, 51328, v6
    v_mfma_f32_16x16x32_bf16 v[100:103], v[16:19], v[84:87], v[100:103]
    v_subrev_u32 v2, 51328, v2
    v_subrev_u32 v3, 51328, v3
    v_mfma_f32_16x16x32_bf16 v[104:107], v[16:19], v[88:91], v[104:107]
    v_subrev_u32 v5, 51328, v5
    ds_read_b128 v[64:67], v4 offset:0
    v_mfma_f32_16x16x32_bf16 v[108:111], v[16:19], v[92:95], v[108:111]
    ds_read_b64_tr_b16 v[16:17], v2 offset:0
    ds_read_b64_tr_b16 v[18:19], v2 offset:2304
    v_mfma_f32_16x16x32_bf16 v[112:115], v[20:23], v[80:83], v[112:115]
    ds_read_b128 v[68:71], v4 offset:1024
    ds_read_b128 v[72:75], v4 offset:2048
    v_mfma_f32_16x16x32_bf16 v[116:119], v[20:23], v[84:87], v[116:119]
    ds_read_b128 v[76:79], v4 offset:3072
    ds_read_b64_tr_b16 v[48:49], v6 offset:0
    v_mfma_f32_16x16x32_bf16 v[120:123], v[20:23], v[88:91], v[120:123]
    ds_read_b64_tr_b16 v[50:51], v6 offset:256
    s_add_u32 m0, s8, 51328
    v_mfma_f32_16x16x32_bf16 v[124:127], v[20:23], v[92:95], v[124:127]
    ds_read_b64_tr_b16 v[20:21], v2 offset:9248
    ds_read_b64_tr_b16 v[22:23], v2 offset:11552
    v_mfma_f32_16x16x32_bf16 v[128:131], v[24:27], v[80:83], v[128:131]
    buffer_load_dwordx4 v7, s[40:43], s6 offen lds
    s_add_u32 s6, s6, 18432
    v_mfma_f32_16x16x32_bf16 v[132:135], v[24:27], v[84:87], v[132:135]
    s_mov_b32 m0, 71840
    v_mfma_f32_16x16x32_bf16 v[136:139], v[24:27], v[88:91], v[136:139]
    buffer_load_dwordx4 v8, s[48:51], s14 offen lds
    s_add_u32 s14, s14, 576
    v_mfma_f32_16x16x32_bf16 v[140:143], v[24:27], v[92:95], v[140:143]
    ds_read_b64_tr_b16 v[24:25], v3 offset:32
    ds_read_b64_tr_b16 v[26:27], v3 offset:2336
    v_mfma_f32_16x16x32_bf16 v[144:147], v[28:31], v[80:83], v[144:147]
    s_add_u32 m0, s9, 51328
    v_mfma_f32_16x16x32_bf16 v[148:151], v[28:31], v[84:87], v[148:151]
    buffer_load_dwordx4 v9, s[44:47], s7 offen sc1 lds
    v_mfma_f32_16x16x32_bf16 v[152:155], v[28:31], v[88:91], v[152:155]
    s_add_u32 m0, s9, 52352
    v_mfma_f32_16x16x32_bf16 v[156:159], v[28:31], v[92:95], v[156:159]
    ds_read_b64_tr_b16 v[28:29], v3 offset:9280
    ds_read_b64_tr_b16 v[30:31], v3 offset:11584
    v_mfma_f32_16x16x32_bf16 v[160:163], v[32:35], v[80:83], v[160:163]
    buffer_load_dwordx4 v10, s[44:47], s7 offen sc1 lds
    v_mfma_f32_16x16x32_bf16 v[164:167], v[32:35], v[84:87], v[164:167]
    s_add_u32 s7, s7, 73728
    v_mfma_f32_16x16x32_bf16 v[168:171], v[32:35], v[88:91], v[168:171]
    s_add_u32 m0, s8, 76992
    v_mfma_f32_16x16x32_bf16 v[172:175], v[32:35], v[92:95], v[172:175]
    ds_read_b64_tr_b16 v[32:33], v2 offset:64
    ds_read_b64_tr_b16 v[34:35], v2 offset:2368
    v_mfma_f32_16x16x32_bf16 v[176:179], v[36:39], v[80:83], v[176:179]
    buffer_load_dwordx4 v7, s[40:43], s6 offen lds
    v_mfma_f32_16x16x32_bf16 v[180:183], v[36:39], v[84:87], v[180:183]
    s_add_u32 s6, s6, 18432
    v_mfma_f32_16x16x32_bf16 v[184:187], v[36:39], v[88:91], v[184:187]
    s_mov_b32 m0, 97504
    v_mfma_f32_16x16x32_bf16 v[188:191], v[36:39], v[92:95], v[188:191]
    ds_read_b64_tr_b16 v[36:37], v2 offset:9312
    v_mfma_f32_16x16x32_bf16 v[192:195], v[40:43], v[80:83], v[192:195]
    ds_read_b64_tr_b16 v[38:39], v2 offset:11616
    v_mfma_f32_16x16x32_bf16 v[196:199], v[40:43], v[84:87], v[196:199]
    buffer_load_dwordx4 v8, s[48:51], s14 offen lds
    v_mfma_f32_16x16x32_bf16 v[200:203], v[40:43], v[88:91], v[200:203]
    s_add_u32 s14, s14, 576
    v_mfma_f32_16x16x32_bf16 v[204:207], v[40:43], v[92:95], v[204:207]
    ds_read_b64_tr_b16 v[40:41], v5 offset:0
    v_mfma_f32_16x16x32_bf16 v[208:211], v[44:47], v[80:83], v[208:211]
    ds_read_b64_tr_b16 v[42:43], v5 offset:256
    v_mfma_f32_16x16x32_bf16 v[212:215], v[44:47], v[84:87], v[212:215]
    s_add_u32 m0, s9, 76992
    v_mfma_f32_16x16x32_bf16 v[216:219], v[44:47], v[88:91], v[216:219]
    buffer_load_dwordx4 v9, s[44:47], s7 offen sc1 lds
    v_mfma_f32_16x16x32_bf16 v[220:223], v[44:47], v[92:95], v[220:223]
    ds_read_b64_tr_b16 v[44:45], v5 offset:1024
    v_mfma_f32_16x16x32_bf16 v[224:227], v[56:59], v[80:83], v[224:227]
    ds_read_b64_tr_b16 v[46:47], v5 offset:1280
    v_mfma_f32_16x16x32_bf16 v[228:231], v[56:59], v[84:87], v[228:231]
    s_add_u32 m0, s9, 78016
    v_mfma_f32_16x16x32_bf16 v[232:235], v[56:59], v[88:91], v[232:235]
    buffer_load_dwordx4 v10, s[44:47], s7 offen sc1 lds
    v_mfma_f32_16x16x32_bf16 v[236:239], v[56:59], v[92:95], v[236:239]
    s_sub_u32 s7, s7, 72704
    s_waitcnt vmcnt(8) lgkmcnt(0)
    s_barrier
    v_mfma_f32_16x16x32_bf16 v[96:99], v[16:19], v[64:67], v[96:99]
    v_add_u32 v4, 102656, v4
    v_add_u32 v6, 102656, v6
    v_mfma_f32_16x16x32_bf16 v[100:103], v[16:19], v[68:71], v[100:103]
    v_add_u32 v2, 102656, v2
    v_add_u32 v3, 102656, v3
    v_mfma_f32_16x16x32_bf16 v[104:107], v[16:19], v[72:75], v[104:107]
    v_add_u32 v5, 102656, v5
    ds_read_b128 v[80:83], v4 offset:0
    v_mfma_f32_16x16x32_bf16 v[108:111], v[16:19], v[76:79], v[108:111]
    ds_read_b64_tr_b16 v[16:17], v2 offset:0
    ds_read_b64_tr_b16 v[18:19], v2 offset:2304
    v_mfma_f32_16x16x32_bf16 v[112:115], v[20:23], v[64:67], v[112:115]
    ds_read_b128 v[84:87], v4 offset:1024
    ds_read_b128 v[88:91], v4 offset:2048
    v_mfma_f32_16x16x32_bf16 v[116:119], v[20:23], v[68:71], v[116:119]
    ds_read_b128 v[92:95], v4 offset:3072
    ds_read_b64_tr_b16 v[56:57], v6 offset:0
    v_mfma_f32_16x16x32_bf16 v[120:123], v[20:23], v[72:75], v[120:123]
    ds_read_b64_tr_b16 v[58:59], v6 offset:256
    s_add_u32 m0, s8, 0
    v_mfma_f32_16x16x32_bf16 v[124:127], v[20:23], v[76:79], v[124:127]
    ds_read_b64_tr_b16 v[20:21], v2 offset:9248
    ds_read_b64_tr_b16 v[22:23], v2 offset:11552
    v_mfma_f32_16x16x32_bf16 v[128:131], v[24:27], v[64:67], v[128:131]
    buffer_load_dwordx4 v7, s[40:43], s6 offen lds
    s_add_u32 s6, s6, 18432
    v_mfma_f32_16x16x32_bf16 v[132:135], v[24:27], v[68:71], v[132:135]
    s_mov_b32 m0, 20512
    v_mfma_f32_16x16x32_bf16 v[136:139], v[24:27], v[72:75], v[136:139]
    buffer_load_dwordx4 v8, s[48:51], s14 offen lds
    s_add_u32 s14, s14, 576
    v_mfma_f32_16x16x32_bf16 v[140:143], v[24:27], v[76:79], v[140:143]
    ds_read_b64_tr_b16 v[24:25], v3 offset:32
    ds_read_b64_tr_b16 v[26:27], v3 offset:2336
    v_mfma_f32_16x16x32_bf16 v[144:147], v[28:31], v[64:67], v[144:147]
    s_add_u32 m0, s9, 0
    v_mfma_f32_16x16x32_bf16 v[148:151], v[28:31], v[68:71], v[148:151]
    buffer_load_dwordx4 v9, s[44:47], s7 offen sc1 lds
    v_mfma_f32_16x16x32_bf16 v[152:155], v[28:31], v[72:75], v[152:155]
    s_add_u32 m0, s9, 1024
    v_mfma_f32_16x16x32_bf16 v[156:159], v[28:31], v[76:79], v[156:159]
    ds_read_b64_tr_b16 v[28:29], v3 offset:9280
    ds_read_b64_tr_b16 v[30:31], v3 offset:11584
    v_mfma_f32_16x16x32_bf16 v[160:163], v[32:35], v[64:67], v[160:163]
    buffer_load_dwordx4 v10, s[44:47], s7 offen sc1 lds
    v_mfma_f32_16x16x32_bf16 v[164:167], v[32:35], v[68:71], v[164:167]
    s_add_u32 s7, s7, 73728
    v_mfma_f32_16x16x32_bf16 v[168:171], v[32:35], v[72:75], v[168:171]
    s_add_u32 m0, s8, 25664
    v_mfma_f32_16x16x32_bf16 v[172:175], v[32:35], v[76:79], v[172:175]
    ds_read_b64_tr_b16 v[32:33], v2 offset:64
    ds_read_b64_tr_b16 v[34:35], v2 offset:2368
    v_mfma_f32_16x16x32_bf16 v[176:179], v[36:39], v[64:67], v[176:179]
    buffer_load_dwordx4 v7, s[40:43], s6 offen lds
    v_mfma_f32_16x16x32_bf16 v[180:183], v[36:39], v[68:71], v[180:183]
    s_add_u32 s6, s6, 18432
    v_mfma_f32_16x16x32_bf16 v[184:187], v[36:39], v[72:75], v[184:187]
    s_mov_b32 m0, 46176
    v_mfma_f32_16x16x32_bf16 v[188:191], v[36:39], v[76:79], v[188:191]
    ds_read_b64_tr_b16 v[36:37], v2 offset:9312
    v_mfma_f32_16x16x32_bf16 v[192:195], v[40:43], v[64:67], v[192:195]
    ds_read_b64_tr_b16 v[38:39], v2 offset:11616
    v_mfma_f32_16x16x32_bf16 v[196:199], v[40:43], v[68:71], v[196:199]
    buffer_load_dwordx4 v8, s[48:51], s14 offen lds
    v_mfma_f32_16x16x32_bf16 v[200:203], v[40:43], v[72:75], v[200:203]
    s_add_u32 s14, s14, 576
    v_mfma_f32_16x16x32_bf16 v[204:207], v[40:43], v[76:79], v[204:207]
    ds_read_b64_tr_b16 v[40:41], v5 offset:0
    v_mfma_f32_16x16x32_bf16 v[208:211], v[44:47], v[64:67], v[208:211]
    ds_read_b64_tr_b16 v[42:43], v5 offset:256
    v_mfma_f32_16x16x32_bf16 v[212:215], v[44:47], v[68:71], v[212:215]
    s_add_u32 m0, s9, 25664
    v_mfma_f32_16x16x32_bf16 v[216:219], v[44:47], v[72:75], v[216:219]
    buffer_load_dwordx4 v9, s[44:47], s7 offen sc1 lds
    v_mfma_f32_16x16x32_bf16 v[220:223], v[44:47], v[76:79], v[220:223]
    ds_read_b64_tr_b16 v[44:45], v5 offset:1024
    v_mfma_f32_16x16x32_bf16 v[224:227], v[48:51], v[64:67], v[224:227]
    ds_read_b64_tr_b16 v[46:47], v5 offset:1280
    v_mfma_f32_16x16x32_bf16 v[228:231], v[48:51], v[68:71], v[228:231]
    s_add_u32 m0, s9, 26688
    v_mfma_f32_16x16x32_bf16 v[232:235], v[48:51], v[72:75], v[232:235]
    buffer_load_dwordx4 v10, s[44:47], s7 offen sc1 lds
    v_mfma_f32_16x16x32_bf16 v[236:239], v[48:51], v[76:79], v[236:239]
    s_sub_u32 s7, s7, 72704
    s_waitcnt vmcnt(8) lgkmcnt(0)
    s_barrier
    v_mfma_f32_16x16x32_bf16 v[96:99], v[16:19], v[80:83], v[96:99]
    v_subrev_u32 v4, 51328, v4
    v_subrev_u32 v6, 51328, v6
    v_mfma_f32_16x16x32_bf16 v[100:103], v[16:19], v[84:87], v[100:103]
    v_subrev_u32 v2, 51328, v2
    v_subrev_u32 v3, 51328, v3
    v_mfma_f32_16x16x32_bf16 v[104:107], v[16:19], v[88:91], v[104:107]
    v_subrev_u32 v5, 51328, v5
    ds_read_b128 v[64:67], v4 offset:0
    v_mfma_f32_16x16x32_bf16 v[108:111], v[16:19], v[92:95], v[108:111]
    ds_read_b64_tr_b16 v[16:17], v2 offset:0
    ds_read_b64_tr_b16 v[18:19], v2 offset:2304
    v_mfma_f32_16x16x32_bf16 v[112:115], v[20:23], v[80:83], v[112:115]
    ds_read_b128 v[68:71], v4 offset:1024
    ds_read_b128 v[72:75], v4 offset:2048
    v_mfma_f32_16x16x32_bf16 v[116:119], v[20:23], v[84:87], v[116:119]
    ds_read_b128 v[76:79], v4 offset:3072
    ds_read_b64_tr_b16 v[48:49], v6 offset:0
    v_mfma_f32_16x16x32_bf16 v[120:123], v[20:23], v[88:91], v[120:123]
    ds_read_b64_tr_b16 v[50:51], v6 offset:256
    s_mov_b32 s48, s32
    v_mfma_f32_16x16x32_bf16 v[124:127], v[20:23], v[92:95], v[124:127]
    ds_read_b64_tr_b16 v[20:21], v2 offset:9248
    ds_read_b64_tr_b16 v[22:23], v2 offset:11552
    v_mfma_f32_16x16x32_bf16 v[128:131], v[24:27], v[80:83], v[128:131]
    s_mov_b32 s49, s33
    v_mfma_f32_16x16x32_bf16 v[132:135], v[24:27], v[84:87], v[132:135]
    s_mov_b32 s50, 5308416
    v_mfma_f32_16x16x32_bf16 v[136:139], v[24:27], v[88:91], v[136:139]
    s_mov_b32 s51, 0x20000
    v_mfma_f32_16x16x32_bf16 v[140:143], v[24:27], v[92:95], v[140:143]
    ds_read_b64_tr_b16 v[24:25], v3 offset:32
    ds_read_b64_tr_b16 v[26:27], v3 offset:2336
    v_mfma_f32_16x16x32_bf16 v[144:147], v[28:31], v[80:83], v[144:147]
    s_lshr_b32 s56, s2, 3
    v_mfma_f32_16x16x32_bf16 v[148:151], v[28:31], v[84:87], v[148:151]
    s_mul_i32 s56, s56, 162
    v_mfma_f32_16x16x32_bf16 v[152:155], v[28:31], v[88:91], v[152:155]
    s_mul_i32 s57, s15, 81
    v_mfma_f32_16x16x32_bf16 v[156:159], v[28:31], v[92:95], v[156:159]
    ds_read_b64_tr_b16 v[28:29], v3 offset:9280
    v_mfma_f32_16x16x32_bf16 v[160:163], v[32:35], v[80:83], v[160:163]
    ds_read_b64_tr_b16 v[30:31], v3 offset:11584
    v_mfma_f32_16x16x32_bf16 v[164:167], v[32:35], v[84:87], v[164:167]
    s_add_u32 s56, s56, s57
    v_mfma_f32_16x16x32_bf16 v[168:171], v[32:35], v[88:91], v[168:171]
    s_lshl_b32 s56, s56, 7
    v_mfma_f32_16x16x32_bf16 v[172:175], v[32:35], v[92:95], v[172:175]
    ds_read_b64_tr_b16 v[32:33], v2 offset:64
    v_mfma_f32_16x16x32_bf16 v[176:179], v[36:39], v[80:83], v[176:179]
    ds_read_b64_tr_b16 v[34:35], v2 offset:2368
    v_mfma_f32_16x16x32_bf16 v[180:183], v[36:39], v[84:87], v[180:183]
    s_and_b32 s57, s2, 7
    v_mfma_f32_16x16x32_bf16 v[184:187], v[36:39], v[88:91], v[184:187]
    s_mul_i32 s57, s57, 663552
    v_mfma_f32_16x16x32_bf16 v[188:191], v[36:39], v[92:95], v[188:191]
    ds_read_b64_tr_b16 v[36:37], v2 offset:9312
    v_mfma_f32_16x16x32_bf16 v[192:195], v[40:43], v[80:83], v[192:195]
    ds_read_b64_tr_b16 v[38:39], v2 offset:11616
    v_mfma_f32_16x16x32_bf16 v[196:199], v[40:43], v[84:87], v[196:199]
    s_add_u32 s56, s56, s57
    v_mfma_f32_16x16x32_bf16 v[200:203], v[40:43], v[88:91], v[200:203]
    v_lshlrev_b32 v14, 7, v0
    v_mfma_f32_16x16x32_bf16 v[204:207], v[40:43], v[92:95], v[204:207]
    ds_read_b64_tr_b16 v[40:41], v5 offset:0
    v_mfma_f32_16x16x32_bf16 v[208:211], v[44:47], v[80:83], v[208:211]
    ds_read_b64_tr_b16 v[42:43], v5 offset:256
    v_mfma_f32_16x16x32_bf16 v[212:215], v[44:47], v[84:87], v[212:215]
    v_min_u32 v15, 16, v0
    v_mfma_f32_16x16x32_bf16 v[216:219], v[44:47], v[88:91], v[216:219]
    v_lshlrev_b32 v15, 7, v15
    v_mfma_f32_16x16x32_bf16 v[220:223], v[44:47], v[92:95], v[220:223]
    ds_read_b64_tr_b16 v[44:45], v5 offset:1024
    v_mfma_f32_16x16x32_bf16 v[224:227], v[56:59], v[80:83], v[224:227]
    ds_read_b64_tr_b16 v[46:47], v5 offset:1280
    v_mfma_f32_16x16x32_bf16 v[228:231], v[56:59], v[84:87], v[228:231]
    v_add_u32 v15, 8192, v15
    v_mfma_f32_16x16x32_bf16 v[232:235], v[56:59], v[88:91], v[232:235]
    buffer_load_dword v7, v14, s[48:51], s56 offen
    v_mfma_f32_16x16x32_bf16 v[236:239], v[56:59], v[92:95], v[236:239]
    buffer_load_dword v8, v15, s[48:51], s56 offen
    s_waitcnt vmcnt(2) lgkmcnt(0)
    s_barrier
    v_mfma_f32_16x16x32_bf16 v[96:99], v[16:19], v[64:67], v[96:99]
    v_subrev_u32 v4, 51328, v4
    v_mfma_f32_16x16x32_bf16 v[100:103], v[16:19], v[68:71], v[100:103]
    v_subrev_u32 v6, 51328, v6
    v_mfma_f32_16x16x32_bf16 v[104:107], v[16:19], v[72:75], v[104:107]
    v_subrev_u32 v2, 51328, v2
    v_mfma_f32_16x16x32_bf16 v[108:111], v[16:19], v[76:79], v[108:111]
    ds_read_b64_tr_b16 v[16:17], v2 offset:0
    v_mfma_f32_16x16x32_bf16 v[112:115], v[20:23], v[64:67], v[112:115]
    ds_read_b64_tr_b16 v[18:19], v2 offset:2304
    v_mfma_f32_16x16x32_bf16 v[116:119], v[20:23], v[68:71], v[116:119]
    v_subrev_u32 v3, 51328, v3
    v_mfma_f32_16x16x32_bf16 v[120:123], v[20:23], v[72:75], v[120:123]
    v_subrev_u32 v5, 51328, v5
    v_mfma_f32_16x16x32_bf16 v[124:127], v[20:23], v[76:79], v[124:127]
    ds_read_b64_tr_b16 v[20:21], v2 offset:9248
    v_mfma_f32_16x16x32_bf16 v[128:131], v[24:27], v[64:67], v[128:131]
    ds_read_b64_tr_b16 v[22:23], v2 offset:11552
    v_mfma_f32_16x16x32_bf16 v[132:135], v[24:27], v[68:71], v[132:135]
    ds_read_b128 v[80:83], v4 offset:0
    v_mfma_f32_16x16x32_bf16 v[136:139], v[24:27], v[72:75], v[136:139]
    ds_read_b128 v[84:87], v4 offset:1024
    v_mfma_f32_16x16x32_bf16 v[140:143], v[24:27], v[76:79], v[140:143]
    ds_read_b64_tr_b16 v[24:25], v3 offset:32
    v_mfma_f32_16x16x32_bf16 v[144:147], v[28:31], v[64:67], v[144:147]
    ds_read_b64_tr_b16 v[26:27], v3 offset:2336
    v_mfma_f32_16x16x32_bf16 v[148:151], v[28:31], v[68:71], v[148:151]
    ds_read_b128 v[88:91], v4 offset:2048
    v_mfma_f32_16x16x32_bf16 v[152:155], v[28:31], v[72:75], v[152:155]
    ds_read_b128 v[92:95], v4 offset:3072
    v_mfma_f32_16x16x32_bf16 v[156:159], v[28:31], v[76:79], v[156:159]
    ds_read_b64_tr_b16 v[28:29], v3 offset:9280
    v_mfma_f32_16x16x32_bf16 v[160:163], v[32:35], v[64:67], v[160:163]
    ds_read_b64_tr_b16 v[30:31], v3 offset:11584
    v_mfma_f32_16x16x32_bf16 v[164:167], v[32:35], v[68:71], v[164:167]
    ds_read_b64_tr_b16 v[56:57], v6 offset:0
    v_mfma_f32_16x16x32_bf16 v[168:171], v[32:35], v[72:75], v[168:171]
    ds_read_b64_tr_b16 v[58:59], v6 offset:256
    v_mfma_f32_16x16x32_bf16 v[172:175], v[32:35], v[76:79], v[172:175]
    ds_read_b64_tr_b16 v[32:33], v2 offset:64
    v_mfma_f32_16x16x32_bf16 v[176:179], v[36:39], v[64:67], v[176:179]
    ds_read_b64_tr_b16 v[34:35], v2 offset:2368
    v_mfma_f32_16x16x32_bf16 v[180:183], v[36:39], v[68:71], v[180:183]
    v_mfma_f32_16x16x32_bf16 v[184:187], v[36:39], v[72:75], v[184:187]
    v_mfma_f32_16x16x32_bf16 v[188:191], v[36:39], v[76:79], v[188:191]
    ds_read_b64_tr_b16 v[36:37], v2 offset:9312
    v_mfma_f32_16x16x32_bf16 v[192:195], v[40:43], v[64:67], v[192:195]
    ds_read_b64_tr_b16 v[38:39], v2 offset:11616
    v_mfma_f32_16x16x32_bf16 v[196:199], v[40:43], v[68:71], v[196:199]
    v_mfma_f32_16x16x32_bf16 v[200:203], v[40:43], v[72:75], v[200:203]
    v_mfma_f32_16x16x32_bf16 v[204:207], v[40:43], v[76:79], v[204:207]
    ds_read_b64_tr_b16 v[40:41], v5 offset:0
    v_mfma_f32_16x16x32_bf16 v[208:211], v[44:47], v[64:67], v[208:211]
    ds_read_b64_tr_b16 v[42:43], v5 offset:256
    v_mfma_f32_16x16x32_bf16 v[212:215], v[44:47], v[68:71], v[212:215]
    v_mfma_f32_16x16x32_bf16 v[216:219], v[44:47], v[72:75], v[216:219]
    v_mfma_f32_16x16x32_bf16 v[220:223], v[44:47], v[76:79], v[220:223]
    ds_read_b64_tr_b16 v[44:45], v5 offset:1024
    v_mfma_f32_16x16x32_bf16 v[224:227], v[48:51], v[64:67], v[224:227]
    ds_read_b64_tr_b16 v[46:47], v5 offset:1280
    v_mfma_f32_16x16x32_bf16 v[228:231], v[48:51], v[68:71], v[228:231]
    v_mfma_f32_16x16x32_bf16 v[232:235], v[48:51], v[72:75], v[232:235]
    v_mfma_f32_16x16x32_bf16 v[236:239], v[48:51], v[76:79], v[236:239]
    s_waitcnt vmcnt(0) lgkmcnt(0)
    s_barrier
    v_mfma_f32_16x16x32_bf16 v[96:99], v[16:19], v[80:83], v[96:99]
    v_lshrrev_b32 v72, 5, v0
    v_bfe_u32 v73, v0, 2, 2
    v_bfe_u32 v74, v0, 4, 1
    v_and_b32 v75, 3, v0
    s_lshr_b32 s56, s3, 1
    v_mfma_f32_16x16x32_bf16 v[100:103], v[16:19], v[84:87], v[100:103]
    s_and_b32 s57, s3, 1
    s_lshl_b32 s58, s57, 11
    v_add_u32 v6, s58, v1
    v_add_u32 v7, 36864, v6
    v_and_b32 v76, 15, v0
    v_mfma_f32_16x16x32_bf16 v[104:107], v[16:19], v[88:91], v[104:107]
    v_lshl_add_u32 v77, v74, 5, v76
    v_lshlrev_b32 v77, 4, v77
    v_lshl_add_u32 v77, v72, 3, v77
    s_mul_i32 s59, s56, 20480
    s_add_u32 s59, s59, s58
    v_mfma_f32_16x16x32_bf16 v[108:111], v[16:19], v[92:95], v[108:111]
    v_add_u32 v8, s59, v77
    s_mul_i32 s59, s57, 4608
    s_add_u32 s59, s59, 153984
    v_add_u32 v9, s59, v77
    v_mul_u32_u24 v10, 1152, v74
    v_mfma_f32_16x16x32_bf16 v[112:115], v[20:23], v[80:83], v[112:115]
    v_lshl_add_u32 v10, v76, 2, v10
    s_add_u32 s59, s59, 1024
    v_add_u32 v10, s59, v10
    s_mul_i32 s58, s56, 9
    s_cmp_ge_u32 s56, 2
    v_mfma_f32_16x16x32_bf16 v[116:119], v[20:23], v[84:87], v[116:119]
    s_cselect_b32 s59, 13, 0
    s_sub_u32 s13, s58, s59
    v_lshl_add_u32 v76, v72, 2, v73
    v_mul_u32_u24 v76, 1152, v76
    v_lshl_add_u32 v76, v74, 5, v76
    v_mfma_f32_16x16x32_bf16 v[120:123], v[20:23], v[88:91], v[120:123]
    v_lshl_add_u32 v76, v75, 3, v76
    v_lshrrev_b32 v77, 1, v73
    s_and_b32 s58, s13, 1
    v_xor_b32 v77, s58, v77
    v_lshl_add_u32 v2, v77, 6, v76
    v_mfma_f32_16x16x32_bf16 v[124:127], v[20:23], v[92:95], v[124:127]
    v_xor_b32 v77, 1, v77
    v_lshl_add_u32 v4, v77, 6, v76
    s_lshr_b32 s58, s13, 1
    s_lshl_b32 s58, s58, 7
    s_add_u32 s58, s58, 76992
    v_mfma_f32_16x16x32_bf16 v[128:131], v[24:27], v[80:83], v[128:131]
    v_add_u32 v2, s58, v2
    s_add_u32 s58, s13, 1
    s_lshr_b32 s58, s58, 1
    s_lshl_b32 s58, s58, 7
    s_add_u32 s58, s58, 76992
    v_mfma_f32_16x16x32_bf16 v[132:135], v[24:27], v[84:87], v[132:135]
    v_add_u32 v4, s58, v4
    v_add_u32 v3, 36864, v2
    v_add_u32 v5, 36864, v4
    s_mul_i32 s58, s3, 1152
    s_add_u32 s58, s58, 153984
    v_mfma_f32_16x16x32_bf16 v[136:139], v[24:27], v[88:91], v[136:139]
    v_add_u32 v14, s58, v1
    v_and_b32 v76, 31, v0
    v_lshlrev_b32 v76, 2, v76
    s_add_u32 s58, s58, 1024
    v_add_u32 v15, s58, v76
    v_mfma_f32_16x16x32_bf16 v[140:143], v[24:27], v[92:95], v[140:143]
    v_mfma_f32_16x16x32_bf16 v[144:147], v[28:31], v[80:83], v[144:147]
    v_mfma_f32_16x16x32_bf16 v[148:151], v[28:31], v[84:87], v[148:151]
    v_mfma_f32_16x16x32_bf16 v[152:155], v[28:31], v[88:91], v[152:155]
    v_mfma_f32_16x16x32_bf16 v[156:159], v[28:31], v[92:95], v[156:159]
    v_max_f32 v96, 0, v96
    v_max_f32 v97, 0, v97
    v_max_f32 v98, 0, v98
    v_max_f32 v99, 0, v99
    v_mul_f32 v96, v96, v112
    v_mfma_f32_16x16x32_bf16 v[160:163], v[32:35], v[80:83], v[160:163]
    v_mul_f32 v97, v97, v113
    v_mul_f32 v98, v98, v114
    v_mul_f32 v99, v99, v115
    v_cvt_pk_bf16_f32 v48, v96, v97
    v_cvt_pk_bf16_f32 v49, v98, v99
    v_mfma_f32_16x16x32_bf16 v[164:167], v[32:35], v[84:87], v[164:167]
    ds_write_b64 v8, v[48:49] offset:0
    v_max_f32 v100, 0, v100
    v_max_f32 v101, 0, v101
    v_max_f32 v102, 0, v102
    v_max_f32 v103, 0, v103
    v_mfma_f32_16x16x32_bf16 v[168:171], v[32:35], v[88:91], v[168:171]
    v_mul_f32 v100, v100, v116
    v_mul_f32 v101, v101, v117
    v_mul_f32 v102, v102, v118
    v_mul_f32 v103, v103, v119
    v_cvt_pk_bf16_f32 v50, v100, v101
    v_mfma_f32_16x16x32_bf16 v[172:175], v[32:35], v[92:95], v[172:175]
    v_cvt_pk_bf16_f32 v51, v102, v103
    ds_write_b64 v8, v[50:51] offset:256
    v_max_f32 v104, 0, v104
    v_max_f32 v105, 0, v105
    v_max_f32 v106, 0, v106
    v_mfma_f32_16x16x32_bf16 v[176:179], v[36:39], v[80:83], v[176:179]
    v_max_f32 v107, 0, v107
    v_mul_f32 v104, v104, v120
    v_mul_f32 v105, v105, v121
    v_mul_f32 v106, v106, v122
    v_mul_f32 v107, v107, v123
    v_mfma_f32_16x16x32_bf16 v[180:183], v[36:39], v[84:87], v[180:183]
    v_cvt_pk_bf16_f32 v52, v104, v105
    v_cvt_pk_bf16_f32 v53, v106, v107
    ds_write_b64 v8, v[52:53] offset:1024
    v_max_f32 v108, 0, v108
    v_max_f32 v109, 0, v109
    v_mfma_f32_16x16x32_bf16 v[184:187], v[36:39], v[88:91], v[184:187]
    v_max_f32 v110, 0, v110
    v_max_f32 v111, 0, v111
    v_mul_f32 v108, v108, v124
    v_mul_f32 v109, v109, v125
    v_mul_f32 v110, v110, v126
    v_mfma_f32_16x16x32_bf16 v[188:191], v[36:39], v[92:95], v[188:191]
    v_mul_f32 v111, v111, v127
    v_cvt_pk_bf16_f32 v54, v108, v109
    v_cvt_pk_bf16_f32 v55, v110, v111
    ds_write_b64 v8, v[54:55] offset:1280
    v_mfma_f32_16x16x32_bf16 v[192:195], v[40:43], v[80:83], v[192:195]
    v_max_f32 v128, 0, v128
    v_max_f32 v129, 0, v129
    v_max_f32 v130, 0, v130
    v_max_f32 v131, 0, v131
    v_mul_f32 v128, v128, v144
    v_mfma_f32_16x16x32_bf16 v[196:199], v[40:43], v[84:87], v[196:199]
    v_mul_f32 v129, v129, v145
    v_mul_f32 v130, v130, v146
    v_mul_f32 v131, v131, v147
    v_cvt_pk_bf16_f32 v48, v128, v129
    v_cvt_pk_bf16_f32 v49, v130, v131
    v_mfma_f32_16x16x32_bf16 v[200:203], v[40:43], v[88:91], v[200:203]
    ds_write_b64 v8, v[48:49] offset:4096
    v_max_f32 v132, 0, v132
    v_max_f32 v133, 0, v133
    v_max_f32 v134, 0, v134
    v_max_f32 v135, 0, v135
    v_mfma_f32_16x16x32_bf16 v[204:207], v[40:43], v[92:95], v[204:207]
    v_mul_f32 v132, v132, v148
    v_mul_f32 v133, v133, v149
    v_mul_f32 v134, v134, v150
    v_mul_f32 v135, v135, v151
    v_cvt_pk_bf16_f32 v50, v132, v133
    v_mfma_f32_16x16x32_bf16 v[208:211], v[44:47], v[80:83], v[208:211]
    v_cvt_pk_bf16_f32 v51, v134, v135
    ds_write_b64 v8, v[50:51] offset:4352
    v_max_f32 v136, 0, v136
    v_max_f32 v137, 0, v137
    v_max_f32 v138, 0, v138
    v_mfma_f32_16x16x32_bf16 v[212:215], v[44:47], v[84:87], v[212:215]
    v_max_f32 v139, 0, v139
    v_mul_f32 v136, v136, v152
    v_mul_f32 v137, v137, v153
    v_mul_f32 v138, v138, v154
    v_mul_f32 v139, v139, v155
    v_mfma_f32_16x16x32_bf16 v[216:219], v[44:47], v[88:91], v[216:219]
    v_cvt_pk_bf16_f32 v52, v136, v137
    v_cvt_pk_bf16_f32 v53, v138, v139
    ds_write_b64 v8, v[52:53] offset:5120
    v_max_f32 v140, 0, v140
    v_max_f32 v141, 0, v141
    v_mfma_f32_16x16x32_bf16 v[220:223], v[44:47], v[92:95], v[220:223]
    v_max_f32 v142, 0, v142
    v_max_f32 v143, 0, v143
    v_mul_f32 v140, v140, v156
    v_mul_f32 v141, v141, v157
    v_mul_f32 v142, v142, v158
    v_mfma_f32_16x16x32_bf16 v[224:227], v[56:59], v[80:83], v[224:227]
    v_mul_f32 v143, v143, v159
    v_cvt_pk_bf16_f32 v54, v140, v141
    v_cvt_pk_bf16_f32 v55, v142, v143
    ds_write_b64 v8, v[54:55] offset:5376
    v_mfma_f32_16x16x32_bf16 v[228:231], v[56:59], v[84:87], v[228:231]
    v_max_f32 v160, 0, v160
    v_max_f32 v161, 0, v161
    v_max_f32 v162, 0, v162
    v_max_f32 v163, 0, v163
    v_mul_f32 v160, v160, v176
    v_mfma_f32_16x16x32_bf16 v[232:235], v[56:59], v[88:91], v[232:235]
    v_mul_f32 v161, v161, v177
    v_mul_f32 v162, v162, v178
    v_mul_f32 v163, v163, v179
    v_cvt_pk_bf16_f32 v48, v160, v161
    v_cvt_pk_bf16_f32 v49, v162, v163
    v_mfma_f32_16x16x32_bf16 v[236:239], v[56:59], v[92:95], v[236:239]
    ds_write_b64 v8, v[48:49] offset:8192
    v_max_f32 v164, 0, v164
    v_max_f32 v165, 0, v165
    v_max_f32 v166, 0, v166
    v_max_f32 v167, 0, v167
    v_mul_f32 v164, v164, v180
    v_mul_f32 v165, v165, v181
    v_mul_f32 v166, v166, v182
    v_mul_f32 v167, v167, v183
    v_cvt_pk_bf16_f32 v50, v164, v165
    v_cvt_pk_bf16_f32 v51, v166, v167
    ds_write_b64 v8, v[50:51] offset:8448
    v_max_f32 v168, 0, v168
    v_max_f32 v169, 0, v169
    v_max_f32 v170, 0, v170
    v_max_f32 v171, 0, v171
    v_mul_f32 v168, v168, v184
    v_mul_f32 v169, v169, v185
    v_mul_f32 v170, v170, v186
    v_mul_f32 v171, v171, v187
    v_cvt_pk_bf16_f32 v52, v168, v169
    v_cvt_pk_bf16_f32 v53, v170, v171
    ds_write_b64 v8, v[52:53] offset:9216
    v_max_f32 v172, 0, v172
    v_max_f32 v173, 0, v173
    v_max_f32 v174, 0, v174
    v_max_f32 v175, 0, v175
    v_mul_f32 v172, v172, v188
    v_mul_f32 v173, v173, v189
    v_mul_f32 v174, v174, v190
    v_mul_f32 v175, v175, v191
    v_cvt_pk_bf16_f32 v54, v172, v173
    v_cvt_pk_bf16_f32 v55, v174, v175
    ds_write_b64 v8, v[54:55] offset:9472
    s_nop 7
    s_cmp_ge_u32 s5, 6
    s_cbranch_scc1 KVP_END
    s_lshl_b32 s56, s4, 2
    s_lshl_b32 s57, s15, 1
    s_add_u32 s56, s56, s57
    s_mul_i32 s56, s56, 2368
    s_add_u32 s56, s56, 2359296
    s_add_u32 s57, s56, 2368
    v_cvt_pk_bf16_f32 v16, v224, v225
    v_cvt_pk_bf16_f32 v17, v226, v227
    v_cvt_pk_bf16_f32 v18, v228, v229
    v_cvt_pk_bf16_f32 v19, v230, v231
    v_cvt_pk_bf16_f32 v20, v232, v233
    v_cvt_pk_bf16_f32 v21, v234, v235
    v_cvt_pk_bf16_f32 v22, v236, v237
    v_cvt_pk_bf16_f32 v23, v238, v239
    v_and_b32 v24, 15, v0
    v_bfe_u32 v25, v0, 4, 1
    s_cmp_ge_u32 s5, 3
    s_cbranch_scc1 KVP_V
    s_cmp_eq_u32 s5, 2
    s_cbranch_scc1 KVP_KB
    v_lshl_add_u32 v26, v25, 5, v24
    v_lshlrev_b32 v26, 4, v26
    s_lshl_b32 s58, s5, 3
    v_add_u32 v26, s58, v26
    s_mov_b32 exec_lo, 0
    buffer_store_dwordx2 v[16:17], v26, s[44:47], s56 offen offset:0 sc1
    buffer_store_dwordx2 v[18:19], v26, s[44:47], s56 offen offset:256 sc1
    buffer_store_dwordx2 v[20:21], v26, s[44:47], s57 offen offset:0 sc1
    buffer_store_dwordx2 v[22:23], v26, s[44:47], s57 offen offset:256 sc1
    s_mov_b32 exec_lo, -1
    s_branch KVP_END
KVP_KB:
    v_lshlrev_b32 v26, 2, v24
    s_mov_b32 exec_lo, 0
    s_mov_b32 exec_hi, 0xffff
    buffer_store_dword v16, v26, s[44:47], s56 offen offset:1024 sc1
    buffer_store_dword v18, v26, s[44:47], s56 offen offset:1088 sc1
    buffer_store_dword v20, v26, s[44:47], s57 offen offset:1024 sc1
    buffer_store_dword v22, v26, s[44:47], s57 offen offset:1088 sc1
    s_mov_b64 exec, -1
    s_branch KVP_END
KVP_V:
    v_lshlrev_b32 v26, 8, v25
    v_bfe_u32 v27, v24, 2, 1
    v_lshl_add_u32 v26, v27, 4, v26
    v_and_b32 v27, 3, v24
    v_lshl_add_u32 v26, v27, 1, v26
    v_bfe_u32 v27, v24, 3, 1
    v_lshl_add_u32 v26, v27, 3, v26
    s_lshl_b32 s58, s15, 10
    s_add_u32 s58, s58, 73728
    v_add_u32 v26, s58, v26
    s_mov_b32 exec_lo, 0
    ds_write_b16 v26, v16 offset:0
    ds_write_b16_d16_hi v26, v16 offset:64
    ds_write_b16 v26, v17 offset:128
    ds_write_b16_d16_hi v26, v17 offset:192
    ds_write_b16 v26, v18 offset:32
    ds_write_b16_d16_hi v26, v18 offset:96
    ds_write_b16 v26, v19 offset:160
    ds_write_b16_d16_hi v26, v19 offset:224
    ds_write_b16 v26, v20 offset:512
    ds_write_b16_d16_hi v26, v20 offset:576
    ds_write_b16 v26, v21 offset:640
    ds_write_b16_d16_hi v26, v21 offset:704
    ds_write_b16 v26, v22 offset:544
    ds_write_b16_d16_hi v26, v22 offset:608
    ds_write_b16 v26, v23 offset:672
    ds_write_b16_d16_hi v26, v23 offset:736
    s_mov_b32 exec_lo, -1
    v_add_u32 v27, s58, v1
    s_waitcnt lgkmcnt(0)
    ds_read_b128 v[28:31], v27
    v_bfe_u32 v24, v0, 2, 3
    s_sub_u32 s58, s5, 3
    s_lshl_b32 s58, s58, 3
    v_add_u32 v24, s58, v24
    v_and_b32 v25, 1, v0
    v_mul_u32_u24 v25, 19, v25
    v_add_lshl_u32 v25, v25, v24, 4
    v_bfe_u32 v26, v0, 1, 1
    v_mul_u32_u24 v26, 608, v26
    v_add_u32 v25, v25, v26
    v_lshrrev_b32 v26, 5, v0
    v_mul_u32_u24 v26, 2368, v26
    v_add_u32 v25, v25, v26
    v_cmp_eq_u32 vcc, 18, v24
    v_mov_b32 v26, 0x3f803f80
    s_waitcnt lgkmcnt(0)
    v_cndmask_b32 v28, v28, v26, vcc
    v_cndmask_b32 v29, v29, v26, vcc
    v_cndmask_b32 v30, v30, v26, vcc
    v_cndmask_b32 v31, v31, v26, vcc
    v_cmp_gt_u32 vcc, 19, v24
    s_and_saveexec_b64 s[74:75], vcc
    buffer_store_dwordx4 v[28:31], v25, s[44:47], s56 offen offset:1152 sc1
    s_mov_b64 exec, -1
    s_nop 1
KVP_END:
    s_mov_b32 s56, 0x3eae1a93
    v_mul_f32 v192, s56, v192
    v_mul_f32 v193, s56, v193
    v_mul_f32 v194, s56, v194
    v_mul_f32 v195, s56, v195
    v_cvt_pk_bf16_f32 v56, v192, v193
    v_cvt_pk_bf16_f32 v57, v194, v195
    ds_write_b64 v9, v[56:57] offset:0
    v_mul_f32 v196, s56, v196
    v_mul_f32 v197, s56, v197
    v_mul_f32 v198, s56, v198
    v_mul_f32 v199, s56, v199
    v_cvt_pk_bf16_f32 v58, v196, v197
    v_cvt_pk_bf16_f32 v59, v198, v199
    ds_write_b64 v9, v[58:59] offset:256
    v_mul_f32 v200, s56, v200
    v_mul_f32 v201, s56, v201
    v_mul_f32 v202, s56, v202
    v_mul_f32 v203, s56, v203
    v_cvt_pk_bf16_f32 v60, v200, v201
    v_cvt_pk_bf16_f32 v61, v202, v203
    ds_write_b64 v9, v[60:61] offset:2304
    v_mul_f32 v204, s56, v204
    v_mul_f32 v205, s56, v205
    v_mul_f32 v206, s56, v206
    v_mul_f32 v207, s56, v207
    v_cvt_pk_bf16_f32 v62, v204, v205
    v_cvt_pk_bf16_f32 v63, v206, v207
    ds_write_b64 v9, v[62:63] offset:2560
    v_mul_f32 v208, s56, v208
    v_mul_f32 v209, s56, v209
    v_mul_f32 v210, s56, v210
    v_mul_f32 v211, s56, v211
    v_cvt_pk_bf16_f32 v56, v208, v209
    v_cvt_pk_bf16_f32 v57, v210, v211
    ds_write_b64 v9, v[56:57] offset:1152
    v_mul_f32 v212, s56, v212
    v_mul_f32 v213, s56, v213
    v_mul_f32 v214, s56, v214
    v_mul_f32 v215, s56, v215
    v_cvt_pk_bf16_f32 v58, v212, v213
    v_cvt_pk_bf16_f32 v59, v214, v215
    ds_write_b64 v9, v[58:59] offset:1408
    v_mul_f32 v216, s56, v216
    v_mul_f32 v217, s56, v217
    v_mul_f32 v218, s56, v218
    v_mul_f32 v219, s56, v219
    v_cvt_pk_bf16_f32 v60, v216, v217
    v_cvt_pk_bf16_f32 v61, v218, v219
    ds_write_b64 v9, v[60:61] offset:3456
    v_mul_f32 v220, s56, v220
    v_mul_f32 v221, s56, v221
    v_mul_f32 v222, s56, v222
    v_mul_f32 v223, s56, v223
    v_cvt_pk_bf16_f32 v62, v220, v221
    v_cvt_pk_bf16_f32 v63, v222, v223
    ds_write_b64 v9, v[62:63] offset:3712
    v_mul_f32 v224, s56, v224
    v_mul_f32 v225, s56, v225
    v_cvt_pk_bf16_f32 v64, v224, v225
    v_mul_f32 v228, s56, v228
    v_mul_f32 v229, s56, v229
    v_cvt_pk_bf16_f32 v65, v228, v229
    v_mul_f32 v232, s56, v232
    v_mul_f32 v233, s56, v233
    v_cvt_pk_bf16_f32 v66, v232, v233
    v_mul_f32 v236, s56, v236
    v_mul_f32 v237, s56, v237
    v_cvt_pk_bf16_f32 v67, v236, v237
    s_mov_b32 exec_hi, 0
    ds_write_b32 v10, v64 offset:0
    ds_write_b32 v10, v65 offset:64
    ds_write_b32 v10, v66 offset:2304
    ds_write_b32 v10, v67 offset:2368
    s_mov_b32 exec_hi, -1
    s_waitcnt vmcnt(0) lgkmcnt(0)
    s_barrier
    ds_read_b128 v[36:39], v6 offset:0
    ds_read_b128 v[40:43], v6 offset:1024
    ds_read_b64_tr_b16 v[16:17], v3 offset:0
    ds_read_b64_tr_b16 v[18:19], v3 offset:9216
    ds_read_b64_tr_b16 v[20:21], v5 offset:0
    ds_read_b64_tr_b16 v[22:23], v5 offset:9216
    ds_read_b64_tr_b16 v[24:25], v3 offset:128
    ds_read_b64_tr_b16 v[26:27], v3 offset:9344
    ds_read_b64_tr_b16 v[28:29], v5 offset:128
    ds_read_b64_tr_b16 v[30:31], v5 offset:9344
    ds_read_b128 v[88:91], v14
    ds_read_b32 v92, v15
    s_cmp_lg_u32 s15, 0
    s_cbranch_scc1 G2_NOSIG
    s_mov_b32 exec_lo, 1
    s_mov_b32 exec_hi, 0
    v_mov_b32 v80, 1
    s_bfe_u32 s56, s2, 0x10003
    s_lshl_b32 s56, s56, 6
    buffer_atomic_add v80, off, s[52:55], s56 offset:128 sc1
    s_mov_b64 exec, -1
G2_NOSIG:
    v_and_b32 v81, 1, v0
    v_lshlrev_b32 v81, 6, v81
    s_lshl_b32 s58, s15, 10
    s_add_u32 s59, s58, 2359296
    s_waitcnt lgkmcnt(0)
    s_barrier
    v_mfma_f32_32x32x16_bf16 v[96:111], v[16:19], v[36:39], 0
    ds_read_b128 v[64:67], v6 offset:4096
    ds_read_b128 v[68:71], v6 offset:5120
    v_mfma_f32_32x32x16_bf16 v[112:127], v[16:19], v[40:43], 0
    ds_read_b64_tr_b16 v[44:45], v3 offset:18432
    ds_read_b64_tr_b16 v[46:47], v3 offset:27648
    v_mfma_f32_32x32x16_bf16 v[128:143], v[20:23], v[36:39], 0
    ds_read_b64_tr_b16 v[48:49], v5 offset:18432
    ds_read_b64_tr_b16 v[50:51], v5 offset:27648
    v_mfma_f32_32x32x16_bf16 v[144:159], v[20:23], v[40:43], 0
    ds_read_b64_tr_b16 v[52:53], v3 offset:18560
    ds_read_b64_tr_b16 v[54:55], v3 offset:27776
    v_mfma_f32_32x32x16_bf16 v[160:175], v[24:27], v[36:39], 0
    ds_read_b64_tr_b16 v[56:57], v5 offset:18560
    ds_read_b64_tr_b16 v[58:59], v5 offset:27776
    v_mfma_f32_32x32x16_bf16 v[176:191], v[24:27], v[40:43], 0
    s_add_u32 m0, s69, 0
    s_nop 0
    buffer_load_dwordx4 v11, s[64:67], s62 offen lds
    v_mfma_f32_32x32x16_bf16 v[192:207], v[28:31], v[36:39], 0
    s_add_u32 m0, s69, 1024
    s_nop 0
    buffer_load_dwordx4 v12, s[64:67], s63 offen lds
    v_mfma_f32_32x32x16_bf16 v[208:223], v[28:31], v[40:43], 0
    s_waitcnt lgkmcnt(0)
    s_barrier
    v_mfma_f32_32x32x16_bf16 v[96:111], v[44:47], v[64:67], v[96:111]
    ds_read_b128 v[36:39], v6 offset:8192
    ds_read_b128 v[40:43], v6 offset:9216
    v_mfma_f32_32x32x16_bf16 v[112:127], v[44:47], v[68:71], v[112:127]
    ds_read_b64_tr_b16 v[16:17], v2 offset:0
    ds_read_b64_tr_b16 v[18:19], v2 offset:9216
    v_mfma_f32_32x32x16_bf16 v[128:143], v[48:51], v[64:67], v[128:143]
    ds_read_b64_tr_b16 v[20:21], v4 offset:0
    ds_read_b64_tr_b16 v[22:23], v4 offset:9216
    v_mfma_f32_32x32x16_bf16 v[144:159], v[48:51], v[68:71], v[144:159]
    ds_read_b64_tr_b16 v[24:25], v2 offset:128
    ds_read_b64_tr_b16 v[26:27], v2 offset:9344
    v_mfma_f32_32x32x16_bf16 v[160:175], v[52:55], v[64:67], v[160:175]
    ds_read_b64_tr_b16 v[28:29], v4 offset:128
    ds_read_b64_tr_b16 v[30:31], v4 offset:9344
    v_mfma_f32_32x32x16_bf16 v[176:191], v[52:55], v[68:71], v[176:191]
    v_mfma_f32_32x32x16_bf16 v[192:207], v[56:59], v[64:67], v[192:207]
    v_mfma_f32_32x32x16_bf16 v[208:223], v[56:59], v[68:71], v[208:223]
    s_waitcnt lgkmcnt(0)
    s_barrier
    v_mfma_f32_32x32x16_bf16 v[96:111], v[16:19], v[36:39], v[96:111]
    ds_read_b128 v[64:67], v6 offset:12288
    ds_read_b128 v[68:71], v6 offset:13312
    v_mfma_f32_32x32x16_bf16 v[112:127], v[16:19], v[40:43], v[112:127]
    ds_read_b64_tr_b16 v[44:45], v2 offset:18432
    ds_read_b64_tr_b16 v[46:47], v2 offset:27648
    v_mfma_f32_32x32x16_bf16 v[128:143], v[20:23], v[36:39], v[128:143]
    ds_read_b64_tr_b16 v[48:49], v4 offset:18432
    ds_read_b64_tr_b16 v[50:51], v4 offset:27648
    v_mfma_f32_32x32x16_bf16 v[144:159], v[20:23], v[40:43], v[144:159]
    ds_read_b64_tr_b16 v[52:53], v2 offset:18560
    ds_read_b64_tr_b16 v[54:55], v2 offset:27776
    v_mfma_f32_32x32x16_bf16 v[160:175], v[24:27], v[36:39], v[160:175]
    ds_read_b64_tr_b16 v[56:57], v4 offset:18560
    ds_read_b64_tr_b16 v[58:59], v4 offset:27776
    v_mfma_f32_32x32x16_bf16 v[176:191], v[24:27], v[40:43], v[176:191]
    v_mfma_f32_32x32x16_bf16 v[192:207], v[28:31], v[36:39], v[192:207]
    v_mfma_f32_32x32x16_bf16 v[208:223], v[28:31], v[40:43], v[208:223]
    s_waitcnt lgkmcnt(0)
    s_barrier
    v_mfma_f32_32x32x16_bf16 v[96:111], v[44:47], v[64:67], v[96:111]
    ds_read_b128 v[36:39], v6 offset:16384
    ds_read_b128 v[40:43], v6 offset:17408
    v_mfma_f32_32x32x16_bf16 v[112:127], v[44:47], v[68:71], v[112:127]
    ds_read_b64_tr_b16 v[16:17], v3 offset:0
    ds_read_b64_tr_b16 v[18:19], v3 offset:9216
    v_mfma_f32_32x32x16_bf16 v[128:143], v[48:51], v[64:67], v[128:143]
    ds_read_b64_tr_b16 v[20:21], v5 offset:0
    ds_read_b64_tr_b16 v[22:23], v5 offset:9216
    v_mfma_f32_32x32x16_bf16 v[144:159], v[48:51], v[68:71], v[144:159]
    ds_read_b64_tr_b16 v[24:25], v3 offset:128
    ds_read_b64_tr_b16 v[26:27], v3 offset:9344
    v_mfma_f32_32x32x16_bf16 v[160:175], v[52:55], v[64:67], v[160:175]
    ds_read_b64_tr_b16 v[28:29], v5 offset:128
    ds_read_b64_tr_b16 v[30:31], v5 offset:9344
    v_mfma_f32_32x32x16_bf16 v[176:191], v[52:55], v[68:71], v[176:191]
    v_mfma_f32_32x32x16_bf16 v[192:207], v[56:59], v[64:67], v[192:207]
    v_mfma_f32_32x32x16_bf16 v[208:223], v[56:59], v[68:71], v[208:223]
    s_waitcnt lgkmcnt(0)
    s_barrier
    v_mfma_f32_32x32x16_bf16 v[96:111], v[16:19], v[36:39], v[96:111]
    ds_read_b128 v[64:67], v6 offset:20480
    ds_read_b128 v[68:71], v6 offset:21504
    v_mfma_f32_32x32x16_bf16 v[112:127], v[16:19], v[40:43], v[112:127]
    ds_read_b64_tr_b16 v[44:45], v3 offset:18432
    ds_read_b64_tr_b16 v[46:47], v3 offset:27648
    v_mfma_f32_32x32x16_bf16 v[128:143], v[20:23], v[36:39], v[128:143]
    ds_read_b64_tr_b16 v[48:49], v5 offset:18432
    ds_read_b64_tr_b16 v[50:51], v5 offset:27648
    v_mfma_f32_32x32x16_bf16 v[144:159], v[20:23], v[40:43], v[144:159]
    ds_read_b64_tr_b16 v[52:53], v3 offset:18560
    ds_read_b64_tr_b16 v[54:55], v3 offset:27776
    v_mfma_f32_32x32x16_bf16 v[160:175], v[24:27], v[36:39], v[160:175]
    ds_read_b64_tr_b16 v[56:57], v5 offset:18560
    ds_read_b64_tr_b16 v[58:59], v5 offset:27776
    v_mfma_f32_32x32x16_bf16 v[176:191], v[24:27], v[40:43], v[176:191]
    v_mfma_f32_32x32x16_bf16 v[192:207], v[28:31], v[36:39], v[192:207]
    v_mfma_f32_32x32x16_bf16 v[208:223], v[28:31], v[40:43], v[208:223]
    s_waitcnt lgkmcnt(0)
    s_barrier
    v_mfma_f32_32x32x16_bf16 v[96:111], v[44:47], v[64:67], v[96:111]
    ds_read_b128 v[36:39], v6 offset:24576
    ds_read_b128 v[40:43], v6 offset:25600
    v_mfma_f32_32x32x16_bf16 v[112:127], v[44:47], v[68:71], v[112:127]
    ds_read_b64_tr_b16 v[16:17], v2 offset:0
    ds_read_b64_tr_b16 v[18:19], v2 offset:9216
    v_mfma_f32_32x32x16_bf16 v[128:143], v[48:51], v[64:67], v[128:143]
    ds_read_b64_tr_b16 v[20:21], v4 offset:0
    ds_read_b64_tr_b16 v[22:23], v4 offset:9216
    v_mfma_f32_32x32x16_bf16 v[144:159], v[48:51], v[68:71], v[144:159]
    ds_read_b64_tr_b16 v[24:25], v2 offset:128
    ds_read_b64_tr_b16 v[26:27], v2 offset:9344
    v_mfma_f32_32x32x16_bf16 v[160:175], v[52:55], v[64:67], v[160:175]
    ds_read_b64_tr_b16 v[28:29], v4 offset:128
    ds_read_b64_tr_b16 v[30:31], v4 offset:9344
    v_mfma_f32_32x32x16_bf16 v[176:191], v[52:55], v[68:71], v[176:191]
    buffer_load_dword v80, v81, s[52:55], 0 offen offset:128 sc1
    v_mfma_f32_32x32x16_bf16 v[192:207], v[56:59], v[64:67], v[192:207]
    v_mfma_f32_32x32x16_bf16 v[208:223], v[56:59], v[68:71], v[208:223]
    s_mov_b32 s68, 0
    s_cmp_lg_u32 s15, 0
    s_cbranch_scc1 G2_POLL_W7
G2_POLL:
    s_waitcnt vmcnt(0)
    v_cmp_le_u32 vcc, 128, v80
    s_nop 3
    s_cmp_eq_u64 vcc, -1
    s_cbranch_scc1 G2_POLL_OK
    s_add_u32 s68, s68, 1
    s_cmp_ge_u32 s68, 0x8000
    s_cbranch_scc1 G2_POLL_OK
    s_sleep 8
    buffer_load_dword v80, v81, s[52:55], 0 offen offset:128 sc1
    s_branch G2_POLL
G2_POLL_W7:
    s_waitcnt vmcnt(0)
G2_POLL_OK:
    s_waitcnt lgkmcnt(0)
    s_barrier
    v_mfma_f32_32x32x16_bf16 v[96:111], v[16:19], v[36:39], v[96:111]
    ds_read_b128 v[64:67], v6 offset:28672
    ds_read_b128 v[68:71], v6 offset:29696
    v_mfma_f32_32x32x16_bf16 v[112:127], v[16:19], v[40:43], v[112:127]
    ds_read_b64_tr_b16 v[44:45], v2 offset:18432
    ds_read_b64_tr_b16 v[46:47], v2 offset:27648
    v_mfma_f32_32x32x16_bf16 v[128:143], v[20:23], v[36:39], v[128:143]
    ds_read_b64_tr_b16 v[48:49], v4 offset:18432
    ds_read_b64_tr_b16 v[50:51], v4 offset:27648
    v_mfma_f32_32x32x16_bf16 v[144:159], v[20:23], v[40:43], v[144:159]
    ds_read_b64_tr_b16 v[52:53], v2 offset:18560
    ds_read_b64_tr_b16 v[54:55], v2 offset:27776
    v_mfma_f32_32x32x16_bf16 v[160:175], v[24:27], v[36:39], v[160:175]
    ds_read_b64_tr_b16 v[56:57], v4 offset:18560
    ds_read_b64_tr_b16 v[58:59], v4 offset:27776
    v_mfma_f32_32x32x16_bf16 v[176:191], v[24:27], v[40:43], v[176:191]
    ds_read_b64_tr_b16 v[72:73], v13 offset:0
    ds_read_b64_tr_b16 v[74:75], v13 offset:256
    ds_read_b64_tr_b16 v[76:77], v13 offset:1024
    ds_read_b64_tr_b16 v[78:79], v13 offset:1280
    v_bfe_u32 v11, v0, 4, 1
    v_mul_u32_u24 v11, 18432, v11
    v_lshrrev_b32 v12, 5, v0
    v_lshl_add_u32 v11, v12, 8, v11
    v_and_b32 v12, 15, v0
    v_lshl_add_u32 v11, v12, 4, v11
    v_mfma_f32_32x32x16_bf16 v[192:207], v[28:31], v[36:39], v[192:207]
    v_mfma_f32_32x32x16_bf16 v[208:223], v[28:31], v[40:43], v[208:223]
    s_waitcnt lgkmcnt(0)
    s_barrier
    v_mfma_f32_32x32x16_bf16 v[96:111], v[44:47], v[64:67], v[96:111]
    ds_read_b128 v[36:39], v6 offset:32768
    ds_read_b128 v[40:43], v6 offset:33792
    v_mfma_f32_32x32x16_bf16 v[112:127], v[44:47], v[68:71], v[112:127]
    ds_read_b64_tr_b16 v[16:17], v3 offset:0
    ds_read_b64_tr_b16 v[18:19], v3 offset:9216
    v_mfma_f32_32x32x16_bf16 v[128:143], v[48:51], v[64:67], v[128:143]
    ds_read_b64_tr_b16 v[20:21], v5 offset:0
    ds_read_b64_tr_b16 v[22:23], v5 offset:9216
    v_mfma_f32_32x32x16_bf16 v[144:159], v[48:51], v[68:71], v[144:159]
    ds_read_b64_tr_b16 v[24:25], v3 offset:128
    ds_read_b64_tr_b16 v[26:27], v3 offset:9344
    v_mfma_f32_32x32x16_bf16 v[160:175], v[52:55], v[64:67], v[160:175]
    ds_read_b64_tr_b16 v[28:29], v5 offset:128
    ds_read_b64_tr_b16 v[30:31], v5 offset:9344
    v_mfma_f32_32x32x16_bf16 v[176:191], v[52:55], v[68:71], v[176:191]
    buffer_store_dwordx4 v[72:75], v11, s[44:47], s60 offen sc1
    v_mfma_f32_32x32x16_bf16 v[192:207], v[56:59], v[64:67], v[192:207]
    buffer_store_dwordx4 v[76:79], v11, s[44:47], s61 offen sc1
    v_mfma_f32_32x32x16_bf16 v[208:223], v[56:59], v[68:71], v[208:223]
    s_waitcnt lgkmcnt(0)
    s_barrier
    v_mfma_f32_32x32x16_bf16 v[96:111], v[16:19], v[36:39], v[96:111]
    ds_read_b128 v[64:67], v7 offset:0
    ds_read_b128 v[68:71], v7 offset:1024
    v_mfma_f32_32x32x16_bf16 v[112:127], v[16:19], v[40:43], v[112:127]
    ds_read_b64_tr_b16 v[44:45], v3 offset:18432
    ds_read_b64_tr_b16 v[46:47], v3 offset:27648
    v_mfma_f32_32x32x16_bf16 v[128:143], v[20:23], v[36:39], v[128:143]
    ds_read_b64_tr_b16 v[48:49], v5 offset:18432
    ds_read_b64_tr_b16 v[50:51], v5 offset:27648
    v_mfma_f32_32x32x16_bf16 v[144:159], v[20:23], v[40:43], v[144:159]
    ds_read_b64_tr_b16 v[52:53], v3 offset:18560
    ds_read_b64_tr_b16 v[54:55], v3 offset:27776
    v_mfma_f32_32x32x16_bf16 v[160:175], v[24:27], v[36:39], v[160:175]
    ds_read_b64_tr_b16 v[56:57], v5 offset:18560
    ds_read_b64_tr_b16 v[58:59], v5 offset:27776
    v_mfma_f32_32x32x16_bf16 v[176:191], v[24:27], v[40:43], v[176:191]
    v_mfma_f32_32x32x16_bf16 v[192:207], v[28:31], v[36:39], v[192:207]
    v_mfma_f32_32x32x16_bf16 v[208:223], v[28:31], v[40:43], v[208:223]
    s_waitcnt lgkmcnt(0)
    s_barrier
    v_mfma_f32_32x32x16_bf16 v[96:111], v[44:47], v[64:67], v[96:111]
    ds_read_b128 v[36:39], v7 offset:4096
    ds_read_b128 v[40:43], v7 offset:5120
    v_mfma_f32_32x32x16_bf16 v[112:127], v[44:47], v[68:71], v[112:127]
    ds_read_b64_tr_b16 v[16:17], v2 offset:0
    ds_read_b64_tr_b16 v[18:19], v2 offset:9216
    v_mfma_f32_32x32x16_bf16 v[128:143], v[48:51], v[64:67], v[128:143]
    ds_read_b64_tr_b16 v[20:21], v4 offset:0
    ds_read_b64_tr_b16 v[22:23], v4 offset:9216
    v_mfma_f32_32x32x16_bf16 v[144:159], v[48:51], v[68:71], v[144:159]
    ds_read_b64_tr_b16 v[24:25], v2 offset:128
    ds_read_b64_tr_b16 v[26:27], v2 offset:9344
    v_mfma_f32_32x32x16_bf16 v[160:175], v[52:55], v[64:67], v[160:175]
    ds_read_b64_tr_b16 v[28:29], v4 offset:128
    ds_read_b64_tr_b16 v[30:31], v4 offset:9344
    s_add_u32 m0, s58, 0
    s_add_u32 s57, s59, 0
    buffer_load_dwordx4 v1, s[44:47], s57 offen sc1 lds
    v_mfma_f32_32x32x16_bf16 v[176:191], v[52:55], v[68:71], v[176:191]
    s_add_u32 m0, s58, 2048
    s_add_u32 s57, s59, 2048
    buffer_load_dwordx4 v1, s[44:47], s57 offen sc1 lds
    v_mfma_f32_32x32x16_bf16 v[192:207], v[56:59], v[64:67], v[192:207]
    s_add_u32 m0, s58, 4096
    s_add_u32 s57, s59, 4096
    buffer_load_dwordx4 v1, s[44:47], s57 offen sc1 lds
    v_mfma_f32_32x32x16_bf16 v[208:223], v[56:59], v[68:71], v[208:223]
    s_add_u32 m0, s58, 6144
    s_add_u32 s57, s59, 6144
    buffer_load_dwordx4 v1, s[44:47], s57 offen sc1 lds
    s_waitcnt lgkmcnt(0)
    s_barrier
    v_mfma_f32_32x32x16_bf16 v[96:111], v[16:19], v[36:39], v[96:111]
    ds_read_b128 v[64:67], v7 offset:8192
    ds_read_b128 v[68:71], v7 offset:9216
    v_mfma_f32_32x32x16_bf16 v[112:127], v[16:19], v[40:43], v[112:127]
    ds_read_b64_tr_b16 v[44:45], v2 offset:18432
    ds_read_b64_tr_b16 v[46:47], v2 offset:27648
    v_mfma_f32_32x32x16_bf16 v[128:143], v[20:23], v[36:39], v[128:143]
    ds_read_b64_tr_b16 v[48:49], v4 offset:18432
    ds_read_b64_tr_b16 v[50:51], v4 offset:27648
    v_mfma_f32_32x32x16_bf16 v[144:159], v[20:23], v[40:43], v[144:159]
    ds_read_b64_tr_b16 v[52:53], v2 offset:18560
    ds_read_b64_tr_b16 v[54:55], v2 offset:27776
    v_mfma_f32_32x32x16_bf16 v[160:175], v[24:27], v[36:39], v[160:175]
    ds_read_b64_tr_b16 v[56:57], v4 offset:18560
    ds_read_b64_tr_b16 v[58:59], v4 offset:27776
    s_add_u32 m0, s58, 8192
    s_add_u32 s57, s59, 8192
    buffer_load_dwordx4 v1, s[44:47], s57 offen sc1 lds
    v_mfma_f32_32x32x16_bf16 v[176:191], v[24:27], v[40:43], v[176:191]
    s_add_u32 m0, s58, 10240
    s_add_u32 s57, s59, 10240
    buffer_load_dwordx4 v1, s[44:47], s57 offen sc1 lds
    v_mfma_f32_32x32x16_bf16 v[192:207], v[28:31], v[36:39], v[192:207]
    s_add_u32 m0, s58, 12288
    s_add_u32 s57, s59, 12288
    buffer_load_dwordx4 v1, s[44:47], s57 offen sc1 lds
    v_mfma_f32_32x32x16_bf16 v[208:223], v[28:31], v[40:43], v[208:223]
    s_add_u32 m0, s58, 14336
    s_add_u32 s57, s59, 14336
    buffer_load_dwordx4 v1, s[44:47], s57 offen sc1 lds
    s_waitcnt lgkmcnt(0)
    s_barrier
    v_mfma_f32_32x32x16_bf16 v[96:111], v[44:47], v[64:67], v[96:111]
    ds_read_b128 v[36:39], v7 offset:12288
    ds_read_b128 v[40:43], v7 offset:13312
    v_mfma_f32_32x32x16_bf16 v[112:127], v[44:47], v[68:71], v[112:127]
    ds_read_b64_tr_b16 v[16:17], v3 offset:0
    ds_read_b64_tr_b16 v[18:19], v3 offset:9216
    v_mfma_f32_32x32x16_bf16 v[128:143], v[48:51], v[64:67], v[128:143]
    ds_read_b64_tr_b16 v[20:21], v5 offset:0
    ds_read_b64_tr_b16 v[22:23], v5 offset:9216
    v_mfma_f32_32x32x16_bf16 v[144:159], v[48:51], v[68:71], v[144:159]
    ds_read_b64_tr_b16 v[24:25], v3 offset:128
    ds_read_b64_tr_b16 v[26:27], v3 offset:9344
    v_mfma_f32_32x32x16_bf16 v[160:175], v[52:55], v[64:67], v[160:175]
    ds_read_b64_tr_b16 v[28:29], v5 offset:128
    ds_read_b64_tr_b16 v[30:31], v5 offset:9344
    s_add_u32 m0, s58, 16384
    s_add_u32 s57, s59, 16384
    buffer_load_dwordx4 v1, s[44:47], s57 offen sc1 lds
    v_mfma_f32_32x32x16_bf16 v[176:191], v[52:55], v[68:71], v[176:191]
    s_add_u32 m0, s58, 18432
    s_add_u32 s57, s59, 18432
    buffer_load_dwordx4 v1, s[44:47], s57 offen sc1 lds
    v_mfma_f32_32x32x16_bf16 v[192:207], v[56:59], v[64:67], v[192:207]
    s_add_u32 m0, s58, 20480
    s_add_u32 s57, s59, 20480
    buffer_load_dwordx4 v1, s[44:47], s57 offen sc1 lds
    v_mfma_f32_32x32x16_bf16 v[208:223], v[56:59], v[68:71], v[208:223]
    s_add_u32 m0, s58, 22528
    s_add_u32 s57, s59, 22528
    buffer_load_dwordx4 v1, s[44:47], s57 offen sc1 lds
    s_waitcnt lgkmcnt(0)
    s_barrier
    v_mfma_f32_32x32x16_bf16 v[96:111], v[16:19], v[36:39], v[96:111]
    ds_read_b128 v[64:67], v7 offset:16384
    ds_read_b128 v[68:71], v7 offset:17408
    v_mfma_f32_32x32x16_bf16 v[112:127], v[16:19], v[40:43], v[112:127]
    ds_read_b64_tr_b16 v[44:45], v3 offset:18432
    ds_read_b64_tr_b16 v[46:47], v3 offset:27648
    v_mfma_f32_32x32x16_bf16 v[128:143], v[20:23], v[36:39], v[128:143]
    ds_read_b64_tr_b16 v[48:49], v5 offset:18432
    ds_read_b64_tr_b16 v[50:51], v5 offset:27648
    v_mfma_f32_32x32x16_bf16 v[144:159], v[20:23], v[40:43], v[144:159]
    ds_read_b64_tr_b16 v[52:53], v3 offset:18560
    ds_read_b64_tr_b16 v[54:55], v3 offset:27776
    v_mfma_f32_32x32x16_bf16 v[160:175], v[24:27], v[36:39], v[160:175]
    ds_read_b64_tr_b16 v[56:57], v5 offset:18560
    ds_read_b64_tr_b16 v[58:59], v5 offset:27776
    s_add_u32 m0, s58, 24576
    s_add_u32 s57, s59, 24576
    buffer_load_dwordx4 v1, s[44:47], s57 offen sc1 lds
    v_mfma_f32_32x32x16_bf16 v[176:191], v[24:27], v[40:43], v[176:191]
    s_add_u32 m0, s58, 26624
    s_add_u32 s57, s59, 26624
    buffer_load_dwordx4 v1, s[44:47], s57 offen sc1 lds
    v_mfma_f32_32x32x16_bf16 v[192:207], v[28:31], v[36:39], v[192:207]
    s_add_u32 m0, s58, 28672
    s_add_u32 s57, s59, 28672
    buffer_load_dwordx4 v1, s[44:47], s57 offen sc1 lds
    v_mfma_f32_32x32x16_bf16 v[208:223], v[28:31], v[40:43], v[208:223]
    s_add_u32 m0, s58, 30720
    s_add_u32 s57, s59, 30720
    buffer_load_dwordx4 v1, s[44:47], s57 offen sc1 lds
    s_waitcnt lgkmcnt(0)
    s_barrier
    v_mfma_f32_32x32x16_bf16 v[96:111], v[44:47], v[64:67], v[96:111]
    ds_read_b128 v[36:39], v7 offset:20480
    ds_read_b128 v[40:43], v7 offset:21504
    v_mfma_f32_32x32x16_bf16 v[112:127], v[44:47], v[68:71], v[112:127]
    ds_read_b64_tr_b16 v[16:17], v2 offset:0
    ds_read_b64_tr_b16 v[18:19], v2 offset:9216
    v_mfma_f32_32x32x16_bf16 v[128:143], v[48:51], v[64:67], v[128:143]
    ds_read_b64_tr_b16 v[20:21], v4 offset:0
    ds_read_b64_tr_b16 v[22:23], v4 offset:9216
    v_mfma_f32_32x32x16_bf16 v[144:159], v[48:51], v[68:71], v[144:159]
    ds_read_b64_tr_b16 v[24:25], v2 offset:128
    ds_read_b64_tr_b16 v[26:27], v2 offset:9344
    v_mfma_f32_32x32x16_bf16 v[160:175], v[52:55], v[64:67], v[160:175]
    ds_read_b64_tr_b16 v[28:29], v4 offset:128
    ds_read_b64_tr_b16 v[30:31], v4 offset:9344
    s_add_u32 m0, s58, 32768
    s_add_u32 s57, s59, 32768
    buffer_load_dwordx4 v1, s[44:47], s57 offen sc1 lds
    v_mfma_f32_32x32x16_bf16 v[176:191], v[52:55], v[68:71], v[176:191]
    s_add_u32 m0, s58, 34816
    s_add_u32 s57, s59, 34816
    buffer_load_dwordx4 v1, s[44:47], s57 offen sc1 lds
    v_mfma_f32_32x32x16_bf16 v[192:207], v[56:59], v[64:67], v[192:207]
    s_add_u32 m0, s58, 36864
    s_add_u32 s57, s59, 36864
    buffer_load_dwordx4 v1, s[44:47], s57 offen sc1 lds
    v_mfma_f32_32x32x16_bf16 v[208:223], v[56:59], v[68:71], v[208:223]
    s_add_u32 m0, s58, 38912
    s_add_u32 s57, s59, 38912
    buffer_load_dwordx4 v1, s[44:47], s57 offen sc1 lds
    s_waitcnt lgkmcnt(0)
    s_barrier
    v_mfma_f32_32x32x16_bf16 v[96:111], v[16:19], v[36:39], v[96:111]
    ds_read_b128 v[64:67], v7 offset:24576
    ds_read_b128 v[68:71], v7 offset:25600
    v_mfma_f32_32x32x16_bf16 v[112:127], v[16:19], v[40:43], v[112:127]
    ds_read_b64_tr_b16 v[44:45], v2 offset:18432
    ds_read_b64_tr_b16 v[46:47], v2 offset:27648
    v_mfma_f32_32x32x16_bf16 v[128:143], v[20:23], v[36:39], v[128:143]
    ds_read_b64_tr_b16 v[48:49], v4 offset:18432
    ds_read_b64_tr_b16 v[50:51], v4 offset:27648
    v_mfma_f32_32x32x16_bf16 v[144:159], v[20:23], v[40:43], v[144:159]
    ds_read_b64_tr_b16 v[52:53], v2 offset:18560
    ds_read_b64_tr_b16 v[54:55], v2 offset:27776
    v_mfma_f32_32x32x16_bf16 v[160:175], v[24:27], v[36:39], v[160:175]
    ds_read_b64_tr_b16 v[56:57], v4 offset:18560
    ds_read_b64_tr_b16 v[58:59], v4 offset:27776
    s_add_u32 m0, s58, 40960
    s_add_u32 s57, s59, 40960
    buffer_load_dwordx4 v1, s[44:47], s57 offen sc1 lds
    v_mfma_f32_32x32x16_bf16 v[176:191], v[24:27], v[40:43], v[176:191]
    s_add_u32 m0, s58, 43008
    s_add_u32 s57, s59, 43008
    buffer_load_dwordx4 v1, s[44:47], s57 offen sc1 lds
    v_mfma_f32_32x32x16_bf16 v[192:207], v[28:31], v[36:39], v[192:207]
    s_add_u32 m0, s58, 45056
    s_add_u32 s57, s59, 45056
    buffer_load_dwordx4 v1, s[44:47], s57 offen sc1 lds
    v_mfma_f32_32x32x16_bf16 v[208:223], v[28:31], v[40:43], v[208:223]
    s_add_u32 m0, s58, 47104
    s_add_u32 s57, s59, 47104
    buffer_load_dwordx4 v1, s[44:47], s57 offen sc1 lds
    s_waitcnt lgkmcnt(0)
    s_barrier
    v_mfma_f32_32x32x16_bf16 v[96:111], v[44:47], v[64:67], v[96:111]
    ds_read_b128 v[36:39], v7 offset:28672
    ds_read_b128 v[40:43], v7 offset:29696
    v_mfma_f32_32x32x16_bf16 v[112:127], v[44:47], v[68:71], v[112:127]
    ds_read_b64_tr_b16 v[16:17], v3 offset:0
    ds_read_b64_tr_b16 v[18:19], v3 offset:9216
    v_mfma_f32_32x32x16_bf16 v[128:143], v[48:51], v[64:67], v[128:143]
    ds_read_b64_tr_b16 v[20:21], v5 offset:0
    ds_read_b64_tr_b16 v[22:23], v5 offset:9216
    v_mfma_f32_32x32x16_bf16 v[144:159], v[48:51], v[68:71], v[144:159]
    ds_read_b64_tr_b16 v[24:25], v3 offset:128
    ds_read_b64_tr_b16 v[26:27], v3 offset:9344
    v_mfma_f32_32x32x16_bf16 v[160:175], v[52:55], v[64:67], v[160:175]
    ds_read_b64_tr_b16 v[28:29], v5 offset:128
    ds_read_b64_tr_b16 v[30:31], v5 offset:9344
    s_add_u32 m0, s58, 49152
    s_add_u32 s57, s59, 49152
    buffer_load_dwordx4 v1, s[44:47], s57 offen sc1 lds
    v_mfma_f32_32x32x16_bf16 v[176:191], v[52:55], v[68:71], v[176:191]
    s_add_u32 m0, s58, 51200
    s_add_u32 s57, s59, 51200
    buffer_load_dwordx4 v1, s[44:47], s57 offen sc1 lds
    v_mfma_f32_32x32x16_bf16 v[192:207], v[56:59], v[64:67], v[192:207]
    s_add_u32 m0, s58, 53248
    s_add_u32 s57, s59, 53248
    buffer_load_dwordx4 v1, s[44:47], s57 offen sc1 lds
    v_mfma_f32_32x32x16_bf16 v[208:223], v[56:59], v[68:71], v[208:223]
    s_add_u32 m0, s58, 55296
    s_add_u32 s57, s59, 55296
    buffer_load_dwordx4 v1, s[44:47], s57 offen sc1 lds
    s_waitcnt lgkmcnt(0)
    s_barrier
    v_mfma_f32_32x32x16_bf16 v[96:111], v[16:19], v[36:39], v[96:111]
    ds_read_b128 v[64:67], v7 offset:32768
    ds_read_b128 v[68:71], v7 offset:33792
    v_mfma_f32_32x32x16_bf16 v[112:127], v[16:19], v[40:43], v[112:127]
    ds_read_b64_tr_b16 v[44:45], v3 offset:18432
    ds_read_b64_tr_b16 v[46:47], v3 offset:27648
    v_mfma_f32_32x32x16_bf16 v[128:143], v[20:23], v[36:39], v[128:143]
    ds_read_b64_tr_b16 v[48:49], v5 offset:18432
    ds_read_b64_tr_b16 v[50:51], v5 offset:27648
    v_mfma_f32_32x32x16_bf16 v[144:159], v[20:23], v[40:43], v[144:159]
    ds_read_b64_tr_b16 v[52:53], v3 offset:18560
    ds_read_b64_tr_b16 v[54:55], v3 offset:27776
    v_mfma_f32_32x32x16_bf16 v[160:175], v[24:27], v[36:39], v[160:175]
    ds_read_b64_tr_b16 v[56:57], v5 offset:18560
    ds_read_b64_tr_b16 v[58:59], v5 offset:27776
    s_add_u32 m0, s58, 57344
    s_add_u32 s57, s59, 57344
    buffer_load_dwordx4 v1, s[44:47], s57 offen sc1 lds
    v_mfma_f32_32x32x16_bf16 v[176:191], v[24:27], v[40:43], v[176:191]
    s_add_u32 m0, s58, 59392
    s_add_u32 s57, s59, 59392
    buffer_load_dwordx4 v1, s[44:47], s57 offen sc1 lds
    v_mfma_f32_32x32x16_bf16 v[192:207], v[28:31], v[36:39], v[192:207]
    s_add_u32 m0, s58, 61440
    s_add_u32 s57, s59, 61440
    buffer_load_dwordx4 v1, s[44:47], s57 offen sc1 lds
    v_mfma_f32_32x32x16_bf16 v[208:223], v[28:31], v[40:43], v[208:223]
    s_add_u32 m0, s58, 63488
    s_add_u32 s57, s59, 63488
    buffer_load_dwordx4 v1, s[44:47], s57 offen sc1 lds
    s_waitcnt lgkmcnt(0)
    s_barrier
    v_mfma_f32_32x32x16_bf16 v[96:111], v[44:47], v[64:67], v[96:111]
    v_mfma_f32_32x32x16_bf16 v[112:127], v[44:47], v[68:71], v[112:127]
    v_mfma_f32_32x32x16_bf16 v[128:143], v[48:51], v[64:67], v[128:143]
    v_mfma_f32_32x32x16_bf16 v[144:159], v[48:51], v[68:71], v[144:159]
    v_mfma_f32_32x32x16_bf16 v[160:175], v[52:55], v[64:67], v[160:175]
    s_add_u32 m0, s58, 65536
    s_add_u32 s57, s59, 65536
    buffer_load_dwordx4 v1, s[44:47], s57 offen sc1 lds
    v_mfma_f32_32x32x16_bf16 v[176:191], v[52:55], v[68:71], v[176:191]
    s_add_u32 m0, s58, 67584
    s_add_u32 s57, s59, 67584
    buffer_load_dwordx4 v1, s[44:47], s57 offen sc1 lds
    v_mfma_f32_32x32x16_bf16 v[192:207], v[56:59], v[64:67], v[192:207]
    s_add_u32 m0, s58, 69632
    s_add_u32 s57, s59, 69632
    buffer_load_dwordx4 v1, s[44:47], s57 offen sc1 lds
    v_mfma_f32_32x32x16_bf16 v[208:223], v[56:59], v[68:71], v[208:223]
    s_add_u32 m0, s58, 71680
    s_add_u32 s57, s59, 71680
    buffer_load_dwordx4 v1, s[44:47], s57 offen sc1 lds
    s_waitcnt vmcnt(12)
    s_branch ATT
ATT:
    s_lshl_b32 s60, s5, 6
    s_lshl_b32 s61, s4, 2
    s_add_u32 s60, s60, s61
    s_and_b32 s61, s3, 1
    s_lshl_b32 s61, s61, 1
    s_add_u32 s60, s60, s61
    s_mul_i32 s60, s60, 18
    s_add_u32 s60, s60, s13
    s_lshl_b32 s60, s60, 11
    s_add_u32 s60, s60, 5570560
    s_add_u32 s61, s60, 36864
    s_add_u32 s62, s60, 2048
    s_add_u32 s63, s61, 2048
    s_add_u32 s64, s60, 4096
    s_add_u32 s65, s61, 4096
    s_add_u32 s66, s60, 6144
    s_add_u32 s67, s61, 6144
    s_add_u32 s68, s60, 8192
    s_add_u32 s69, s61, 8192
    s_cmp_ge_u32 s3, 4
    s_cselect_b32 s68, 0x7f000000, s68
    s_cselect_b32 s69, 0x7f000000, s69
    s_barrier
    s_cmp_lg_u32 s3, 6
    s_cbranch_scc1 ATT_NOWOC
    s_mov_b32 exec_lo, 1
    s_mov_b32 exec_hi, 0
    v_mov_b32 v5, 1
    s_bfe_u32 s56, s2, 0x10003
    s_lshl_b32 s56, s56, 6
    buffer_atomic_add v5, off, s[52:55], s56 offset:132 sc1
    s_mov_b64 exec, -1
    s_nop 1
ATT_NOWOC:
    s_mov_b32 s40, s16
    s_mov_b32 s41, s17
    s_mov_b32 s42, 2359296
    s_mov_b32 s43, 0x20000
    s_mov_b32 s48, s34
    s_mov_b32 s49, s35
    s_mov_b32 s50, 2359296
    s_mov_b32 s51, 0x20000
    v_mov_b32 v2, v1
    v_and_b32 v5, 31, v0
    v_lshlrev_b32 v3, 2, v5
    ds_read_b128 v[16:19], v2 offset:0
    ds_read_b32 v24, v3 offset:1024
    v_subrev_u32 v6, 16, v5
    v_cmp_gt_u32 vcc, 19, v5
    v_lshrrev_b32 v7, 5, v0
    v_mul_u32_u24 v7, 19, v7
    v_cndmask_b32 v6, v6, v5, vcc
    v_add_lshl_u32 v4, v6, v7, 4
    s_mov_b32 s70, -1
    s_mov_b32 s71, 0
    v_mov_b32 v25, 0x3f803f80
    v_mov_b32 v26, 0x3f803f80
    v_mov_b32 v27, 0
    v_mov_b32 v29, 0x3f803f80
    v_mov_b32 v30, 0x3f803f80
    v_mov_b32 v31, 0
    v_cndmask_b32 v92, 0, v92, s[70:71]
    v_mov_b32 v93, 0
    v_mov_b32 v94, 0
    v_mov_b32 v95, 0
    s_waitcnt lgkmcnt(0)
    v_mfma_f32_32x32x16_bf16 v[48:63], v[16:19], v[88:91], 0
    v_mfma_f32_32x32x16_bf16 v[48:63], v[24:27], v[92:95], v[48:63]
    v_cvt_pk_bf16_f32 v96, v96, v97
    v_cvt_pk_bf16_f32 v97, v98, v99
    v_cvt_pk_bf16_f32 v98, v100, v101
    v_cvt_pk_bf16_f32 v99, v102, v103
    v_cvt_pk_bf16_f32 v100, v104, v105
    v_cvt_pk_bf16_f32 v101, v106, v107
    v_cvt_pk_bf16_f32 v102, v108, v109
    v_cvt_pk_bf16_f32 v103, v110, v111
    buffer_store_dwordx4 v[96:99], v1, s[44:47], s60 offen sc1
    buffer_store_dwordx4 v[100:103], v1, s[44:47], s60 offen offset:1024 sc1
    v_cvt_pk_bf16_f32 v112, v112, v113
    v_cvt_pk_bf16_f32 v113, v114, v115
    v_cvt_pk_bf16_f32 v114, v116, v117
    v_cvt_pk_bf16_f32 v115, v118, v119
    v_cvt_pk_bf16_f32 v116, v120, v121
    v_cvt_pk_bf16_f32 v117, v122, v123
    v_cvt_pk_bf16_f32 v118, v124, v125
    v_cvt_pk_bf16_f32 v119, v126, v127
    buffer_store_dwordx4 v[112:115], v1, s[44:47], s61 offen sc1
    buffer_store_dwordx4 v[116:119], v1, s[44:47], s61 offen offset:1024 sc1
    v_max3_f32 v5, v48, v49, v50
    v_max_f32 v5, v5, v51
    v_max3_f32 v5, v5, v52, v53
    v_max3_f32 v5, v5, v54, v55
    v_max3_f32 v5, v5, v56, v57
    v_max3_f32 v5, v5, v58, v59
    v_max3_f32 v5, v5, v60, v61
    v_max3_f32 v5, v5, v62, v63
    v_mov_b32 v9, v5
    s_nop 1
    v_permlane32_swap_b32 v9, v5
    s_nop 1
    v_max_f32 v5, v5, v9
    v_sub_f32 v9, 0, v5
    v_and_b32 v10, 0xffff0000, v9
    v_sub_f32 v9, v9, v10
    v_and_b32 v11, 0xffff0000, v9
    v_sub_f32 v9, v9, v11
    v_lshrrev_b32 v10, 16, v10
    v_or_b32 v10, v10, v11
    v_lshrrev_b32 v9, 16, v9
    v_cndmask_b32 v93, 0, v10, s[70:71]
    v_cndmask_b32 v94, 0, v9, s[70:71]
    s_mov_b32 s72, 0
ATT_PASS:
    v_mov_b32 v32, 0
    v_mov_b32 v33, 0
    v_mov_b32 v34, 0
    v_mov_b32 v35, 0
    v_mov_b32 v36, 0
    v_mov_b32 v37, 0
    v_mov_b32 v38, 0
    v_mov_b32 v39, 0
    v_mov_b32 v40, 0
    v_mov_b32 v41, 0
    v_mov_b32 v42, 0
    v_mov_b32 v43, 0
    v_mov_b32 v44, 0
    v_mov_b32 v45, 0
    v_mov_b32 v46, 0
    v_mov_b32 v47, 0
    s_mov_b32 s10, 0x7ffff
    s_mov_b32 s11, 0x7ffff
    ds_read_b128 v[16:19], v2 offset:0
    ds_read_b32 v24, v3 offset:1024
    ds_read_b128 v[20:23], v2 offset:2368
    ds_read_b32 v28, v3 offset:3392
    s_mov_b64 exec, s[10:11]
    ds_read_b128 v[32:35], v4 offset:1152
    ds_read_b128 v[36:39], v4 offset:1760
    s_mov_b64 exec, -1
    v_mov_b32 v104, 0
    v_mov_b32 v105, 0
    v_mov_b32 v106, 0
    v_mov_b32 v107, 0
    v_mov_b32 v108, 0
    v_mov_b32 v109, 0
    v_mov_b32 v110, 0
    v_mov_b32 v111, 0
    v_mov_b32 v112, 0
    v_mov_b32 v113, 0
    v_mov_b32 v114, 0
    v_mov_b32 v115, 0
    v_mov_b32 v116, 0
    v_mov_b32 v117, 0
    v_mov_b32 v118, 0
    v_mov_b32 v119, 0
    v_mov_b32 v100, 0
    v_mov_b32 v101, 0
    v_mov_b32 v102, 0
    v_mov_b32 v103, 0
    s_waitcnt lgkmcnt(0)
    v_mfma_f32_32x32x16_bf16 v[48:63], v[16:19], v[88:91], 0
    v_mfma_f32_32x32x16_bf16 v[48:63], v[24:27], v[92:95], v[48:63]
    s_mov_b32 s12, 0
    s_cmp_lg_u32 s72, 0
    s_nop 9
    s_cbranch_scc1 ATT_LOOP
    s_waitcnt lgkmcnt(0)
    v_mfma_f32_32x32x16_bf16 v[64:79], v[20:23], v[88:91], 0
    v_exp_f32 v48, v48
    v_exp_f32 v49, v49
    v_exp_f32 v50, v50
    v_exp_f32 v51, v51
    v_cvt_pk_bf16_f32 v96, v48, v49
    v_cvt_pk_bf16_f32 v97, v50, v51
    v_mfma_f32_32x32x16_bf16 v[104:119], v[44:47], v[100:103], v[104:119]
    ds_read_b128 v[16:19], v2 offset:4736
    ds_read_b32 v24, v3 offset:5760
    v_exp_f32 v52, v52
    v_exp_f32 v53, v53
    v_exp_f32 v54, v54
    v_exp_f32 v55, v55
    v_cvt_pk_bf16_f32 v98, v52, v53
    v_cvt_pk_bf16_f32 v99, v54, v55
    v_mfma_f32_32x32x16_bf16 v[64:79], v[28:31], v[92:95], v[64:79]
    s_mov_b64 exec, s[10:11]
    ds_read_b128 v[40:43], v4 offset:3520
    ds_read_b128 v[44:47], v4 offset:4128
    s_mov_b64 exec, -1
    v_exp_f32 v56, v56
    v_exp_f32 v57, v57
    v_exp_f32 v58, v58
    v_exp_f32 v59, v59
    v_cvt_pk_bf16_f32 v100, v56, v57
    v_cvt_pk_bf16_f32 v101, v58, v59
    v_mfma_f32_32x32x16_bf16 v[104:119], v[32:35], v[96:99], v[104:119]
    v_exp_f32 v60, v60
    v_exp_f32 v61, v61
    v_exp_f32 v62, v62
    v_exp_f32 v63, v63
    v_cvt_pk_bf16_f32 v102, v60, v61
    v_cvt_pk_bf16_f32 v103, v62, v63
    s_waitcnt lgkmcnt(0)
    v_mfma_f32_32x32x16_bf16 v[48:63], v[16:19], v[88:91], 0
    v_exp_f32 v64, v64
    v_exp_f32 v65, v65
    v_exp_f32 v66, v66
    v_exp_f32 v67, v67
    v_cvt_pk_bf16_f32 v96, v64, v65
    v_cvt_pk_bf16_f32 v97, v66, v67
    v_mfma_f32_32x32x16_bf16 v[104:119], v[36:39], v[100:103], v[104:119]
    ds_read_b128 v[20:23], v2 offset:7104
    ds_read_b32 v28, v3 offset:8128
    v_exp_f32 v68, v68
    v_exp_f32 v69, v69
    v_exp_f32 v70, v70
    v_exp_f32 v71, v71
    v_cvt_pk_bf16_f32 v98, v68, v69
    v_cvt_pk_bf16_f32 v99, v70, v71
    v_mfma_f32_32x32x16_bf16 v[48:63], v[24:27], v[92:95], v[48:63]
    s_mov_b64 exec, s[10:11]
    ds_read_b128 v[32:35], v4 offset:5888
    ds_read_b128 v[36:39], v4 offset:6496
    s_mov_b64 exec, -1
    v_exp_f32 v72, v72
    v_exp_f32 v73, v73
    v_exp_f32 v74, v74
    v_exp_f32 v75, v75
    v_cvt_pk_bf16_f32 v100, v72, v73
    v_cvt_pk_bf16_f32 v101, v74, v75
    v_mfma_f32_32x32x16_bf16 v[104:119], v[40:43], v[96:99], v[104:119]
    v_exp_f32 v76, v76
    v_exp_f32 v77, v77
    v_exp_f32 v78, v78
    v_exp_f32 v79, v79
    v_cvt_pk_bf16_f32 v102, v76, v77
    v_cvt_pk_bf16_f32 v103, v78, v79
    v_cvt_pk_bf16_f32 v128, v128, v129
    v_cvt_pk_bf16_f32 v129, v130, v131
    v_cvt_pk_bf16_f32 v130, v132, v133
    v_cvt_pk_bf16_f32 v131, v134, v135
    v_cvt_pk_bf16_f32 v132, v136, v137
    v_cvt_pk_bf16_f32 v133, v138, v139
    v_cvt_pk_bf16_f32 v134, v140, v141
    v_cvt_pk_bf16_f32 v135, v142, v143
    buffer_store_dwordx4 v[128:131], v1, s[44:47], s62 offen sc1
    s_waitcnt lgkmcnt(0)
    v_mfma_f32_32x32x16_bf16 v[64:79], v[20:23], v[88:91], 0
    v_exp_f32 v48, v48
    v_exp_f32 v49, v49
    v_exp_f32 v50, v50
    v_exp_f32 v51, v51
    v_cvt_pk_bf16_f32 v96, v48, v49
    v_cvt_pk_bf16_f32 v97, v50, v51
    v_mfma_f32_32x32x16_bf16 v[104:119], v[44:47], v[100:103], v[104:119]
    ds_read_b128 v[16:19], v2 offset:9472
    ds_read_b32 v24, v3 offset:10496
    v_exp_f32 v52, v52
    v_exp_f32 v53, v53
    v_exp_f32 v54, v54
    v_exp_f32 v55, v55
    v_cvt_pk_bf16_f32 v98, v52, v53
    v_cvt_pk_bf16_f32 v99, v54, v55
    v_mfma_f32_32x32x16_bf16 v[64:79], v[28:31], v[92:95], v[64:79]
    s_mov_b64 exec, s[10:11]
    ds_read_b128 v[40:43], v4 offset:8256
    ds_read_b128 v[44:47], v4 offset:8864
    s_mov_b64 exec, -1
    v_exp_f32 v56, v56
    v_exp_f32 v57, v57
    v_exp_f32 v58, v58
    v_exp_f32 v59, v59
    v_cvt_pk_bf16_f32 v100, v56, v57
    v_cvt_pk_bf16_f32 v101, v58, v59
    v_mfma_f32_32x32x16_bf16 v[104:119], v[32:35], v[96:99], v[104:119]
    v_exp_f32 v60, v60
    v_exp_f32 v61, v61
    v_exp_f32 v62, v62
    v_exp_f32 v63, v63
    v_cvt_pk_bf16_f32 v102, v60, v61
    v_cvt_pk_bf16_f32 v103, v62, v63
    buffer_store_dwordx4 v[132:135], v1, s[44:47], s62 offen offset:1024 sc1
    s_waitcnt lgkmcnt(0)
    v_mfma_f32_32x32x16_bf16 v[48:63], v[16:19], v[88:91], 0
    v_exp_f32 v64, v64
    v_exp_f32 v65, v65
    v_exp_f32 v66, v66
    v_exp_f32 v67, v67
    v_cvt_pk_bf16_f32 v96, v64, v65
    v_cvt_pk_bf16_f32 v97, v66, v67
    v_mfma_f32_32x32x16_bf16 v[104:119], v[36:39], v[100:103], v[104:119]
    ds_read_b128 v[20:23], v2 offset:11840
    ds_read_b32 v28, v3 offset:12864
    v_exp_f32 v68, v68
    v_exp_f32 v69, v69
    v_exp_f32 v70, v70
    v_exp_f32 v71, v71
    v_cvt_pk_bf16_f32 v98, v68, v69
    v_cvt_pk_bf16_f32 v99, v70, v71
    v_mfma_f32_32x32x16_bf16 v[48:63], v[24:27], v[92:95], v[48:63]
    s_mov_b64 exec, s[10:11]
    ds_read_b128 v[32:35], v4 offset:10624
    ds_read_b128 v[36:39], v4 offset:11232
    s_mov_b64 exec, -1
    v_exp_f32 v72, v72
    v_exp_f32 v73, v73
    v_exp_f32 v74, v74
    v_exp_f32 v75, v75
    v_cvt_pk_bf16_f32 v100, v72, v73
    v_cvt_pk_bf16_f32 v101, v74, v75
    v_mfma_f32_32x32x16_bf16 v[104:119], v[40:43], v[96:99], v[104:119]
    v_exp_f32 v76, v76
    v_exp_f32 v77, v77
    v_exp_f32 v78, v78
    v_exp_f32 v79, v79
    v_cvt_pk_bf16_f32 v102, v76, v77
    v_cvt_pk_bf16_f32 v103, v78, v79
    s_waitcnt lgkmcnt(0)
    v_mfma_f32_32x32x16_bf16 v[64:79], v[20:23], v[88:91], 0
    v_exp_f32 v48, v48
    v_exp_f32 v49, v49
    v_exp_f32 v50, v50
    v_exp_f32 v51, v51
    v_cvt_pk_bf16_f32 v96, v48, v49
    v_cvt_pk_bf16_f32 v97, v50, v51
    v_mfma_f32_32x32x16_bf16 v[104:119], v[44:47], v[100:103], v[104:119]
    ds_read_b128 v[16:19], v2 offset:14208
    ds_read_b32 v24, v3 offset:15232
    v_exp_f32 v52, v52
    v_exp_f32 v53, v53
    v_exp_f32 v54, v54
    v_exp_f32 v55, v55
    v_cvt_pk_bf16_f32 v98, v52, v53
    v_cvt_pk_bf16_f32 v99, v54, v55
    v_mfma_f32_32x32x16_bf16 v[64:79], v[28:31], v[92:95], v[64:79]
    s_mov_b64 exec, s[10:11]
    ds_read_b128 v[40:43], v4 offset:12992
    ds_read_b128 v[44:47], v4 offset:13600
    s_mov_b64 exec, -1
    v_exp_f32 v56, v56
    v_exp_f32 v57, v57
    v_exp_f32 v58, v58
    v_exp_f32 v59, v59
    v_cvt_pk_bf16_f32 v100, v56, v57
    v_cvt_pk_bf16_f32 v101, v58, v59
    v_mfma_f32_32x32x16_bf16 v[104:119], v[32:35], v[96:99], v[104:119]
    v_exp_f32 v60, v60
    v_exp_f32 v61, v61
    v_exp_f32 v62, v62
    v_exp_f32 v63, v63
    v_cvt_pk_bf16_f32 v102, v60, v61
    v_cvt_pk_bf16_f32 v103, v62, v63
    v_cvt_pk_bf16_f32 v144, v144, v145
    v_cvt_pk_bf16_f32 v145, v146, v147
    v_cvt_pk_bf16_f32 v146, v148, v149
    v_cvt_pk_bf16_f32 v147, v150, v151
    v_cvt_pk_bf16_f32 v148, v152, v153
    v_cvt_pk_bf16_f32 v149, v154, v155
    v_cvt_pk_bf16_f32 v150, v156, v157
    v_cvt_pk_bf16_f32 v151, v158, v159
    buffer_store_dwordx4 v[144:147], v1, s[44:47], s63 offen sc1
    s_waitcnt lgkmcnt(0)
    v_mfma_f32_32x32x16_bf16 v[48:63], v[16:19], v[88:91], 0
    v_exp_f32 v64, v64
    v_exp_f32 v65, v65
    v_exp_f32 v66, v66
    v_exp_f32 v67, v67
    v_cvt_pk_bf16_f32 v96, v64, v65
    v_cvt_pk_bf16_f32 v97, v66, v67
    v_mfma_f32_32x32x16_bf16 v[104:119], v[36:39], v[100:103], v[104:119]
    ds_read_b128 v[20:23], v2 offset:16576
    ds_read_b32 v28, v3 offset:17600
    v_exp_f32 v68, v68
    v_exp_f32 v69, v69
    v_exp_f32 v70, v70
    v_exp_f32 v71, v71
    v_cvt_pk_bf16_f32 v98, v68, v69
    v_cvt_pk_bf16_f32 v99, v70, v71
    v_mfma_f32_32x32x16_bf16 v[48:63], v[24:27], v[92:95], v[48:63]
    s_mov_b64 exec, s[10:11]
    ds_read_b128 v[32:35], v4 offset:15360
    ds_read_b128 v[36:39], v4 offset:15968
    s_mov_b64 exec, -1
    v_exp_f32 v72, v72
    v_exp_f32 v73, v73
    v_exp_f32 v74, v74
    v_exp_f32 v75, v75
    v_cvt_pk_bf16_f32 v100, v72, v73
    v_cvt_pk_bf16_f32 v101, v74, v75
    v_mfma_f32_32x32x16_bf16 v[104:119], v[40:43], v[96:99], v[104:119]
    v_exp_f32 v76, v76
    v_exp_f32 v77, v77
    v_exp_f32 v78, v78
    v_exp_f32 v79, v79
    v_cvt_pk_bf16_f32 v102, v76, v77
    v_cvt_pk_bf16_f32 v103, v78, v79
    s_waitcnt lgkmcnt(0)
    v_mfma_f32_32x32x16_bf16 v[64:79], v[20:23], v[88:91], 0
    v_exp_f32 v48, v48
    v_exp_f32 v49, v49
    v_exp_f32 v50, v50
    v_exp_f32 v51, v51
    v_cvt_pk_bf16_f32 v96, v48, v49
    v_cvt_pk_bf16_f32 v97, v50, v51
    v_mfma_f32_32x32x16_bf16 v[104:119], v[44:47], v[100:103], v[104:119]
    ds_read_b128 v[16:19], v2 offset:18944
    ds_read_b32 v24, v3 offset:19968
    v_exp_f32 v52, v52
    v_exp_f32 v53, v53
    v_exp_f32 v54, v54
    v_exp_f32 v55, v55
    v_cvt_pk_bf16_f32 v98, v52, v53
    v_cvt_pk_bf16_f32 v99, v54, v55
    v_mfma_f32_32x32x16_bf16 v[64:79], v[28:31], v[92:95], v[64:79]
    s_mov_b64 exec, s[10:11]
    ds_read_b128 v[40:43], v4 offset:17728
    ds_read_b128 v[44:47], v4 offset:18336
    s_mov_b64 exec, -1
    v_exp_f32 v56, v56
    v_exp_f32 v57, v57
    v_exp_f32 v58, v58
    v_exp_f32 v59, v59
    v_cvt_pk_bf16_f32 v100, v56, v57
    v_cvt_pk_bf16_f32 v101, v58, v59
    v_mfma_f32_32x32x16_bf16 v[104:119], v[32:35], v[96:99], v[104:119]
    v_exp_f32 v60, v60
    v_exp_f32 v61, v61
    v_exp_f32 v62, v62
    v_exp_f32 v63, v63
    v_cvt_pk_bf16_f32 v102, v60, v61
    v_cvt_pk_bf16_f32 v103, v62, v63
    buffer_store_dwordx4 v[148:151], v1, s[44:47], s63 offen offset:1024 sc1
    s_waitcnt lgkmcnt(0)
    v_mfma_f32_32x32x16_bf16 v[48:63], v[16:19], v[88:91], 0
    v_exp_f32 v64, v64
    v_exp_f32 v65, v65
    v_exp_f32 v66, v66
    v_exp_f32 v67, v67
    v_cvt_pk_bf16_f32 v96, v64, v65
    v_cvt_pk_bf16_f32 v97, v66, v67
    v_mfma_f32_32x32x16_bf16 v[104:119], v[36:39], v[100:103], v[104:119]
    ds_read_b128 v[20:23], v2 offset:21312
    ds_read_b32 v28, v3 offset:22336
    v_exp_f32 v68, v68
    v_exp_f32 v69, v69
    v_exp_f32 v70, v70
    v_exp_f32 v71, v71
    v_cvt_pk_bf16_f32 v98, v68, v69
    v_cvt_pk_bf16_f32 v99, v70, v71
    v_mfma_f32_32x32x16_bf16 v[48:63], v[24:27], v[92:95], v[48:63]
    s_mov_b64 exec, s[10:11]
    ds_read_b128 v[32:35], v4 offset:20096
    ds_read_b128 v[36:39], v4 offset:20704
    s_mov_b64 exec, -1
    v_exp_f32 v72, v72
    v_exp_f32 v73, v73
    v_exp_f32 v74, v74
    v_exp_f32 v75, v75
    v_cvt_pk_bf16_f32 v100, v72, v73
    v_cvt_pk_bf16_f32 v101, v74, v75
    v_mfma_f32_32x32x16_bf16 v[104:119], v[40:43], v[96:99], v[104:119]
    v_exp_f32 v76, v76
    v_exp_f32 v77, v77
    v_exp_f32 v78, v78
    v_exp_f32 v79, v79
    v_cvt_pk_bf16_f32 v102, v76, v77
    v_cvt_pk_bf16_f32 v103, v78, v79
    v_cvt_pk_bf16_f32 v160, v160, v161
    v_cvt_pk_bf16_f32 v161, v162, v163
    v_cvt_pk_bf16_f32 v162, v164, v165
    v_cvt_pk_bf16_f32 v163, v166, v167
    v_cvt_pk_bf16_f32 v164, v168, v169
    v_cvt_pk_bf16_f32 v165, v170, v171
    v_cvt_pk_bf16_f32 v166, v172, v173
    v_cvt_pk_bf16_f32 v167, v174, v175
    buffer_store_dwordx4 v[160:163], v1, s[44:47], s64 offen sc1
    s_waitcnt lgkmcnt(0)
    v_mfma_f32_32x32x16_bf16 v[64:79], v[20:23], v[88:91], 0
    v_exp_f32 v48, v48
    v_exp_f32 v49, v49
    v_exp_f32 v50, v50
    v_exp_f32 v51, v51
    v_cvt_pk_bf16_f32 v96, v48, v49
    v_cvt_pk_bf16_f32 v97, v50, v51
    v_mfma_f32_32x32x16_bf16 v[104:119], v[44:47], v[100:103], v[104:119]
    ds_read_b128 v[16:19], v2 offset:23680
    ds_read_b32 v24, v3 offset:24704
    v_exp_f32 v52, v52
    v_exp_f32 v53, v53
    v_exp_f32 v54, v54
    v_exp_f32 v55, v55
    v_cvt_pk_bf16_f32 v98, v52, v53
    v_cvt_pk_bf16_f32 v99, v54, v55
    v_mfma_f32_32x32x16_bf16 v[64:79], v[28:31], v[92:95], v[64:79]
    s_mov_b64 exec, s[10:11]
    ds_read_b128 v[40:43], v4 offset:22464
    ds_read_b128 v[44:47], v4 offset:23072
    s_mov_b64 exec, -1
    v_exp_f32 v56, v56
    v_exp_f32 v57, v57
    v_exp_f32 v58, v58
    v_exp_f32 v59, v59
    v_cvt_pk_bf16_f32 v100, v56, v57
    v_cvt_pk_bf16_f32 v101, v58, v59
    v_mfma_f32_32x32x16_bf16 v[104:119], v[32:35], v[96:99], v[104:119]
    v_exp_f32 v60, v60
    v_exp_f32 v61, v61
    v_exp_f32 v62, v62
    v_exp_f32 v63, v63
    v_cvt_pk_bf16_f32 v102, v60, v61
    v_cvt_pk_bf16_f32 v103, v62, v63
    s_waitcnt lgkmcnt(0)
    v_mfma_f32_32x32x16_bf16 v[48:63], v[16:19], v[88:91], 0
    v_exp_f32 v64, v64
    v_exp_f32 v65, v65
    v_exp_f32 v66, v66
    v_exp_f32 v67, v67
    v_cvt_pk_bf16_f32 v96, v64, v65
    v_cvt_pk_bf16_f32 v97, v66, v67
    v_mfma_f32_32x32x16_bf16 v[104:119], v[36:39], v[100:103], v[104:119]
    ds_read_b128 v[20:23], v2 offset:26048
    ds_read_b32 v28, v3 offset:27072
    v_exp_f32 v68, v68
    v_exp_f32 v69, v69
    v_exp_f32 v70, v70
    v_exp_f32 v71, v71
    v_cvt_pk_bf16_f32 v98, v68, v69
    v_cvt_pk_bf16_f32 v99, v70, v71
    v_mfma_f32_32x32x16_bf16 v[48:63], v[24:27], v[92:95], v[48:63]
    s_mov_b64 exec, s[10:11]
    ds_read_b128 v[32:35], v4 offset:24832
    ds_read_b128 v[36:39], v4 offset:25440
    s_mov_b64 exec, -1
    v_exp_f32 v72, v72
    v_exp_f32 v73, v73
    v_exp_f32 v74, v74
    v_exp_f32 v75, v75
    v_cvt_pk_bf16_f32 v100, v72, v73
    v_cvt_pk_bf16_f32 v101, v74, v75
    v_mfma_f32_32x32x16_bf16 v[104:119], v[40:43], v[96:99], v[104:119]
    v_exp_f32 v76, v76
    v_exp_f32 v77, v77
    v_exp_f32 v78, v78
    v_exp_f32 v79, v79
    v_cvt_pk_bf16_f32 v102, v76, v77
    v_cvt_pk_bf16_f32 v103, v78, v79
    buffer_store_dwordx4 v[164:167], v1, s[44:47], s64 offen offset:1024 sc1
    s_waitcnt lgkmcnt(0)
    v_mfma_f32_32x32x16_bf16 v[64:79], v[20:23], v[88:91], 0
    v_exp_f32 v48, v48
    v_exp_f32 v49, v49
    v_exp_f32 v50, v50
    v_exp_f32 v51, v51
    v_cvt_pk_bf16_f32 v96, v48, v49
    v_cvt_pk_bf16_f32 v97, v50, v51
    v_mfma_f32_32x32x16_bf16 v[104:119], v[44:47], v[100:103], v[104:119]
    ds_read_b128 v[16:19], v2 offset:28416
    ds_read_b32 v24, v3 offset:29440
    v_exp_f32 v52, v52
    v_exp_f32 v53, v53
    v_exp_f32 v54, v54
    v_exp_f32 v55, v55
    v_cvt_pk_bf16_f32 v98, v52, v53
    v_cvt_pk_bf16_f32 v99, v54, v55
    v_mfma_f32_32x32x16_bf16 v[64:79], v[28:31], v[92:95], v[64:79]
    s_mov_b64 exec, s[10:11]
    ds_read_b128 v[40:43], v4 offset:27200
    ds_read_b128 v[44:47], v4 offset:27808
    s_mov_b64 exec, -1
    v_exp_f32 v56, v56
    v_exp_f32 v57, v57
    v_exp_f32 v58, v58
    v_exp_f32 v59, v59
    v_cvt_pk_bf16_f32 v100, v56, v57
    v_cvt_pk_bf16_f32 v101, v58, v59
    v_mfma_f32_32x32x16_bf16 v[104:119], v[32:35], v[96:99], v[104:119]
    v_exp_f32 v60, v60
    v_exp_f32 v61, v61
    v_exp_f32 v62, v62
    v_exp_f32 v63, v63
    v_cvt_pk_bf16_f32 v102, v60, v61
    v_cvt_pk_bf16_f32 v103, v62, v63
    s_waitcnt lgkmcnt(0)
    v_mfma_f32_32x32x16_bf16 v[48:63], v[16:19], v[88:91], 0
    v_exp_f32 v64, v64
    v_exp_f32 v65, v65
    v_exp_f32 v66, v66
    v_exp_f32 v67, v67
    v_cvt_pk_bf16_f32 v96, v64, v65
    v_cvt_pk_bf16_f32 v97, v66, v67
    v_mfma_f32_32x32x16_bf16 v[104:119], v[36:39], v[100:103], v[104:119]
    ds_read_b128 v[20:23], v2 offset:30784
    ds_read_b32 v28, v3 offset:31808
    v_exp_f32 v68, v68
    v_exp_f32 v69, v69
    v_exp_f32 v70, v70
    v_exp_f32 v71, v71
    v_cvt_pk_bf16_f32 v98, v68, v69
    v_cvt_pk_bf16_f32 v99, v70, v71
    v_mfma_f32_32x32x16_bf16 v[48:63], v[24:27], v[92:95], v[48:63]
    s_mov_b64 exec, s[10:11]
    ds_read_b128 v[32:35], v4 offset:29568
    ds_read_b128 v[36:39], v4 offset:30176
    s_mov_b64 exec, -1
    v_exp_f32 v72, v72
    v_exp_f32 v73, v73
    v_exp_f32 v74, v74
    v_exp_f32 v75, v75
    v_cvt_pk_bf16_f32 v100, v72, v73
    v_cvt_pk_bf16_f32 v101, v74, v75
    v_mfma_f32_32x32x16_bf16 v[104:119], v[40:43], v[96:99], v[104:119]
    v_exp_f32 v76, v76
    v_exp_f32 v77, v77
    v_exp_f32 v78, v78
    v_exp_f32 v79, v79
    v_cvt_pk_bf16_f32 v102, v76, v77
    v_cvt_pk_bf16_f32 v103, v78, v79
    v_cvt_pk_bf16_f32 v176, v176, v177
    v_cvt_pk_bf16_f32 v177, v178, v179
    v_cvt_pk_bf16_f32 v178, v180, v181
    v_cvt_pk_bf16_f32 v179, v182, v183
    v_cvt_pk_bf16_f32 v180, v184, v185
    v_cvt_pk_bf16_f32 v181, v186, v187
    v_cvt_pk_bf16_f32 v182, v188, v189
    v_cvt_pk_bf16_f32 v183, v190, v191
    buffer_store_dwordx4 v[176:179], v1, s[44:47], s65 offen sc1
    s_waitcnt lgkmcnt(0)
    v_mfma_f32_32x32x16_bf16 v[64:79], v[20:23], v[88:91], 0
    v_exp_f32 v48, v48
    v_exp_f32 v49, v49
    v_exp_f32 v50, v50
    v_exp_f32 v51, v51
    v_cvt_pk_bf16_f32 v96, v48, v49
    v_cvt_pk_bf16_f32 v97, v50, v51
    v_mfma_f32_32x32x16_bf16 v[104:119], v[44:47], v[100:103], v[104:119]
    ds_read_b128 v[16:19], v2 offset:33152
    ds_read_b32 v24, v3 offset:34176
    v_exp_f32 v52, v52
    v_exp_f32 v53, v53
    v_exp_f32 v54, v54
    v_exp_f32 v55, v55
    v_cvt_pk_bf16_f32 v98, v52, v53
    v_cvt_pk_bf16_f32 v99, v54, v55
    v_mfma_f32_32x32x16_bf16 v[64:79], v[28:31], v[92:95], v[64:79]
    s_mov_b64 exec, s[10:11]
    ds_read_b128 v[40:43], v4 offset:31936
    ds_read_b128 v[44:47], v4 offset:32544
    s_mov_b64 exec, -1
    v_exp_f32 v56, v56
    v_exp_f32 v57, v57
    v_exp_f32 v58, v58
    v_exp_f32 v59, v59
    v_cvt_pk_bf16_f32 v100, v56, v57
    v_cvt_pk_bf16_f32 v101, v58, v59
    v_mfma_f32_32x32x16_bf16 v[104:119], v[32:35], v[96:99], v[104:119]
    v_exp_f32 v60, v60
    v_exp_f32 v61, v61
    v_exp_f32 v62, v62
    v_exp_f32 v63, v63
    v_cvt_pk_bf16_f32 v102, v60, v61
    v_cvt_pk_bf16_f32 v103, v62, v63
    buffer_store_dwordx4 v[180:183], v1, s[44:47], s65 offen offset:1024 sc1
    s_waitcnt lgkmcnt(0)
    v_mfma_f32_32x32x16_bf16 v[48:63], v[16:19], v[88:91], 0
    v_exp_f32 v64, v64
    v_exp_f32 v65, v65
    v_exp_f32 v66, v66
    v_exp_f32 v67, v67
    v_cvt_pk_bf16_f32 v96, v64, v65
    v_cvt_pk_bf16_f32 v97, v66, v67
    v_mfma_f32_32x32x16_bf16 v[104:119], v[36:39], v[100:103], v[104:119]
    ds_read_b128 v[20:23], v2 offset:35520
    ds_read_b32 v28, v3 offset:36544
    v_exp_f32 v68, v68
    v_exp_f32 v69, v69
    v_exp_f32 v70, v70
    v_exp_f32 v71, v71
    v_cvt_pk_bf16_f32 v98, v68, v69
    v_cvt_pk_bf16_f32 v99, v70, v71
    v_mfma_f32_32x32x16_bf16 v[48:63], v[24:27], v[92:95], v[48:63]
    s_mov_b64 exec, s[10:11]
    ds_read_b128 v[32:35], v4 offset:34304
    ds_read_b128 v[36:39], v4 offset:34912
    s_mov_b64 exec, -1
    v_exp_f32 v72, v72
    v_exp_f32 v73, v73
    v_exp_f32 v74, v74
    v_exp_f32 v75, v75
    v_cvt_pk_bf16_f32 v100, v72, v73
    v_cvt_pk_bf16_f32 v101, v74, v75
    v_mfma_f32_32x32x16_bf16 v[104:119], v[40:43], v[96:99], v[104:119]
    v_exp_f32 v76, v76
    v_exp_f32 v77, v77
    v_exp_f32 v78, v78
    v_exp_f32 v79, v79
    v_cvt_pk_bf16_f32 v102, v76, v77
    v_cvt_pk_bf16_f32 v103, v78, v79
    s_waitcnt lgkmcnt(0)
    v_mfma_f32_32x32x16_bf16 v[64:79], v[20:23], v[88:91], 0
    v_exp_f32 v48, v48
    v_exp_f32 v49, v49
    v_exp_f32 v50, v50
    v_exp_f32 v51, v51
    v_cvt_pk_bf16_f32 v96, v48, v49
    v_cvt_pk_bf16_f32 v97, v50, v51
    v_mfma_f32_32x32x16_bf16 v[104:119], v[44:47], v[100:103], v[104:119]
    ds_read_b128 v[16:19], v2 offset:37888
    ds_read_b32 v24, v3 offset:38912
    v_exp_f32 v52, v52
    v_exp_f32 v53, v53
    v_exp_f32 v54, v54
    v_exp_f32 v55, v55
    v_cvt_pk_bf16_f32 v98, v52, v53
    v_cvt_pk_bf16_f32 v99, v54, v55
    v_mfma_f32_32x32x16_bf16 v[64:79], v[28:31], v[92:95], v[64:79]
    s_mov_b64 exec, s[10:11]
    ds_read_b128 v[40:43], v4 offset:36672
    ds_read_b128 v[44:47], v4 offset:37280
    s_mov_b64 exec, -1
    v_exp_f32 v56, v56
    v_exp_f32 v57, v57
    v_exp_f32 v58, v58
    v_exp_f32 v59, v59
    v_cvt_pk_bf16_f32 v100, v56, v57
    v_cvt_pk_bf16_f32 v101, v58, v59
    v_mfma_f32_32x32x16_bf16 v[104:119], v[32:35], v[96:99], v[104:119]
    v_exp_f32 v60, v60
    v_exp_f32 v61, v61
    v_exp_f32 v62, v62
    v_exp_f32 v63, v63
    v_cvt_pk_bf16_f32 v102, v60, v61
    v_cvt_pk_bf16_f32 v103, v62, v63
    v_cvt_pk_bf16_f32 v192, v192, v193
    v_cvt_pk_bf16_f32 v193, v194, v195
    v_cvt_pk_bf16_f32 v194, v196, v197
    v_cvt_pk_bf16_f32 v195, v198, v199
    v_cvt_pk_bf16_f32 v196, v200, v201
    v_cvt_pk_bf16_f32 v197, v202, v203
    v_cvt_pk_bf16_f32 v198, v204, v205
    v_cvt_pk_bf16_f32 v199, v206, v207
    buffer_store_dwordx4 v[192:195], v1, s[44:47], s66 offen sc1
    s_waitcnt lgkmcnt(0)
    v_mfma_f32_32x32x16_bf16 v[48:63], v[16:19], v[88:91], 0
    v_exp_f32 v64, v64
    v_exp_f32 v65, v65
    v_exp_f32 v66, v66
    v_exp_f32 v67, v67
    v_cvt_pk_bf16_f32 v96, v64, v65
    v_cvt_pk_bf16_f32 v97, v66, v67
    v_mfma_f32_32x32x16_bf16 v[104:119], v[36:39], v[100:103], v[104:119]
    ds_read_b128 v[20:23], v2 offset:40256
    ds_read_b32 v28, v3 offset:41280
    v_exp_f32 v68, v68
    v_exp_f32 v69, v69
    v_exp_f32 v70, v70
    v_exp_f32 v71, v71
    v_cvt_pk_bf16_f32 v98, v68, v69
    v_cvt_pk_bf16_f32 v99, v70, v71
    v_mfma_f32_32x32x16_bf16 v[48:63], v[24:27], v[92:95], v[48:63]
    s_mov_b64 exec, s[10:11]
    ds_read_b128 v[32:35], v4 offset:39040
    ds_read_b128 v[36:39], v4 offset:39648
    s_mov_b64 exec, -1
    v_exp_f32 v72, v72
    v_exp_f32 v73, v73
    v_exp_f32 v74, v74
    v_exp_f32 v75, v75
    v_cvt_pk_bf16_f32 v100, v72, v73
    v_cvt_pk_bf16_f32 v101, v74, v75
    v_mfma_f32_32x32x16_bf16 v[104:119], v[40:43], v[96:99], v[104:119]
    v_exp_f32 v76, v76
    v_exp_f32 v77, v77
    v_exp_f32 v78, v78
    v_exp_f32 v79, v79
    v_cvt_pk_bf16_f32 v102, v76, v77
    v_cvt_pk_bf16_f32 v103, v78, v79
    v_add_u32 v2, 37888, v2
    v_add_u32 v3, 37888, v3
    v_add_u32 v4, 37888, v4
    s_waitcnt vmcnt(13)
    s_barrier
    s_waitcnt lgkmcnt(0)
    v_mfma_f32_32x32x16_bf16 v[64:79], v[20:23], v[88:91], 0
    v_exp_f32 v48, v48
    v_exp_f32 v49, v49
    v_exp_f32 v50, v50
    v_exp_f32 v51, v51
    v_cvt_pk_bf16_f32 v96, v48, v49
    v_cvt_pk_bf16_f32 v97, v50, v51
    v_mfma_f32_32x32x16_bf16 v[104:119], v[44:47], v[100:103], v[104:119]
    ds_read_b128 v[16:19], v2 offset:4736
    ds_read_b32 v24, v3 offset:5760
    v_exp_f32 v52, v52
    v_exp_f32 v53, v53
    v_exp_f32 v54, v54
    v_exp_f32 v55, v55
    v_cvt_pk_bf16_f32 v98, v52, v53
    v_cvt_pk_bf16_f32 v99, v54, v55
    v_mfma_f32_32x32x16_bf16 v[64:79], v[28:31], v[92:95], v[64:79]
    s_mov_b64 exec, s[10:11]
    ds_read_b128 v[40:43], v4 offset:3520
    ds_read_b128 v[44:47], v4 offset:4128
    s_mov_b64 exec, -1
    v_exp_f32 v56, v56
    v_exp_f32 v57, v57
    v_exp_f32 v58, v58
    v_exp_f32 v59, v59
    v_cvt_pk_bf16_f32 v100, v56, v57
    v_cvt_pk_bf16_f32 v101, v58, v59
    v_mfma_f32_32x32x16_bf16 v[104:119], v[32:35], v[96:99], v[104:119]
    v_exp_f32 v60, v60
    v_exp_f32 v61, v61
    v_exp_f32 v62, v62
    v_exp_f32 v63, v63
    v_cvt_pk_bf16_f32 v102, v60, v61
    v_cvt_pk_bf16_f32 v103, v62, v63
    buffer_store_dwordx4 v[196:199], v1, s[44:47], s66 offen offset:1024 sc1
    s_waitcnt lgkmcnt(0)
    v_mfma_f32_32x32x16_bf16 v[48:63], v[16:19], v[88:91], 0
    v_exp_f32 v64, v64
    v_exp_f32 v65, v65
    v_exp_f32 v66, v66
    v_exp_f32 v67, v67
    v_cvt_pk_bf16_f32 v96, v64, v65
    v_cvt_pk_bf16_f32 v97, v66, v67
    v_mfma_f32_32x32x16_bf16 v[104:119], v[36:39], v[100:103], v[104:119]
    ds_read_b128 v[20:23], v2 offset:7104
    ds_read_b32 v28, v3 offset:8128
    v_exp_f32 v68, v68
    v_exp_f32 v69, v69
    v_exp_f32 v70, v70
    v_exp_f32 v71, v71
    v_cvt_pk_bf16_f32 v98, v68, v69
    v_cvt_pk_bf16_f32 v99, v70, v71
    v_mfma_f32_32x32x16_bf16 v[48:63], v[24:27], v[92:95], v[48:63]
    s_mov_b64 exec, s[10:11]
    ds_read_b128 v[32:35], v4 offset:5888
    ds_read_b128 v[36:39], v4 offset:6496
    s_mov_b64 exec, -1
    v_exp_f32 v72, v72
    v_exp_f32 v73, v73
    v_exp_f32 v74, v74
    v_exp_f32 v75, v75
    v_cvt_pk_bf16_f32 v100, v72, v73
    v_cvt_pk_bf16_f32 v101, v74, v75
    v_mfma_f32_32x32x16_bf16 v[104:119], v[40:43], v[96:99], v[104:119]
    v_exp_f32 v76, v76
    v_exp_f32 v77, v77
    v_exp_f32 v78, v78
    v_exp_f32 v79, v79
    v_cvt_pk_bf16_f32 v102, v76, v77
    v_cvt_pk_bf16_f32 v103, v78, v79
    s_waitcnt lgkmcnt(0)
    v_mfma_f32_32x32x16_bf16 v[64:79], v[20:23], v[88:91], 0
    v_exp_f32 v48, v48
    v_exp_f32 v49, v49
    v_exp_f32 v50, v50
    v_exp_f32 v51, v51
    v_cvt_pk_bf16_f32 v96, v48, v49
    v_cvt_pk_bf16_f32 v97, v50, v51
    v_mfma_f32_32x32x16_bf16 v[104:119], v[44:47], v[100:103], v[104:119]
    ds_read_b128 v[16:19], v2 offset:9472
    ds_read_b32 v24, v3 offset:10496
    v_exp_f32 v52, v52
    v_exp_f32 v53, v53
    v_exp_f32 v54, v54
    v_exp_f32 v55, v55
    v_cvt_pk_bf16_f32 v98, v52, v53
    v_cvt_pk_bf16_f32 v99, v54, v55
    v_mfma_f32_32x32x16_bf16 v[64:79], v[28:31], v[92:95], v[64:79]
    s_mov_b64 exec, s[10:11]
    ds_read_b128 v[40:43], v4 offset:8256
    ds_read_b128 v[44:47], v4 offset:8864
    s_mov_b64 exec, -1
    v_exp_f32 v56, v56
    v_exp_f32 v57, v57
    v_exp_f32 v58, v58
    v_exp_f32 v59, v59
    v_cvt_pk_bf16_f32 v100, v56, v57
    v_cvt_pk_bf16_f32 v101, v58, v59
    v_mfma_f32_32x32x16_bf16 v[104:119], v[32:35], v[96:99], v[104:119]
    v_exp_f32 v60, v60
    v_exp_f32 v61, v61
    v_exp_f32 v62, v62
    v_exp_f32 v63, v63
    v_cvt_pk_bf16_f32 v102, v60, v61
    v_cvt_pk_bf16_f32 v103, v62, v63
    v_cvt_pk_bf16_f32 v208, v208, v209
    v_cvt_pk_bf16_f32 v209, v210, v211
    v_cvt_pk_bf16_f32 v210, v212, v213
    v_cvt_pk_bf16_f32 v211, v214, v215
    v_cvt_pk_bf16_f32 v212, v216, v217
    v_cvt_pk_bf16_f32 v213, v218, v219
    v_cvt_pk_bf16_f32 v214, v220, v221
    v_cvt_pk_bf16_f32 v215, v222, v223
    buffer_store_dwordx4 v[208:211], v1, s[44:47], s67 offen sc1
    s_waitcnt lgkmcnt(0)
    v_mfma_f32_32x32x16_bf16 v[48:63], v[16:19], v[88:91], 0
    v_exp_f32 v64, v64
    v_exp_f32 v65, v65
    v_exp_f32 v66, v66
    v_exp_f32 v67, v67
    v_cvt_pk_bf16_f32 v96, v64, v65
    v_cvt_pk_bf16_f32 v97, v66, v67
    v_mfma_f32_32x32x16_bf16 v[104:119], v[36:39], v[100:103], v[104:119]
    ds_read_b128 v[20:23], v2 offset:11840
    ds_read_b32 v28, v3 offset:12864
    v_exp_f32 v68, v68
    v_exp_f32 v69, v69
    v_exp_f32 v70, v70
    v_exp_f32 v71, v71
    v_cvt_pk_bf16_f32 v98, v68, v69
    v_cvt_pk_bf16_f32 v99, v70, v71
    v_mfma_f32_32x32x16_bf16 v[48:63], v[24:27], v[92:95], v[48:63]
    s_mov_b64 exec, s[10:11]
    ds_read_b128 v[32:35], v4 offset:10624
    ds_read_b128 v[36:39], v4 offset:11232
    s_mov_b64 exec, -1
    v_exp_f32 v72, v72
    v_exp_f32 v73, v73
    v_exp_f32 v74, v74
    v_exp_f32 v75, v75
    v_cvt_pk_bf16_f32 v100, v72, v73
    v_cvt_pk_bf16_f32 v101, v74, v75
    v_mfma_f32_32x32x16_bf16 v[104:119], v[40:43], v[96:99], v[104:119]
    v_exp_f32 v76, v76
    v_exp_f32 v77, v77
    v_exp_f32 v78, v78
    v_exp_f32 v79, v79
    v_cvt_pk_bf16_f32 v102, v76, v77
    v_cvt_pk_bf16_f32 v103, v78, v79
    buffer_store_dwordx4 v[212:215], v1, s[44:47], s67 offen offset:1024 sc1
    s_waitcnt lgkmcnt(0)
    v_mfma_f32_32x32x16_bf16 v[64:79], v[20:23], v[88:91], 0
    v_exp_f32 v48, v48
    v_exp_f32 v49, v49
    v_exp_f32 v50, v50
    v_exp_f32 v51, v51
    v_cvt_pk_bf16_f32 v96, v48, v49
    v_cvt_pk_bf16_f32 v97, v50, v51
    v_mfma_f32_32x32x16_bf16 v[104:119], v[44:47], v[100:103], v[104:119]
    ds_read_b128 v[16:19], v2 offset:14208
    ds_read_b32 v24, v3 offset:15232
    v_exp_f32 v52, v52
    v_exp_f32 v53, v53
    v_exp_f32 v54, v54
    v_exp_f32 v55, v55
    v_cvt_pk_bf16_f32 v98, v52, v53
    v_cvt_pk_bf16_f32 v99, v54, v55
    v_mfma_f32_32x32x16_bf16 v[64:79], v[28:31], v[92:95], v[64:79]
    s_mov_b64 exec, s[10:11]
    ds_read_b128 v[40:43], v4 offset:12992
    ds_read_b128 v[44:47], v4 offset:13600
    s_mov_b64 exec, -1
    v_exp_f32 v56, v56
    v_exp_f32 v57, v57
    v_exp_f32 v58, v58
    v_exp_f32 v59, v59
    v_cvt_pk_bf16_f32 v100, v56, v57
    v_cvt_pk_bf16_f32 v101, v58, v59
    v_mfma_f32_32x32x16_bf16 v[104:119], v[32:35], v[96:99], v[104:119]
    v_exp_f32 v60, v60
    v_exp_f32 v61, v61
    v_exp_f32 v62, v62
    v_exp_f32 v63, v63
    v_cvt_pk_bf16_f32 v102, v60, v61
    v_cvt_pk_bf16_f32 v103, v62, v63
    s_waitcnt lgkmcnt(0)
    v_mfma_f32_32x32x16_bf16 v[48:63], v[16:19], v[88:91], 0
    v_exp_f32 v64, v64
    v_exp_f32 v65, v65
    v_exp_f32 v66, v66
    v_exp_f32 v67, v67
    v_cvt_pk_bf16_f32 v96, v64, v65
    v_cvt_pk_bf16_f32 v97, v66, v67
    v_mfma_f32_32x32x16_bf16 v[104:119], v[36:39], v[100:103], v[104:119]
    ds_read_b128 v[20:23], v2 offset:16576
    ds_read_b32 v28, v3 offset:17600
    v_exp_f32 v68, v68
    v_exp_f32 v69, v69
    v_exp_f32 v70, v70
    v_exp_f32 v71, v71
    v_cvt_pk_bf16_f32 v98, v68, v69
    v_cvt_pk_bf16_f32 v99, v70, v71
    v_mfma_f32_32x32x16_bf16 v[48:63], v[24:27], v[92:95], v[48:63]
    s_mov_b64 exec, s[10:11]
    ds_read_b128 v[32:35], v4 offset:15360
    ds_read_b128 v[36:39], v4 offset:15968
    s_mov_b64 exec, -1
    v_exp_f32 v72, v72
    v_exp_f32 v73, v73
    v_exp_f32 v74, v74
    v_exp_f32 v75, v75
    v_cvt_pk_bf16_f32 v100, v72, v73
    v_cvt_pk_bf16_f32 v101, v74, v75
    v_mfma_f32_32x32x16_bf16 v[104:119], v[40:43], v[96:99], v[104:119]
    v_exp_f32 v76, v76
    v_exp_f32 v77, v77
    v_exp_f32 v78, v78
    v_exp_f32 v79, v79
    v_cvt_pk_bf16_f32 v102, v76, v77
    v_cvt_pk_bf16_f32 v103, v78, v79
    v_cvt_pk_bf16_f32 v224, v224, v225
    v_cvt_pk_bf16_f32 v225, v226, v227
    v_cvt_pk_bf16_f32 v226, v228, v229
    v_cvt_pk_bf16_f32 v227, v230, v231
    v_cvt_pk_bf16_f32 v228, v232, v233
    v_cvt_pk_bf16_f32 v229, v234, v235
    v_cvt_pk_bf16_f32 v230, v236, v237
    v_cvt_pk_bf16_f32 v231, v238, v239
    buffer_store_dwordx4 v[224:227], v1, s[44:47], s68 offen sc1
    s_waitcnt lgkmcnt(0)
    v_mfma_f32_32x32x16_bf16 v[64:79], v[20:23], v[88:91], 0
    v_exp_f32 v48, v48
    v_exp_f32 v49, v49
    v_exp_f32 v50, v50
    v_exp_f32 v51, v51
    v_cvt_pk_bf16_f32 v96, v48, v49
    v_cvt_pk_bf16_f32 v97, v50, v51
    v_mfma_f32_32x32x16_bf16 v[104:119], v[44:47], v[100:103], v[104:119]
    ds_read_b128 v[16:19], v2 offset:18944
    ds_read_b32 v24, v3 offset:19968
    v_exp_f32 v52, v52
    v_exp_f32 v53, v53
    v_exp_f32 v54, v54
    v_exp_f32 v55, v55
    v_cvt_pk_bf16_f32 v98, v52, v53
    v_cvt_pk_bf16_f32 v99, v54, v55
    v_mfma_f32_32x32x16_bf16 v[64:79], v[28:31], v[92:95], v[64:79]
    s_mov_b64 exec, s[10:11]
    ds_read_b128 v[40:43], v4 offset:17728
    ds_read_b128 v[44:47], v4 offset:18336
    s_mov_b64 exec, -1
    v_exp_f32 v56, v56
    v_exp_f32 v57, v57
    v_exp_f32 v58, v58
    v_exp_f32 v59, v59
    v_cvt_pk_bf16_f32 v100, v56, v57
    v_cvt_pk_bf16_f32 v101, v58, v59
    v_mfma_f32_32x32x16_bf16 v[104:119], v[32:35], v[96:99], v[104:119]
    v_exp_f32 v60, v60
    v_exp_f32 v61, v61
    v_exp_f32 v62, v62
    v_exp_f32 v63, v63
    v_cvt_pk_bf16_f32 v102, v60, v61
    v_cvt_pk_bf16_f32 v103, v62, v63
    s_waitcnt lgkmcnt(0)
    v_mfma_f32_32x32x16_bf16 v[48:63], v[16:19], v[88:91], 0
    v_exp_f32 v64, v64
    v_exp_f32 v65, v65
    v_exp_f32 v66, v66
    v_exp_f32 v67, v67
    v_cvt_pk_bf16_f32 v96, v64, v65
    v_cvt_pk_bf16_f32 v97, v66, v67
    v_mfma_f32_32x32x16_bf16 v[104:119], v[36:39], v[100:103], v[104:119]
    ds_read_b128 v[20:23], v2 offset:21312
    ds_read_b32 v28, v3 offset:22336
    v_exp_f32 v68, v68
    v_exp_f32 v69, v69
    v_exp_f32 v70, v70
    v_exp_f32 v71, v71
    v_cvt_pk_bf16_f32 v98, v68, v69
    v_cvt_pk_bf16_f32 v99, v70, v71
    v_mfma_f32_32x32x16_bf16 v[48:63], v[24:27], v[92:95], v[48:63]
    s_mov_b64 exec, s[10:11]
    ds_read_b128 v[32:35], v4 offset:20096
    ds_read_b128 v[36:39], v4 offset:20704
    s_mov_b64 exec, -1
    v_exp_f32 v72, v72
    v_exp_f32 v73, v73
    v_exp_f32 v74, v74
    v_exp_f32 v75, v75
    v_cvt_pk_bf16_f32 v100, v72, v73
    v_cvt_pk_bf16_f32 v101, v74, v75
    v_mfma_f32_32x32x16_bf16 v[104:119], v[40:43], v[96:99], v[104:119]
    v_exp_f32 v76, v76
    v_exp_f32 v77, v77
    v_exp_f32 v78, v78
    v_exp_f32 v79, v79
    v_cvt_pk_bf16_f32 v102, v76, v77
    v_cvt_pk_bf16_f32 v103, v78, v79
    buffer_store_dwordx4 v[228:231], v1, s[44:47], s68 offen offset:1024 sc1
    s_waitcnt lgkmcnt(0)
    v_mfma_f32_32x32x16_bf16 v[64:79], v[20:23], v[88:91], 0
    v_exp_f32 v48, v48
    v_exp_f32 v49, v49
    v_exp_f32 v50, v50
    v_exp_f32 v51, v51
    v_cvt_pk_bf16_f32 v96, v48, v49
    v_cvt_pk_bf16_f32 v97, v50, v51
    v_mfma_f32_32x32x16_bf16 v[104:119], v[44:47], v[100:103], v[104:119]
    ds_read_b128 v[16:19], v2 offset:23680
    ds_read_b32 v24, v3 offset:24704
    v_exp_f32 v52, v52
    v_exp_f32 v53, v53
    v_exp_f32 v54, v54
    v_exp_f32 v55, v55
    v_cvt_pk_bf16_f32 v98, v52, v53
    v_cvt_pk_bf16_f32 v99, v54, v55
    v_mfma_f32_32x32x16_bf16 v[64:79], v[28:31], v[92:95], v[64:79]
    s_mov_b64 exec, s[10:11]
    ds_read_b128 v[40:43], v4 offset:22464
    ds_read_b128 v[44:47], v4 offset:23072
    s_mov_b64 exec, -1
    v_exp_f32 v56, v56
    v_exp_f32 v57, v57
    v_exp_f32 v58, v58
    v_exp_f32 v59, v59
    v_cvt_pk_bf16_f32 v100, v56, v57
    v_cvt_pk_bf16_f32 v101, v58, v59
    v_mfma_f32_32x32x16_bf16 v[104:119], v[32:35], v[96:99], v[104:119]
    v_exp_f32 v60, v60
    v_exp_f32 v61, v61
    v_exp_f32 v62, v62
    v_exp_f32 v63, v63
    v_cvt_pk_bf16_f32 v102, v60, v61
    v_cvt_pk_bf16_f32 v103, v62, v63
    v_cvt_pk_bf16_f32 v240, v240, v241
    v_cvt_pk_bf16_f32 v241, v242, v243
    v_cvt_pk_bf16_f32 v242, v244, v245
    v_cvt_pk_bf16_f32 v243, v246, v247
    v_cvt_pk_bf16_f32 v244, v248, v249
    v_cvt_pk_bf16_f32 v245, v250, v251
    v_cvt_pk_bf16_f32 v246, v252, v253
    v_cvt_pk_bf16_f32 v247, v254, v255
    buffer_store_dwordx4 v[240:243], v1, s[44:47], s69 offen sc1
    s_waitcnt lgkmcnt(0)
    v_mfma_f32_32x32x16_bf16 v[48:63], v[16:19], v[88:91], 0
    v_exp_f32 v64, v64
    v_exp_f32 v65, v65
    v_exp_f32 v66, v66
    v_exp_f32 v67, v67
    v_cvt_pk_bf16_f32 v96, v64, v65
    v_cvt_pk_bf16_f32 v97, v66, v67
    v_mfma_f32_32x32x16_bf16 v[104:119], v[36:39], v[100:103], v[104:119]
    ds_read_b128 v[20:23], v2 offset:26048
    ds_read_b32 v28, v3 offset:27072
    v_exp_f32 v68, v68
    v_exp_f32 v69, v69
    v_exp_f32 v70, v70
    v_exp_f32 v71, v71
    v_cvt_pk_bf16_f32 v98, v68, v69
    v_cvt_pk_bf16_f32 v99, v70, v71
    v_mfma_f32_32x32x16_bf16 v[48:63], v[24:27], v[92:95], v[48:63]
    s_mov_b64 exec, s[10:11]
    ds_read_b128 v[32:35], v4 offset:24832
    ds_read_b128 v[36:39], v4 offset:25440
    s_mov_b64 exec, -1
    v_exp_f32 v72, v72
    v_exp_f32 v73, v73
    v_exp_f32 v74, v74
    v_exp_f32 v75, v75
    v_cvt_pk_bf16_f32 v100, v72, v73
    v_cvt_pk_bf16_f32 v101, v74, v75
    v_mfma_f32_32x32x16_bf16 v[104:119], v[40:43], v[96:99], v[104:119]
    v_exp_f32 v76, v76
    v_exp_f32 v77, v77
    v_exp_f32 v78, v78
    v_exp_f32 v79, v79
    v_cvt_pk_bf16_f32 v102, v76, v77
    v_cvt_pk_bf16_f32 v103, v78, v79
    s_waitcnt lgkmcnt(0)
    v_mfma_f32_32x32x16_bf16 v[64:79], v[20:23], v[88:91], 0
    v_exp_f32 v48, v48
    v_exp_f32 v49, v49
    v_exp_f32 v50, v50
    v_exp_f32 v51, v51
    v_cvt_pk_bf16_f32 v96, v48, v49
    v_cvt_pk_bf16_f32 v97, v50, v51
    v_mfma_f32_32x32x16_bf16 v[104:119], v[44:47], v[100:103], v[104:119]
    ds_read_b128 v[16:19], v2 offset:28416
    ds_read_b32 v24, v3 offset:29440
    v_exp_f32 v52, v52
    v_exp_f32 v53, v53
    v_exp_f32 v54, v54
    v_exp_f32 v55, v55
    v_cvt_pk_bf16_f32 v98, v52, v53
    v_cvt_pk_bf16_f32 v99, v54, v55
    v_mfma_f32_32x32x16_bf16 v[64:79], v[28:31], v[92:95], v[64:79]
    s_mov_b64 exec, s[10:11]
    ds_read_b128 v[40:43], v4 offset:27200
    ds_read_b128 v[44:47], v4 offset:27808
    s_mov_b64 exec, -1
    v_exp_f32 v56, v56
    v_exp_f32 v57, v57
    v_exp_f32 v58, v58
    v_exp_f32 v59, v59
    v_cvt_pk_bf16_f32 v100, v56, v57
    v_cvt_pk_bf16_f32 v101, v58, v59
    v_mfma_f32_32x32x16_bf16 v[104:119], v[32:35], v[96:99], v[104:119]
    v_exp_f32 v60, v60
    v_exp_f32 v61, v61
    v_exp_f32 v62, v62
    v_exp_f32 v63, v63
    v_cvt_pk_bf16_f32 v102, v60, v61
    v_cvt_pk_bf16_f32 v103, v62, v63
    buffer_store_dwordx4 v[244:247], v1, s[44:47], s69 offen offset:1024 sc1
    s_waitcnt lgkmcnt(0)
    v_mfma_f32_32x32x16_bf16 v[48:63], v[16:19], v[88:91], 0
    v_exp_f32 v64, v64
    v_exp_f32 v65, v65
    v_exp_f32 v66, v66
    v_exp_f32 v67, v67
    v_cvt_pk_bf16_f32 v96, v64, v65
    v_cvt_pk_bf16_f32 v97, v66, v67
    v_mfma_f32_32x32x16_bf16 v[104:119], v[36:39], v[100:103], v[104:119]
    ds_read_b128 v[20:23], v2 offset:30784
    ds_read_b32 v28, v3 offset:31808
    v_exp_f32 v68, v68
    v_exp_f32 v69, v69
    v_exp_f32 v70, v70
    v_exp_f32 v71, v71
    v_cvt_pk_bf16_f32 v98, v68, v69
    v_cvt_pk_bf16_f32 v99, v70, v71
    v_mfma_f32_32x32x16_bf16 v[48:63], v[24:27], v[92:95], v[48:63]
    s_mov_b64 exec, s[10:11]
    ds_read_b128 v[32:35], v4 offset:29568
    ds_read_b128 v[36:39], v4 offset:30176
    s_mov_b64 exec, -1
    v_exp_f32 v72, v72
    v_exp_f32 v73, v73
    v_exp_f32 v74, v74
    v_exp_f32 v75, v75
    v_cvt_pk_bf16_f32 v100, v72, v73
    v_cvt_pk_bf16_f32 v101, v74, v75
    v_mfma_f32_32x32x16_bf16 v[104:119], v[40:43], v[96:99], v[104:119]
    v_exp_f32 v76, v76
    v_exp_f32 v77, v77
    v_exp_f32 v78, v78
    v_exp_f32 v79, v79
    v_cvt_pk_bf16_f32 v102, v76, v77
    v_cvt_pk_bf16_f32 v103, v78, v79
    s_waitcnt lgkmcnt(0)
    v_mfma_f32_32x32x16_bf16 v[64:79], v[20:23], v[88:91], 0
    v_exp_f32 v48, v48
    v_exp_f32 v49, v49
    v_exp_f32 v50, v50
    v_exp_f32 v51, v51
    v_cvt_pk_bf16_f32 v96, v48, v49
    v_cvt_pk_bf16_f32 v97, v50, v51
    v_mfma_f32_32x32x16_bf16 v[104:119], v[44:47], v[100:103], v[104:119]
    ds_read_b128 v[16:19], v2 offset:33152
    ds_read_b32 v24, v3 offset:34176
    v_exp_f32 v52, v52
    v_exp_f32 v53, v53
    v_exp_f32 v54, v54
    v_exp_f32 v55, v55
    v_cvt_pk_bf16_f32 v98, v52, v53
    v_cvt_pk_bf16_f32 v99, v54, v55
    v_mfma_f32_32x32x16_bf16 v[64:79], v[28:31], v[92:95], v[64:79]
    s_mov_b64 exec, s[10:11]
    ds_read_b128 v[40:43], v4 offset:31936
    ds_read_b128 v[44:47], v4 offset:32544
    s_mov_b64 exec, -1
    v_exp_f32 v56, v56
    v_exp_f32 v57, v57
    v_exp_f32 v58, v58
    v_exp_f32 v59, v59
    v_cvt_pk_bf16_f32 v100, v56, v57
    v_cvt_pk_bf16_f32 v101, v58, v59
    v_mfma_f32_32x32x16_bf16 v[104:119], v[32:35], v[96:99], v[104:119]
    v_exp_f32 v60, v60
    v_exp_f32 v61, v61
    v_exp_f32 v62, v62
    v_exp_f32 v63, v63
    v_cvt_pk_bf16_f32 v102, v60, v61
    v_cvt_pk_bf16_f32 v103, v62, v63
    s_waitcnt lgkmcnt(0)
    v_mfma_f32_32x32x16_bf16 v[48:63], v[16:19], v[88:91], 0
    v_exp_f32 v64, v64
    v_exp_f32 v65, v65
    v_exp_f32 v66, v66
    v_exp_f32 v67, v67
    v_cvt_pk_bf16_f32 v96, v64, v65
    v_cvt_pk_bf16_f32 v97, v66, v67
    v_mfma_f32_32x32x16_bf16 v[104:119], v[36:39], v[100:103], v[104:119]
    ds_read_b128 v[20:23], v2 offset:35520
    ds_read_b32 v28, v3 offset:36544
    v_exp_f32 v68, v68
    v_exp_f32 v69, v69
    v_exp_f32 v70, v70
    v_exp_f32 v71, v71
    v_cvt_pk_bf16_f32 v98, v68, v69
    v_cvt_pk_bf16_f32 v99, v70, v71
    v_mfma_f32_32x32x16_bf16 v[48:63], v[24:27], v[92:95], v[48:63]
    s_mov_b64 exec, s[10:11]
    ds_read_b128 v[32:35], v4 offset:34304
    ds_read_b128 v[36:39], v4 offset:34912
    s_mov_b64 exec, -1
    v_exp_f32 v72, v72
    v_exp_f32 v73, v73
    v_exp_f32 v74, v74
    v_exp_f32 v75, v75
    v_cvt_pk_bf16_f32 v100, v72, v73
    v_cvt_pk_bf16_f32 v101, v74, v75
    v_mfma_f32_32x32x16_bf16 v[104:119], v[40:43], v[96:99], v[104:119]
    v_exp_f32 v76, v76
    v_exp_f32 v77, v77
    v_exp_f32 v78, v78
    v_exp_f32 v79, v79
    v_cvt_pk_bf16_f32 v102, v76, v77
    v_cvt_pk_bf16_f32 v103, v78, v79
    s_waitcnt lgkmcnt(0)
    v_mfma_f32_32x32x16_bf16 v[64:79], v[20:23], v[88:91], 0
    v_exp_f32 v48, v48
    v_exp_f32 v49, v49
    v_exp_f32 v50, v50
    v_exp_f32 v51, v51
    v_cvt_pk_bf16_f32 v96, v48, v49
    v_cvt_pk_bf16_f32 v97, v50, v51
    v_mfma_f32_32x32x16_bf16 v[104:119], v[44:47], v[100:103], v[104:119]
    ds_read_b128 v[16:19], v2 offset:37888
    ds_read_b32 v24, v3 offset:38912
    v_exp_f32 v52, v52
    v_exp_f32 v53, v53
    v_exp_f32 v54, v54
    v_exp_f32 v55, v55
    v_cvt_pk_bf16_f32 v98, v52, v53
    v_cvt_pk_bf16_f32 v99, v54, v55
    v_mfma_f32_32x32x16_bf16 v[64:79], v[28:31], v[92:95], v[64:79]
    s_mov_b64 exec, s[10:11]
    ds_read_b128 v[40:43], v4 offset:36672
    ds_read_b128 v[44:47], v4 offset:37280
    s_mov_b64 exec, -1
    v_exp_f32 v56, v56
    v_exp_f32 v57, v57
    v_exp_f32 v58, v58
    v_exp_f32 v59, v59
    v_cvt_pk_bf16_f32 v100, v56, v57
    v_cvt_pk_bf16_f32 v101, v58, v59
    v_mfma_f32_32x32x16_bf16 v[104:119], v[32:35], v[96:99], v[104:119]
    v_exp_f32 v60, v60
    v_exp_f32 v61, v61
    v_exp_f32 v62, v62
    v_exp_f32 v63, v63
    v_cvt_pk_bf16_f32 v102, v60, v61
    v_cvt_pk_bf16_f32 v103, v62, v63
    s_waitcnt vmcnt(0)
    s_barrier
    s_cmp_lg_u32 s3, 6
    s_cbranch_scc1 ATT_NOPUB
    s_lshl_b32 s56, s4, 7
    s_lshl_b32 s57, s5, 3
    s_add_u32 s56, s56, s57
    s_add_u32 s56, s56, 5550080
    v_mov_b32 v6, s76
    v_mov_b32 v7, s77
    s_mov_b32 exec_lo, 1
    s_mov_b32 exec_hi, 0
    buffer_store_dwordx2 v[6:7], off, s[44:47], s56 sc1
    s_mov_b64 exec, -1
    s_nop 1
    v_and_b32 v8, 15, v0
    v_lshlrev_b32 v8, 3, v8
    v_and_b32 v9, 1, v0
    v_lshlrev_b32 v9, 6, v9
ATT_NOPUB:
    s_lshr_b32 s63, s5, 2
    s_lshl_b32 s57, s4, 2
    s_add_u32 s63, s63, s57
    s_mul_i32 s56, s63, 36
    s_and_b32 s57, s5, 3
    s_mul_i32 s64, s57, 9
    s_add_u32 s73, s56, s64
    s_and_b32 s60, s3, 6
    s_add_u32 s60, s60, s73
    s_lshl_b32 s60, s60, 10
    s_and_b32 s58, s3, 1
    s_mul_i32 s58, s58, 18874368
    s_add_u32 s60, s60, s58
    s_add_u32 s60, s60, 5570560
    s_add_u32 s61, s73, 8
    s_lshl_b32 s61, s61, 10
    s_mul_i32 s58, s3, 4718592
    s_add_u32 s61, s61, s58
    s_add_u32 s61, s61, 5570560
    v_bfe_u32 v10, v0, 1, 1
    v_bfe_u32 v11, v0, 3, 1
    v_lshl_add_u32 v10, v11, 1, v10
    v_lshrrev_b32 v11, 3, v0
    v_xor_b32 v11, v11, v0
    v_and_b32 v11, 4, v11
    v_or_b32 v10, v10, v11
    v_bfe_u32 v11, v0, 4, 1
    v_lshl_add_u32 v10, v11, 3, v10
    v_and_b32 v11, 1, v0
    v_lshlrev_b32 v11, 4, v11
    v_mov_b32 v252, 0x3f80
    v_lshlrev_b32 v11, v11, v252
    v_cmp_eq_u32 vcc, 0, v10
    s_nop 1
    v_cndmask_b32 v12, 0, v11, vcc
    v_cmp_eq_u32 vcc, 1, v10
    s_nop 1
    v_cndmask_b32 v13, 0, v11, vcc
    v_cmp_eq_u32 vcc, 2, v10
    s_nop 1
    v_cndmask_b32 v14, 0, v11, vcc
    v_cmp_eq_u32 vcc, 3, v10
    s_nop 1
    v_cndmask_b32 v15, 0, v11, vcc
    v_cmp_eq_u32 vcc, 8, v10
    s_nop 1
    v_cndmask_b32 v84, 0, v11, vcc
    v_cmp_eq_u32 vcc, 9, v10
    s_nop 1
    v_cndmask_b32 v85, 0, v11, vcc
    v_cmp_eq_u32 vcc, 10, v10
    s_nop 1
    v_cndmask_b32 v86, 0, v11, vcc
    v_cmp_eq_u32 vcc, 11, v10
    s_nop 1
    v_cndmask_b32 v87, 0, v11, vcc
    v_and_b32 v252, 31, v0
    v_mul_u32_u24 v252, 1152, v252
    v_lshrrev_b32 v253, 5, v0
    v_lshl_add_u32 v252, v253, 3, v252
    s_and_b32 s56, s3, 3
    s_lshl_b32 s56, s56, 3
    v_and_b32 v253, 7, v0
    v_add_u32 v253, s56, v253
    v_mul_u32_u24 v253, 1152, v253
    s_lshr_b32 s56, s3, 2
    s_lshl_b32 s56, s56, 3
    v_add_u32 v253, s56, v253
    s_mul_i32 s65, s63, 36864
    s_lshl_b32 s56, s64, 5
    s_add_u32 s65, s65, s56
    s_add_u32 s66, s65, 256
    s_lshl_b32 s56, s3, 5
    s_add_u32 s65, s65, s56
    buffer_load_dwordx2 v[120:121], v252, s[40:43], s65 offen
    buffer_load_dwordx2 v[122:123], v252, s[40:43], s65 offen offset:16
    buffer_load_dwordx2 v[124:125], v253, s[40:43], s66 offen
    buffer_load_dwordx2 v[126:127], v253, s[40:43], s66 offen offset:16
    s_waitcnt lgkmcnt(0)
    v_mfma_f32_32x32x16_bf16 v[48:63], v[16:19], v[88:91], 0
    v_exp_f32 v64, v64
    v_exp_f32 v65, v65
    v_exp_f32 v66, v66
    v_exp_f32 v67, v67
    v_cvt_pk_bf16_f32 v96, v64, v65
    v_cvt_pk_bf16_f32 v97, v66, v67
    v_mfma_f32_32x32x16_bf16 v[104:119], v[36:39], v[100:103], v[104:119]
    ds_read_b128 v[20:23], v2 offset:40256
    ds_read_b32 v28, v3 offset:41280
    v_exp_f32 v68, v68
    v_exp_f32 v69, v69
    v_exp_f32 v70, v70
    v_exp_f32 v71, v71
    v_cvt_pk_bf16_f32 v98, v68, v69
    v_cvt_pk_bf16_f32 v99, v70, v71
    v_mfma_f32_32x32x16_bf16 v[48:63], v[24:27], v[92:95], v[48:63]
    s_mov_b64 exec, s[10:11]
    ds_read_b128 v[32:35], v4 offset:39040
    ds_read_b128 v[36:39], v4 offset:39648
    s_mov_b64 exec, -1
    v_exp_f32 v72, v72
    v_exp_f32 v73, v73
    v_exp_f32 v74, v74
    v_exp_f32 v75, v75
    v_cvt_pk_bf16_f32 v100, v72, v73
    v_cvt_pk_bf16_f32 v101, v74, v75
    v_mfma_f32_32x32x16_bf16 v[104:119], v[40:43], v[96:99], v[104:119]
    v_exp_f32 v76, v76
    v_exp_f32 v77, v77
    v_exp_f32 v78, v78
    v_exp_f32 v79, v79
    v_cvt_pk_bf16_f32 v102, v76, v77
    v_cvt_pk_bf16_f32 v103, v78, v79
    v_add_u32 v2, 37888, v2
    v_add_u32 v3, 37888, v3
    v_add_u32 v4, 37888, v4
    s_waitcnt lgkmcnt(0)
    v_mfma_f32_32x32x16_bf16 v[64:79], v[20:23], v[88:91], 0
    v_exp_f32 v48, v48
    v_exp_f32 v49, v49
    v_exp_f32 v50, v50
    v_exp_f32 v51, v51
    v_cvt_pk_bf16_f32 v96, v48, v49
    v_cvt_pk_bf16_f32 v97, v50, v51
    v_mfma_f32_32x32x16_bf16 v[104:119], v[44:47], v[100:103], v[104:119]
    ds_read_b128 v[16:19], v2 offset:4736
    ds_read_b32 v24, v3 offset:5760
    v_exp_f32 v52, v52
    v_exp_f32 v53, v53
    v_exp_f32 v54, v54
    v_exp_f32 v55, v55
    v_cvt_pk_bf16_f32 v98, v52, v53
    v_cvt_pk_bf16_f32 v99, v54, v55
    v_mfma_f32_32x32x16_bf16 v[64:79], v[28:31], v[92:95], v[64:79]
    s_mov_b64 exec, s[10:11]
    ds_read_b128 v[40:43], v4 offset:3520
    ds_read_b128 v[44:47], v4 offset:4128
    s_mov_b64 exec, -1
    v_exp_f32 v56, v56
    v_exp_f32 v57, v57
    v_exp_f32 v58, v58
    v_exp_f32 v59, v59
    v_cvt_pk_bf16_f32 v100, v56, v57
    v_cvt_pk_bf16_f32 v101, v58, v59
    v_mfma_f32_32x32x16_bf16 v[104:119], v[32:35], v[96:99], v[104:119]
    v_exp_f32 v60, v60
    v_exp_f32 v61, v61
    v_exp_f32 v62, v62
    v_exp_f32 v63, v63
    v_cvt_pk_bf16_f32 v102, v60, v61
    v_cvt_pk_bf16_f32 v103, v62, v63
    s_waitcnt lgkmcnt(0)
    v_mfma_f32_32x32x16_bf16 v[48:63], v[16:19], v[88:91], 0
    v_exp_f32 v64, v64
    v_exp_f32 v65, v65
    v_exp_f32 v66, v66
    v_exp_f32 v67, v67
    v_cvt_pk_bf16_f32 v96, v64, v65
    v_cvt_pk_bf16_f32 v97, v66, v67
    v_mfma_f32_32x32x16_bf16 v[104:119], v[36:39], v[100:103], v[104:119]
    ds_read_b128 v[20:23], v2 offset:7104
    ds_read_b32 v28, v3 offset:8128
    v_exp_f32 v68, v68
    v_exp_f32 v69, v69
    v_exp_f32 v70, v70
    v_exp_f32 v71, v71
    v_cvt_pk_bf16_f32 v98, v68, v69
    v_cvt_pk_bf16_f32 v99, v70, v71
    v_mfma_f32_32x32x16_bf16 v[48:63], v[24:27], v[92:95], v[48:63]
    s_mov_b64 exec, s[10:11]
    ds_read_b128 v[32:35], v4 offset:5888
    ds_read_b128 v[36:39], v4 offset:6496
    s_mov_b64 exec, -1
    v_exp_f32 v72, v72
    v_exp_f32 v73, v73
    v_exp_f32 v74, v74
    v_exp_f32 v75, v75
    v_cvt_pk_bf16_f32 v100, v72, v73
    v_cvt_pk_bf16_f32 v101, v74, v75
    v_mfma_f32_32x32x16_bf16 v[104:119], v[40:43], v[96:99], v[104:119]
    v_exp_f32 v76, v76
    v_exp_f32 v77, v77
    v_exp_f32 v78, v78
    v_exp_f32 v79, v79
    v_cvt_pk_bf16_f32 v102, v76, v77
    v_cvt_pk_bf16_f32 v103, v78, v79
    s_waitcnt lgkmcnt(0)
    v_mfma_f32_32x32x16_bf16 v[64:79], v[20:23], v[88:91], 0
    v_exp_f32 v48, v48
    v_exp_f32 v49, v49
    v_exp_f32 v50, v50
    v_exp_f32 v51, v51
    v_cvt_pk_bf16_f32 v96, v48, v49
    v_cvt_pk_bf16_f32 v97, v50, v51
    v_mfma_f32_32x32x16_bf16 v[104:119], v[44:47], v[100:103], v[104:119]
    ds_read_b128 v[16:19], v2 offset:9472
    ds_read_b32 v24, v3 offset:10496
    v_exp_f32 v52, v52
    v_exp_f32 v53, v53
    v_exp_f32 v54, v54
    v_exp_f32 v55, v55
    v_cvt_pk_bf16_f32 v98, v52, v53
    v_cvt_pk_bf16_f32 v99, v54, v55
    v_mfma_f32_32x32x16_bf16 v[64:79], v[28:31], v[92:95], v[64:79]
    s_mov_b64 exec, s[10:11]
    ds_read_b128 v[40:43], v4 offset:8256
    ds_read_b128 v[44:47], v4 offset:8864
    s_mov_b64 exec, -1
    v_exp_f32 v56, v56
    v_exp_f32 v57, v57
    v_exp_f32 v58, v58
    v_exp_f32 v59, v59
    v_cvt_pk_bf16_f32 v100, v56, v57
    v_cvt_pk_bf16_f32 v101, v58, v59
    v_mfma_f32_32x32x16_bf16 v[104:119], v[32:35], v[96:99], v[104:119]
    v_exp_f32 v60, v60
    v_exp_f32 v61, v61
    v_exp_f32 v62, v62
    v_exp_f32 v63, v63
    v_cvt_pk_bf16_f32 v102, v60, v61
    v_cvt_pk_bf16_f32 v103, v62, v63
    s_waitcnt lgkmcnt(0)
    v_mfma_f32_32x32x16_bf16 v[48:63], v[16:19], v[88:91], 0
    v_exp_f32 v64, v64
    v_exp_f32 v65, v65
    v_exp_f32 v66, v66
    v_exp_f32 v67, v67
    v_cvt_pk_bf16_f32 v96, v64, v65
    v_cvt_pk_bf16_f32 v97, v66, v67
    v_mfma_f32_32x32x16_bf16 v[104:119], v[36:39], v[100:103], v[104:119]
    ds_read_b128 v[20:23], v2 offset:11840
    ds_read_b32 v28, v3 offset:12864
    v_exp_f32 v68, v68
    v_exp_f32 v69, v69
    v_exp_f32 v70, v70
    v_exp_f32 v71, v71
    v_cvt_pk_bf16_f32 v98, v68, v69
    v_cvt_pk_bf16_f32 v99, v70, v71
    v_mfma_f32_32x32x16_bf16 v[48:63], v[24:27], v[92:95], v[48:63]
    s_mov_b64 exec, s[10:11]
    ds_read_b128 v[32:35], v4 offset:10624
    ds_read_b128 v[36:39], v4 offset:11232
    s_mov_b64 exec, -1
    v_exp_f32 v72, v72
    v_exp_f32 v73, v73
    v_exp_f32 v74, v74
    v_exp_f32 v75, v75
    v_cvt_pk_bf16_f32 v100, v72, v73
    v_cvt_pk_bf16_f32 v101, v74, v75
    v_mfma_f32_32x32x16_bf16 v[104:119], v[40:43], v[96:99], v[104:119]
    v_exp_f32 v76, v76
    v_exp_f32 v77, v77
    v_exp_f32 v78, v78
    v_exp_f32 v79, v79
    v_cvt_pk_bf16_f32 v102, v76, v77
    v_cvt_pk_bf16_f32 v103, v78, v79
    s_waitcnt lgkmcnt(0)
    v_mfma_f32_32x32x16_bf16 v[64:79], v[20:23], v[88:91], 0
    v_exp_f32 v48, v48
    v_exp_f32 v49, v49
    v_exp_f32 v50, v50
    v_exp_f32 v51, v51
    v_cvt_pk_bf16_f32 v96, v48, v49
    v_cvt_pk_bf16_f32 v97, v50, v51
    v_mfma_f32_32x32x16_bf16 v[104:119], v[44:47], v[100:103], v[104:119]
    ds_read_b128 v[16:19], v2 offset:14208
    ds_read_b32 v24, v3 offset:15232
    v_exp_f32 v52, v52
    v_exp_f32 v53, v53
    v_exp_f32 v54, v54
    v_exp_f32 v55, v55
    v_cvt_pk_bf16_f32 v98, v52, v53
    v_cvt_pk_bf16_f32 v99, v54, v55
    v_mfma_f32_32x32x16_bf16 v[64:79], v[28:31], v[92:95], v[64:79]
    s_mov_b64 exec, s[10:11]
    ds_read_b128 v[40:43], v4 offset:12992
    ds_read_b128 v[44:47], v4 offset:13600
    s_mov_b64 exec, -1
    v_exp_f32 v56, v56
    v_exp_f32 v57, v57
    v_exp_f32 v58, v58
    v_exp_f32 v59, v59
    v_cvt_pk_bf16_f32 v100, v56, v57
    v_cvt_pk_bf16_f32 v101, v58, v59
    v_mfma_f32_32x32x16_bf16 v[104:119], v[32:35], v[96:99], v[104:119]
    v_exp_f32 v60, v60
    v_exp_f32 v61, v61
    v_exp_f32 v62, v62
    v_exp_f32 v63, v63
    v_cvt_pk_bf16_f32 v102, v60, v61
    v_cvt_pk_bf16_f32 v103, v62, v63
    s_waitcnt lgkmcnt(0)
    v_mfma_f32_32x32x16_bf16 v[48:63], v[16:19], v[88:91], 0
    v_exp_f32 v64, v64
    v_exp_f32 v65, v65
    v_exp_f32 v66, v66
    v_exp_f32 v67, v67
    v_cvt_pk_bf16_f32 v96, v64, v65
    v_cvt_pk_bf16_f32 v97, v66, v67
    v_mfma_f32_32x32x16_bf16 v[104:119], v[36:39], v[100:103], v[104:119]
    ds_read_b128 v[20:23], v2 offset:16576
    ds_read_b32 v28, v3 offset:17600
    v_exp_f32 v68, v68
    v_exp_f32 v69, v69
    v_exp_f32 v70, v70
    v_exp_f32 v71, v71
    v_cvt_pk_bf16_f32 v98, v68, v69
    v_cvt_pk_bf16_f32 v99, v70, v71
    v_mfma_f32_32x32x16_bf16 v[48:63], v[24:27], v[92:95], v[48:63]
    s_mov_b64 exec, s[10:11]
    ds_read_b128 v[32:35], v4 offset:15360
    ds_read_b128 v[36:39], v4 offset:15968
    s_mov_b64 exec, -1
    v_exp_f32 v72, v72
    v_exp_f32 v73, v73
    v_exp_f32 v74, v74
    v_exp_f32 v75, v75
    v_cvt_pk_bf16_f32 v100, v72, v73
    v_cvt_pk_bf16_f32 v101, v74, v75
    v_mfma_f32_32x32x16_bf16 v[104:119], v[40:43], v[96:99], v[104:119]
    v_exp_f32 v76, v76
    v_exp_f32 v77, v77
    v_exp_f32 v78, v78
    v_exp_f32 v79, v79
    v_cvt_pk_bf16_f32 v102, v76, v77
    v_cvt_pk_bf16_f32 v103, v78, v79
    s_waitcnt lgkmcnt(0)
    v_mfma_f32_32x32x16_bf16 v[64:79], v[20:23], v[88:91], 0
    v_exp_f32 v48, v48
    v_exp_f32 v49, v49
    v_exp_f32 v50, v50
    v_exp_f32 v51, v51
    v_cvt_pk_bf16_f32 v96, v48, v49
    v_cvt_pk_bf16_f32 v97, v50, v51
    v_mfma_f32_32x32x16_bf16 v[104:119], v[44:47], v[100:103], v[104:119]
    ds_read_b128 v[16:19], v2 offset:18944
    ds_read_b32 v24, v3 offset:19968
    v_exp_f32 v52, v52
    v_exp_f32 v53, v53
    v_exp_f32 v54, v54
    v_exp_f32 v55, v55
    v_cvt_pk_bf16_f32 v98, v52, v53
    v_cvt_pk_bf16_f32 v99, v54, v55
    v_mfma_f32_32x32x16_bf16 v[64:79], v[28:31], v[92:95], v[64:79]
    s_mov_b64 exec, s[10:11]
    ds_read_b128 v[40:43], v4 offset:17728
    ds_read_b128 v[44:47], v4 offset:18336
    s_mov_b64 exec, -1
    v_exp_f32 v56, v56
    v_exp_f32 v57, v57
    v_exp_f32 v58, v58
    v_exp_f32 v59, v59
    v_cvt_pk_bf16_f32 v100, v56, v57
    v_cvt_pk_bf16_f32 v101, v58, v59
    v_mfma_f32_32x32x16_bf16 v[104:119], v[32:35], v[96:99], v[104:119]
    v_exp_f32 v60, v60
    v_exp_f32 v61, v61
    v_exp_f32 v62, v62
    v_exp_f32 v63, v63
    v_cvt_pk_bf16_f32 v102, v60, v61
    v_cvt_pk_bf16_f32 v103, v62, v63
    s_waitcnt lgkmcnt(0)
    v_mfma_f32_32x32x16_bf16 v[48:63], v[16:19], v[88:91], 0
    v_exp_f32 v64, v64
    v_exp_f32 v65, v65
    v_exp_f32 v66, v66
    v_exp_f32 v67, v67
    v_cvt_pk_bf16_f32 v96, v64, v65
    v_cvt_pk_bf16_f32 v97, v66, v67
    v_mfma_f32_32x32x16_bf16 v[104:119], v[36:39], v[100:103], v[104:119]
    ds_read_b128 v[20:23], v2 offset:21312
    ds_read_b32 v28, v3 offset:22336
    v_exp_f32 v68, v68
    v_exp_f32 v69, v69
    v_exp_f32 v70, v70
    v_exp_f32 v71, v71
    v_cvt_pk_bf16_f32 v98, v68, v69
    v_cvt_pk_bf16_f32 v99, v70, v71
    v_mfma_f32_32x32x16_bf16 v[48:63], v[24:27], v[92:95], v[48:63]
    s_mov_b64 exec, s[10:11]
    ds_read_b128 v[32:35], v4 offset:20096
    ds_read_b128 v[36:39], v4 offset:20704
    s_mov_b64 exec, -1
    v_exp_f32 v72, v72
    v_exp_f32 v73, v73
    v_exp_f32 v74, v74
    v_exp_f32 v75, v75
    v_cvt_pk_bf16_f32 v100, v72, v73
    v_cvt_pk_bf16_f32 v101, v74, v75
    v_mfma_f32_32x32x16_bf16 v[104:119], v[40:43], v[96:99], v[104:119]
    v_exp_f32 v76, v76
    v_exp_f32 v77, v77
    v_exp_f32 v78, v78
    v_exp_f32 v79, v79
    v_cvt_pk_bf16_f32 v102, v76, v77
    v_cvt_pk_bf16_f32 v103, v78, v79
    s_waitcnt lgkmcnt(0)
    v_mfma_f32_32x32x16_bf16 v[64:79], v[20:23], v[88:91], 0
    v_exp_f32 v48, v48
    v_exp_f32 v49, v49
    v_exp_f32 v50, v50
    v_exp_f32 v51, v51
    v_cvt_pk_bf16_f32 v96, v48, v49
    v_cvt_pk_bf16_f32 v97, v50, v51
    v_mfma_f32_32x32x16_bf16 v[104:119], v[44:47], v[100:103], v[104:119]
    ds_read_b128 v[16:19], v2 offset:23680
    ds_read_b32 v24, v3 offset:24704
    v_exp_f32 v52, v52
    v_exp_f32 v53, v53
    v_exp_f32 v54, v54
    v_exp_f32 v55, v55
    v_cvt_pk_bf16_f32 v98, v52, v53
    v_cvt_pk_bf16_f32 v99, v54, v55
    v_mfma_f32_32x32x16_bf16 v[64:79], v[28:31], v[92:95], v[64:79]
    s_mov_b64 exec, s[10:11]
    ds_read_b128 v[40:43], v4 offset:22464
    ds_read_b128 v[44:47], v4 offset:23072
    s_mov_b64 exec, -1
    v_exp_f32 v56, v56
    v_exp_f32 v57, v57
    v_exp_f32 v58, v58
    v_exp_f32 v59, v59
    v_cvt_pk_bf16_f32 v100, v56, v57
    v_cvt_pk_bf16_f32 v101, v58, v59
    v_mfma_f32_32x32x16_bf16 v[104:119], v[32:35], v[96:99], v[104:119]
    v_exp_f32 v60, v60
    v_exp_f32 v61, v61
    v_exp_f32 v62, v62
    v_exp_f32 v63, v63
    v_cvt_pk_bf16_f32 v102, v60, v61
    v_cvt_pk_bf16_f32 v103, v62, v63
    s_cmp_lg_u32 s3, 6
    s_cbranch_scc1 ATT_NOP1
    s_lshl_b32 s62, s4, 7
    s_add_u32 s62, s62, 5550080
    buffer_load_dwordx2 v[6:7], v8, s[44:47], s62 offen sc1
    buffer_load_dword v5, v9, s[52:55], 0 offen offset:132 sc1
ATT_NOP1:
    s_waitcnt lgkmcnt(0)
    v_mfma_f32_32x32x16_bf16 v[48:63], v[16:19], v[88:91], 0
    v_exp_f32 v64, v64
    v_exp_f32 v65, v65
    v_exp_f32 v66, v66
    v_exp_f32 v67, v67
    v_cvt_pk_bf16_f32 v96, v64, v65
    v_cvt_pk_bf16_f32 v97, v66, v67
    v_mfma_f32_32x32x16_bf16 v[104:119], v[36:39], v[100:103], v[104:119]
    ds_read_b128 v[20:23], v2 offset:26048
    ds_read_b32 v28, v3 offset:27072
    v_exp_f32 v68, v68
    v_exp_f32 v69, v69
    v_exp_f32 v70, v70
    v_exp_f32 v71, v71
    v_cvt_pk_bf16_f32 v98, v68, v69
    v_cvt_pk_bf16_f32 v99, v70, v71
    v_mfma_f32_32x32x16_bf16 v[48:63], v[24:27], v[92:95], v[48:63]
    s_mov_b64 exec, s[10:11]
    ds_read_b128 v[32:35], v4 offset:24832
    ds_read_b128 v[36:39], v4 offset:25440
    s_mov_b64 exec, -1
    v_exp_f32 v72, v72
    v_exp_f32 v73, v73
    v_exp_f32 v74, v74
    v_exp_f32 v75, v75
    v_cvt_pk_bf16_f32 v100, v72, v73
    v_cvt_pk_bf16_f32 v101, v74, v75
    v_mfma_f32_32x32x16_bf16 v[104:119], v[40:43], v[96:99], v[104:119]
    v_exp_f32 v76, v76
    v_exp_f32 v77, v77
    v_exp_f32 v78, v78
    v_exp_f32 v79, v79
    v_cvt_pk_bf16_f32 v102, v76, v77
    v_cvt_pk_bf16_f32 v103, v78, v79
    s_waitcnt lgkmcnt(0)
    v_mfma_f32_32x32x16_bf16 v[64:79], v[20:23], v[88:91], 0
    v_exp_f32 v48, v48
    v_exp_f32 v49, v49
    v_exp_f32 v50, v50
    v_exp_f32 v51, v51
    v_cvt_pk_bf16_f32 v96, v48, v49
    v_cvt_pk_bf16_f32 v97, v50, v51
    v_mfma_f32_32x32x16_bf16 v[104:119], v[44:47], v[100:103], v[104:119]
    ds_read_b128 v[16:19], v2 offset:28416
    ds_read_b32 v24, v3 offset:29440
    v_exp_f32 v52, v52
    v_exp_f32 v53, v53
    v_exp_f32 v54, v54
    v_exp_f32 v55, v55
    v_cvt_pk_bf16_f32 v98, v52, v53
    v_cvt_pk_bf16_f32 v99, v54, v55
    v_mfma_f32_32x32x16_bf16 v[64:79], v[28:31], v[92:95], v[64:79]
    s_mov_b64 exec, s[10:11]
    ds_read_b128 v[40:43], v4 offset:27200
    ds_read_b128 v[44:47], v4 offset:27808
    s_mov_b64 exec, -1
    v_exp_f32 v56, v56
    v_exp_f32 v57, v57
    v_exp_f32 v58, v58
    v_exp_f32 v59, v59
    v_cvt_pk_bf16_f32 v100, v56, v57
    v_cvt_pk_bf16_f32 v101, v58, v59
    v_mfma_f32_32x32x16_bf16 v[104:119], v[32:35], v[96:99], v[104:119]
    v_exp_f32 v60, v60
    v_exp_f32 v61, v61
    v_exp_f32 v62, v62
    v_exp_f32 v63, v63
    v_cvt_pk_bf16_f32 v102, v60, v61
    v_cvt_pk_bf16_f32 v103, v62, v63
    s_cmp_lg_u32 s3, 6
    s_cbranch_scc1 ATT_NOBUMP
    s_mov_b32 s68, 0
ATT_POLL:
    s_waitcnt vmcnt(0)
    v_cmp_eq_u32 vcc, s76, v6
    v_cmp_eq_u32 s[74:75], s77, v7
    s_nop 3
    s_and_b64 vcc, vcc, s[74:75]
    v_mov_b32 v10, 128
    v_cmp_ge_u32 s[74:75], v5, v10
    s_nop 3
    s_and_b64 vcc, vcc, s[74:75]
    s_cmp_eq_u64 vcc, -1
    s_cbranch_scc1 ATT_POLL_OK
    s_add_u32 s68, s68, 1
    s_cmp_ge_u32 s68, 0x8000
    s_cbranch_scc1 ATT_POLL_OK
    s_sleep 8
    s_lshl_b32 s62, s4, 7
    s_add_u32 s62, s62, 5550080
    buffer_load_dwordx2 v[6:7], v8, s[44:47], s62 offen sc1
    buffer_load_dword v5, v9, s[52:55], 0 offen offset:132 sc1
    s_branch ATT_POLL
ATT_POLL_OK:
    s_cmp_lg_u32 s5, 0
    s_cbranch_scc1 ATT_NOBUMP
    v_mov_b32 v10, s76
    v_mov_b32 v11, s77
    s_lshl_b32 s56, s4, 7
    s_add_u32 s56, s56, 5554176
    s_mov_b32 exec_lo, 1
    s_mov_b32 exec_hi, 0
    buffer_store_dwordx2 v[10:11], off, s[44:47], s56 sc1
    s_mov_b64 exec, -1
    s_nop 1
ATT_NOBUMP:
    s_barrier
    s_lshr_b32 s56, s2, 3
    s_lshl_b32 s56, s56, 3
    s_add_u32 s56, s56, s3
    s_lshl_b32 s56, s56, 13
    s_min_u32 s56, s56, 655360
    s_add_u32 s56, s56, 4882432
    v_lshlrev_b32 v10, 7, v0
    buffer_load_dword v11, v10, s[44:47], s56 offen
    buffer_load_dwordx4 v[148:151], v1, s[44:47], s61 offen sc1
    s_add_u32 s61, s61, 2359296
    s_waitcnt lgkmcnt(0)
    v_mfma_f32_32x32x16_bf16 v[48:63], v[16:19], v[88:91], 0
    v_exp_f32 v64, v64
    v_exp_f32 v65, v65
    v_exp_f32 v66, v66
    v_exp_f32 v67, v67
    v_cvt_pk_bf16_f32 v96, v64, v65
    v_cvt_pk_bf16_f32 v97, v66, v67
    v_mfma_f32_32x32x16_bf16 v[104:119], v[36:39], v[100:103], v[104:119]
    ds_read_b128 v[20:23], v2 offset:30784
    ds_read_b32 v28, v3 offset:31808
    v_exp_f32 v68, v68
    v_exp_f32 v69, v69
    v_exp_f32 v70, v70
    v_exp_f32 v71, v71
    v_cvt_pk_bf16_f32 v98, v68, v69
    v_cvt_pk_bf16_f32 v99, v70, v71
    v_mfma_f32_32x32x16_bf16 v[48:63], v[24:27], v[92:95], v[48:63]
    s_mov_b64 exec, s[10:11]
    ds_read_b128 v[32:35], v4 offset:29568
    ds_read_b128 v[36:39], v4 offset:30176
    s_mov_b64 exec, -1
    v_exp_f32 v72, v72
    v_exp_f32 v73, v73
    v_exp_f32 v74, v74
    v_exp_f32 v75, v75
    v_cvt_pk_bf16_f32 v100, v72, v73
    v_cvt_pk_bf16_f32 v101, v74, v75
    v_mfma_f32_32x32x16_bf16 v[104:119], v[40:43], v[96:99], v[104:119]
    v_exp_f32 v76, v76
    v_exp_f32 v77, v77
    v_exp_f32 v78, v78
    v_exp_f32 v79, v79
    v_cvt_pk_bf16_f32 v102, v76, v77
    v_cvt_pk_bf16_f32 v103, v78, v79
    buffer_load_dwordx4 v[152:155], v1, s[44:47], s61 offen sc1
    s_add_u32 s61, s61, 2359296
    s_waitcnt lgkmcnt(0)
    v_mfma_f32_32x32x16_bf16 v[64:79], v[20:23], v[88:91], 0
    v_exp_f32 v48, v48
    v_exp_f32 v49, v49
    v_exp_f32 v50, v50
    v_exp_f32 v51, v51
    v_cvt_pk_bf16_f32 v96, v48, v49
    v_cvt_pk_bf16_f32 v97, v50, v51
    v_mfma_f32_32x32x16_bf16 v[104:119], v[44:47], v[100:103], v[104:119]
    ds_read_b128 v[16:19], v2 offset:33152
    ds_read_b32 v24, v3 offset:34176
    v_exp_f32 v52, v52
    v_exp_f32 v53, v53
    v_exp_f32 v54, v54
    v_exp_f32 v55, v55
    v_cvt_pk_bf16_f32 v98, v52, v53
    v_cvt_pk_bf16_f32 v99, v54, v55
    v_mfma_f32_32x32x16_bf16 v[64:79], v[28:31], v[92:95], v[64:79]
    s_mov_b64 exec, s[10:11]
    ds_read_b128 v[40:43], v4 offset:31936
    ds_read_b128 v[44:47], v4 offset:32544
    s_mov_b64 exec, -1
    v_exp_f32 v56, v56
    v_exp_f32 v57, v57
    v_exp_f32 v58, v58
    v_exp_f32 v59, v59
    v_cvt_pk_bf16_f32 v100, v56, v57
    v_cvt_pk_bf16_f32 v101, v58, v59
    v_mfma_f32_32x32x16_bf16 v[104:119], v[32:35], v[96:99], v[104:119]
    v_exp_f32 v60, v60
    v_exp_f32 v61, v61
    v_exp_f32 v62, v62
    v_exp_f32 v63, v63
    v_cvt_pk_bf16_f32 v102, v60, v61
    v_cvt_pk_bf16_f32 v103, v62, v63
    buffer_load_dwordx4 v[156:159], v1, s[44:47], s60 offen offset:0 sc1
    v_bfe_u32 v254, v0, 4, 1
    v_mul_u32_u24 v254, 18432, v254
    v_lshrrev_b32 v255, 5, v0
    v_lshlrev_b32 v255, 8, v255
    v_and_b32 v10, 15, v0
    v_lshl_add_u32 v255, v10, 4, v255
    v_add_u32 v254, v254, v255
    s_and_b32 s6, s3, 6
    s_add_u32 s6, s6, s64
    s_mul_i32 s6, s6, 36
    s_and_b32 s7, s3, 1
    s_mul_i32 s7, s7, 18
    s_add_u32 s6, s6, s7
    s_lshl_b32 s6, s6, 9
    s_add_u32 s6, s6, 4882432
    s_add_u32 s8, s64, 8
    s_mul_i32 s8, s8, 36
    s_add_u32 s8, s8, s7
    s_lshr_b32 s67, s3, 1
    s_mul_i32 s67, s67, 5
    s_add_u32 s8, s8, s67
    s_lshl_b32 s8, s8, 9
    s_add_u32 s8, s8, 4882432
    s_cmp_ge_u32 s3, 6
    s_cselect_b32 s9, 0x7f000000, s8
    s_waitcnt lgkmcnt(0)
    v_mfma_f32_32x32x16_bf16 v[48:63], v[16:19], v[88:91], 0
    v_exp_f32 v64, v64
    v_exp_f32 v65, v65
    v_exp_f32 v66, v66
    v_exp_f32 v67, v67
    v_cvt_pk_bf16_f32 v96, v64, v65
    v_cvt_pk_bf16_f32 v97, v66, v67
    v_mfma_f32_32x32x16_bf16 v[104:119], v[36:39], v[100:103], v[104:119]
    ds_read_b128 v[20:23], v2 offset:35520
    ds_read_b32 v28, v3 offset:36544
    v_exp_f32 v68, v68
    v_exp_f32 v69, v69
    v_exp_f32 v70, v70
    v_exp_f32 v71, v71
    v_cvt_pk_bf16_f32 v98, v68, v69
    v_cvt_pk_bf16_f32 v99, v70, v71
    v_mfma_f32_32x32x16_bf16 v[48:63], v[24:27], v[92:95], v[48:63]
    s_mov_b64 exec, s[10:11]
    ds_read_b128 v[32:35], v4 offset:34304
    ds_read_b128 v[36:39], v4 offset:34912
    s_mov_b64 exec, -1
    v_exp_f32 v72, v72
    v_exp_f32 v73, v73
    v_exp_f32 v74, v74
    v_exp_f32 v75, v75
    v_cvt_pk_bf16_f32 v100, v72, v73
    v_cvt_pk_bf16_f32 v101, v74, v75
    v_mfma_f32_32x32x16_bf16 v[104:119], v[40:43], v[96:99], v[104:119]
    v_exp_f32 v76, v76
    v_exp_f32 v77, v77
    v_exp_f32 v78, v78
    v_exp_f32 v79, v79
    v_cvt_pk_bf16_f32 v102, v76, v77
    v_cvt_pk_bf16_f32 v103, v78, v79
    buffer_load_dwordx4 v[160:163], v1, s[44:47], s60 offen offset:1024 sc1
    s_add_u32 s60, s60, 2359296
    buffer_load_dwordx4 v[128:131], v254, s[44:47], s6 offen offset:0 sc1
    s_waitcnt lgkmcnt(0)
    v_mfma_f32_32x32x16_bf16 v[64:79], v[20:23], v[88:91], 0
    v_exp_f32 v48, v48
    v_exp_f32 v49, v49
    v_exp_f32 v50, v50
    v_exp_f32 v51, v51
    v_cvt_pk_bf16_f32 v96, v48, v49
    v_cvt_pk_bf16_f32 v97, v50, v51
    v_mfma_f32_32x32x16_bf16 v[104:119], v[44:47], v[100:103], v[104:119]
    ds_read_b128 v[16:19], v2 offset:37888
    ds_read_b32 v24, v3 offset:38912
    v_exp_f32 v52, v52
    v_exp_f32 v53, v53
    v_exp_f32 v54, v54
    v_exp_f32 v55, v55
    v_cvt_pk_bf16_f32 v98, v52, v53
    v_cvt_pk_bf16_f32 v99, v54, v55
    v_mfma_f32_32x32x16_bf16 v[64:79], v[28:31], v[92:95], v[64:79]
    s_mov_b64 exec, s[10:11]
    ds_read_b128 v[40:43], v4 offset:36672
    ds_read_b128 v[44:47], v4 offset:37280
    s_mov_b64 exec, -1
    v_exp_f32 v56, v56
    v_exp_f32 v57, v57
    v_exp_f32 v58, v58
    v_exp_f32 v59, v59
    v_cvt_pk_bf16_f32 v100, v56, v57
    v_cvt_pk_bf16_f32 v101, v58, v59
    v_mfma_f32_32x32x16_bf16 v[104:119], v[32:35], v[96:99], v[104:119]
    v_exp_f32 v60, v60
    v_exp_f32 v61, v61
    v_exp_f32 v62, v62
    v_exp_f32 v63, v63
    v_cvt_pk_bf16_f32 v102, v60, v61
    v_cvt_pk_bf16_f32 v103, v62, v63
    buffer_load_dwordx4 v[164:167], v1, s[44:47], s60 offen offset:0 sc1
    buffer_load_dwordx4 v[132:135], v254, s[44:47], s6 offen offset:512 sc1
    s_waitcnt lgkmcnt(0)
    v_mfma_f32_32x32x16_bf16 v[48:63], v[16:19], v[88:91], 0
    v_exp_f32 v64, v64
    v_exp_f32 v65, v65
    v_exp_f32 v66, v66
    v_exp_f32 v67, v67
    v_cvt_pk_bf16_f32 v96, v64, v65
    v_cvt_pk_bf16_f32 v97, v66, v67
    v_mfma_f32_32x32x16_bf16 v[104:119], v[36:39], v[100:103], v[104:119]
    ds_read_b128 v[20:23], v2 offset:40256
    ds_read_b32 v28, v3 offset:41280
    v_exp_f32 v68, v68
    v_exp_f32 v69, v69
    v_exp_f32 v70, v70
    v_exp_f32 v71, v71
    v_cvt_pk_bf16_f32 v98, v68, v69
    v_cvt_pk_bf16_f32 v99, v70, v71
    v_mfma_f32_32x32x16_bf16 v[48:63], v[24:27], v[92:95], v[48:63]
    s_mov_b64 exec, s[10:11]
    ds_read_b128 v[32:35], v4 offset:39040
    ds_read_b128 v[36:39], v4 offset:39648
    s_mov_b64 exec, -1
    v_exp_f32 v72, v72
    v_exp_f32 v73, v73
    v_exp_f32 v74, v74
    v_exp_f32 v75, v75
    v_cvt_pk_bf16_f32 v100, v72, v73
    v_cvt_pk_bf16_f32 v101, v74, v75
    v_mfma_f32_32x32x16_bf16 v[104:119], v[40:43], v[96:99], v[104:119]
    v_exp_f32 v76, v76
    v_exp_f32 v77, v77
    v_exp_f32 v78, v78
    v_exp_f32 v79, v79
    v_cvt_pk_bf16_f32 v102, v76, v77
    v_cvt_pk_bf16_f32 v103, v78, v79
    v_add_u32 v2, 37888, v2
    v_add_u32 v3, 37888, v3
    v_add_u32 v4, 37888, v4
    buffer_load_dwordx4 v[136:139], v254, s[44:47], s6 offen offset:1024 sc1
    s_waitcnt vmcnt(7)
    v_mfma_f32_32x32x16_bf16 v[236:251], v[12:15], v[148:151], 0
    buffer_load_dwordx4 v[148:151], v254, s[44:47], s6 offen offset:2560 sc1
    s_waitcnt lgkmcnt(0)
    v_mfma_f32_32x32x16_bf16 v[64:79], v[20:23], v[88:91], 0
    v_exp_f32 v48, v48
    v_exp_f32 v49, v49
    v_exp_f32 v50, v50
    v_exp_f32 v51, v51
    v_cvt_pk_bf16_f32 v96, v48, v49
    v_cvt_pk_bf16_f32 v97, v50, v51
    v_mfma_f32_32x32x16_bf16 v[104:119], v[44:47], v[100:103], v[104:119]
    ds_read_b128 v[16:19], v2 offset:4736
    ds_read_b32 v24, v3 offset:5760
    v_exp_f32 v52, v52
    v_exp_f32 v53, v53
    v_exp_f32 v54, v54
    v_exp_f32 v55, v55
    v_cvt_pk_bf16_f32 v98, v52, v53
    v_cvt_pk_bf16_f32 v99, v54, v55
    v_mfma_f32_32x32x16_bf16 v[64:79], v[28:31], v[92:95], v[64:79]
    s_mov_b64 exec, s[10:11]
    ds_read_b128 v[40:43], v4 offset:3520
    ds_read_b128 v[44:47], v4 offset:4128
    s_mov_b64 exec, -1
    v_exp_f32 v56, v56
    v_exp_f32 v57, v57
    v_exp_f32 v58, v58
    v_exp_f32 v59, v59
    v_cvt_pk_bf16_f32 v100, v56, v57
    v_cvt_pk_bf16_f32 v101, v58, v59
    v_mfma_f32_32x32x16_bf16 v[104:119], v[32:35], v[96:99], v[104:119]
    v_exp_f32 v60, v60
    v_exp_f32 v61, v61
    v_exp_f32 v62, v62
    v_exp_f32 v63, v63
    v_cvt_pk_bf16_f32 v102, v60, v61
    v_cvt_pk_bf16_f32 v103, v62, v63
    buffer_load_dwordx4 v[168:171], v1, s[44:47], s60 offen offset:1024 sc1
    s_add_u32 s60, s60, 2359296
    buffer_load_dwordx4 v[140:143], v254, s[44:47], s6 offen offset:1536 sc1
    s_waitcnt vmcnt(9)
    v_mfma_f32_32x32x16_bf16 v[236:251], v[12:15], v[152:155], v[236:251]
    buffer_load_dwordx4 v[152:155], v254, s[44:47], s6 offen offset:3072 sc1
    s_waitcnt lgkmcnt(0)
    v_mfma_f32_32x32x16_bf16 v[48:63], v[16:19], v[88:91], 0
    v_exp_f32 v64, v64
    v_exp_f32 v65, v65
    v_exp_f32 v66, v66
    v_exp_f32 v67, v67
    v_cvt_pk_bf16_f32 v96, v64, v65
    v_cvt_pk_bf16_f32 v97, v66, v67
    v_mfma_f32_32x32x16_bf16 v[104:119], v[36:39], v[100:103], v[104:119]
    ds_read_b128 v[20:23], v2 offset:7104
    ds_read_b32 v28, v3 offset:8128
    v_exp_f32 v68, v68
    v_exp_f32 v69, v69
    v_exp_f32 v70, v70
    v_exp_f32 v71, v71
    v_cvt_pk_bf16_f32 v98, v68, v69
    v_cvt_pk_bf16_f32 v99, v70, v71
    v_mfma_f32_32x32x16_bf16 v[48:63], v[24:27], v[92:95], v[48:63]
    s_mov_b64 exec, s[10:11]
    ds_read_b128 v[32:35], v4 offset:5888
    ds_read_b128 v[36:39], v4 offset:6496
    s_mov_b64 exec, -1
    v_exp_f32 v72, v72
    v_exp_f32 v73, v73
    v_exp_f32 v74, v74
    v_exp_f32 v75, v75
    v_cvt_pk_bf16_f32 v100, v72, v73
    v_cvt_pk_bf16_f32 v101, v74, v75
    v_mfma_f32_32x32x16_bf16 v[104:119], v[40:43], v[96:99], v[104:119]
    v_exp_f32 v76, v76
    v_exp_f32 v77, v77
    v_exp_f32 v78, v78
    v_exp_f32 v79, v79
    v_cvt_pk_bf16_f32 v102, v76, v77
    v_cvt_pk_bf16_f32 v103, v78, v79
    buffer_load_dwordx4 v[172:175], v1, s[44:47], s60 offen offset:0 sc1
    buffer_load_dwordx4 v[144:147], v254, s[44:47], s6 offen offset:2048 sc1
    s_waitcnt vmcnt(11)
    v_mfma_f32_32x32x16_bf16 v[220:235], v[12:15], v[156:159], 0
    buffer_load_dwordx4 v[156:159], v254, s[44:47], s6 offen offset:3584 sc1
    s_waitcnt lgkmcnt(0)
    v_mfma_f32_32x32x16_bf16 v[64:79], v[20:23], v[88:91], 0
    v_exp_f32 v48, v48
    v_exp_f32 v49, v49
    v_exp_f32 v50, v50
    v_exp_f32 v51, v51
    v_cvt_pk_bf16_f32 v96, v48, v49
    v_cvt_pk_bf16_f32 v97, v50, v51
    v_mfma_f32_32x32x16_bf16 v[104:119], v[44:47], v[100:103], v[104:119]
    ds_read_b128 v[16:19], v2 offset:9472
    ds_read_b32 v24, v3 offset:10496
    v_exp_f32 v52, v52
    v_exp_f32 v53, v53
    v_exp_f32 v54, v54
    v_exp_f32 v55, v55
    v_cvt_pk_bf16_f32 v98, v52, v53
    v_cvt_pk_bf16_f32 v99, v54, v55
    v_mfma_f32_32x32x16_bf16 v[64:79], v[28:31], v[92:95], v[64:79]
    s_mov_b64 exec, s[10:11]
    ds_read_b128 v[40:43], v4 offset:8256
    ds_read_b128 v[44:47], v4 offset:8864
    s_mov_b64 exec, -1
    v_exp_f32 v56, v56
    v_exp_f32 v57, v57
    v_exp_f32 v58, v58
    v_exp_f32 v59, v59
    v_cvt_pk_bf16_f32 v100, v56, v57
    v_cvt_pk_bf16_f32 v101, v58, v59
    v_mfma_f32_32x32x16_bf16 v[104:119], v[32:35], v[96:99], v[104:119]
    v_exp_f32 v60, v60
    v_exp_f32 v61, v61
    v_exp_f32 v62, v62
    v_exp_f32 v63, v63
    v_cvt_pk_bf16_f32 v102, v60, v61
    v_cvt_pk_bf16_f32 v103, v62, v63
    buffer_load_dwordx4 v[176:179], v1, s[44:47], s60 offen offset:1024 sc1
    s_add_u32 s60, s60, 2359296
    s_waitcnt vmcnt(12)
    v_mfma_f32_32x32x16_bf16 v[220:235], v[84:87], v[160:163], v[220:235]
    s_add_u32 s6, s6, 4096
    buffer_load_dwordx4 v[160:163], v254, s[44:47], s6 offen offset:0 sc1
    s_waitcnt lgkmcnt(0)
    v_mfma_f32_32x32x16_bf16 v[48:63], v[16:19], v[88:91], 0
    v_exp_f32 v64, v64
    v_exp_f32 v65, v65
    v_exp_f32 v66, v66
    v_exp_f32 v67, v67
    v_cvt_pk_bf16_f32 v96, v64, v65
    v_cvt_pk_bf16_f32 v97, v66, v67
    v_mfma_f32_32x32x16_bf16 v[104:119], v[36:39], v[100:103], v[104:119]
    ds_read_b128 v[20:23], v2 offset:11840
    ds_read_b32 v28, v3 offset:12864
    v_exp_f32 v68, v68
    v_exp_f32 v69, v69
    v_exp_f32 v70, v70
    v_exp_f32 v71, v71
    v_cvt_pk_bf16_f32 v98, v68, v69
    v_cvt_pk_bf16_f32 v99, v70, v71
    v_mfma_f32_32x32x16_bf16 v[48:63], v[24:27], v[92:95], v[48:63]
    s_mov_b64 exec, s[10:11]
    ds_read_b128 v[32:35], v4 offset:10624
    ds_read_b128 v[36:39], v4 offset:11232
    s_mov_b64 exec, -1
    v_exp_f32 v72, v72
    v_exp_f32 v73, v73
    v_exp_f32 v74, v74
    v_exp_f32 v75, v75
    v_cvt_pk_bf16_f32 v100, v72, v73
    v_cvt_pk_bf16_f32 v101, v74, v75
    v_mfma_f32_32x32x16_bf16 v[104:119], v[40:43], v[96:99], v[104:119]
    v_exp_f32 v76, v76
    v_exp_f32 v77, v77
    v_exp_f32 v78, v78
    v_exp_f32 v79, v79
    v_cvt_pk_bf16_f32 v102, v76, v77
    v_cvt_pk_bf16_f32 v103, v78, v79
    buffer_load_dwordx4 v[180:183], v1, s[44:47], s60 offen offset:0 sc1
    s_waitcnt vmcnt(12)
    v_mfma_f32_32x32x16_bf16 v[220:235], v[12:15], v[164:167], v[220:235]
    buffer_load_dwordx4 v[164:167], v254, s[44:47], s6 offen offset:512 sc1
    s_waitcnt lgkmcnt(0)
    v_mfma_f32_32x32x16_bf16 v[64:79], v[20:23], v[88:91], 0
    v_exp_f32 v48, v48
    v_exp_f32 v49, v49
    v_exp_f32 v50, v50
    v_exp_f32 v51, v51
    v_cvt_pk_bf16_f32 v96, v48, v49
    v_cvt_pk_bf16_f32 v97, v50, v51
    v_mfma_f32_32x32x16_bf16 v[104:119], v[44:47], v[100:103], v[104:119]
    ds_read_b128 v[16:19], v2 offset:14208
    ds_read_b32 v24, v3 offset:15232
    v_exp_f32 v52, v52
    v_exp_f32 v53, v53
    v_exp_f32 v54, v54
    v_exp_f32 v55, v55
    v_cvt_pk_bf16_f32 v98, v52, v53
    v_cvt_pk_bf16_f32 v99, v54, v55
    v_mfma_f32_32x32x16_bf16 v[64:79], v[28:31], v[92:95], v[64:79]
    s_mov_b64 exec, s[10:11]
    ds_read_b128 v[40:43], v4 offset:12992
    ds_read_b128 v[44:47], v4 offset:13600
    s_mov_b64 exec, -1
    v_exp_f32 v56, v56
    v_exp_f32 v57, v57
    v_exp_f32 v58, v58
    v_exp_f32 v59, v59
    v_cvt_pk_bf16_f32 v100, v56, v57
    v_cvt_pk_bf16_f32 v101, v58, v59
    v_mfma_f32_32x32x16_bf16 v[104:119], v[32:35], v[96:99], v[104:119]
    v_exp_f32 v60, v60
    v_exp_f32 v61, v61
    v_exp_f32 v62, v62
    v_exp_f32 v63, v63
    v_cvt_pk_bf16_f32 v102, v60, v61
    v_cvt_pk_bf16_f32 v103, v62, v63
    buffer_load_dwordx4 v[184:187], v1, s[44:47], s60 offen offset:1024 sc1
    s_add_u32 s60, s60, 2359296
    s_waitcnt lgkmcnt(0)
    v_mfma_f32_32x32x16_bf16 v[48:63], v[16:19], v[88:91], 0
    v_exp_f32 v64, v64
    v_exp_f32 v65, v65
    v_exp_f32 v66, v66
    v_exp_f32 v67, v67
    v_cvt_pk_bf16_f32 v96, v64, v65
    v_cvt_pk_bf16_f32 v97, v66, v67
    v_mfma_f32_32x32x16_bf16 v[104:119], v[36:39], v[100:103], v[104:119]
    ds_read_b128 v[20:23], v2 offset:16576
    ds_read_b32 v28, v3 offset:17600
    v_exp_f32 v68, v68
    v_exp_f32 v69, v69
    v_exp_f32 v70, v70
    v_exp_f32 v71, v71
    v_cvt_pk_bf16_f32 v98, v68, v69
    v_cvt_pk_bf16_f32 v99, v70, v71
    v_mfma_f32_32x32x16_bf16 v[48:63], v[24:27], v[92:95], v[48:63]
    s_mov_b64 exec, s[10:11]
    ds_read_b128 v[32:35], v4 offset:15360
    ds_read_b128 v[36:39], v4 offset:15968
    s_mov_b64 exec, -1
    v_exp_f32 v72, v72
    v_exp_f32 v73, v73
    v_exp_f32 v74, v74
    v_exp_f32 v75, v75
    v_cvt_pk_bf16_f32 v100, v72, v73
    v_cvt_pk_bf16_f32 v101, v74, v75
    v_mfma_f32_32x32x16_bf16 v[104:119], v[40:43], v[96:99], v[104:119]
    v_exp_f32 v76, v76
    v_exp_f32 v77, v77
    v_exp_f32 v78, v78
    v_exp_f32 v79, v79
    v_cvt_pk_bf16_f32 v102, v76, v77
    v_cvt_pk_bf16_f32 v103, v78, v79
    s_waitcnt vmcnt(10)
    v_mfma_f32_32x32x16_bf16 v[220:235], v[84:87], v[168:171], v[220:235]
    buffer_load_dwordx4 v[168:171], v254, s[44:47], s6 offen offset:1024 sc1
    s_waitcnt lgkmcnt(0)
    v_mfma_f32_32x32x16_bf16 v[64:79], v[20:23], v[88:91], 0
    v_exp_f32 v48, v48
    v_exp_f32 v49, v49
    v_exp_f32 v50, v50
    v_exp_f32 v51, v51
    v_cvt_pk_bf16_f32 v96, v48, v49
    v_cvt_pk_bf16_f32 v97, v50, v51
    v_mfma_f32_32x32x16_bf16 v[104:119], v[44:47], v[100:103], v[104:119]
    ds_read_b128 v[16:19], v2 offset:18944
    ds_read_b32 v24, v3 offset:19968
    v_exp_f32 v52, v52
    v_exp_f32 v53, v53
    v_exp_f32 v54, v54
    v_exp_f32 v55, v55
    v_cvt_pk_bf16_f32 v98, v52, v53
    v_cvt_pk_bf16_f32 v99, v54, v55
    v_mfma_f32_32x32x16_bf16 v[64:79], v[28:31], v[92:95], v[64:79]
    s_mov_b64 exec, s[10:11]
    ds_read_b128 v[40:43], v4 offset:17728
    ds_read_b128 v[44:47], v4 offset:18336
    s_mov_b64 exec, -1
    v_exp_f32 v56, v56
    v_exp_f32 v57, v57
    v_exp_f32 v58, v58
    v_exp_f32 v59, v59
    v_cvt_pk_bf16_f32 v100, v56, v57
    v_cvt_pk_bf16_f32 v101, v58, v59
    v_mfma_f32_32x32x16_bf16 v[104:119], v[32:35], v[96:99], v[104:119]
    v_exp_f32 v60, v60
    v_exp_f32 v61, v61
    v_exp_f32 v62, v62
    v_exp_f32 v63, v63
    v_cvt_pk_bf16_f32 v102, v60, v61
    v_cvt_pk_bf16_f32 v103, v62, v63
    buffer_load_dwordx4 v[188:191], v1, s[44:47], s60 offen offset:0 sc1
    s_waitcnt vmcnt(9)
    v_mfma_f32_32x32x16_bf16 v[220:235], v[12:15], v[172:175], v[220:235]
    buffer_load_dwordx4 v[172:175], v254, s[44:47], s6 offen offset:1536 sc1
    s_waitcnt lgkmcnt(0)
    v_mfma_f32_32x32x16_bf16 v[48:63], v[16:19], v[88:91], 0
    v_exp_f32 v64, v64
    v_exp_f32 v65, v65
    v_exp_f32 v66, v66
    v_exp_f32 v67, v67
    v_cvt_pk_bf16_f32 v96, v64, v65
    v_cvt_pk_bf16_f32 v97, v66, v67
    v_mfma_f32_32x32x16_bf16 v[104:119], v[36:39], v[100:103], v[104:119]
    ds_read_b128 v[20:23], v2 offset:21312
    ds_read_b32 v28, v3 offset:22336
    v_exp_f32 v68, v68
    v_exp_f32 v69, v69
    v_exp_f32 v70, v70
    v_exp_f32 v71, v71
    v_cvt_pk_bf16_f32 v98, v68, v69
    v_cvt_pk_bf16_f32 v99, v70, v71
    v_mfma_f32_32x32x16_bf16 v[48:63], v[24:27], v[92:95], v[48:63]
    s_mov_b64 exec, s[10:11]
    ds_read_b128 v[32:35], v4 offset:20096
    ds_read_b128 v[36:39], v4 offset:20704
    s_mov_b64 exec, -1
    v_exp_f32 v72, v72
    v_exp_f32 v73, v73
    v_exp_f32 v74, v74
    v_exp_f32 v75, v75
    v_cvt_pk_bf16_f32 v100, v72, v73
    v_cvt_pk_bf16_f32 v101, v74, v75
    v_mfma_f32_32x32x16_bf16 v[104:119], v[40:43], v[96:99], v[104:119]
    v_exp_f32 v76, v76
    v_exp_f32 v77, v77
    v_exp_f32 v78, v78
    v_exp_f32 v79, v79
    v_cvt_pk_bf16_f32 v102, v76, v77
    v_cvt_pk_bf16_f32 v103, v78, v79
    buffer_load_dwordx4 v[192:195], v1, s[44:47], s60 offen offset:1024 sc1
    s_add_u32 s60, s60, 2359296
    s_waitcnt vmcnt(8)
    v_mfma_f32_32x32x16_bf16 v[220:235], v[84:87], v[176:179], v[220:235]
    buffer_load_dwordx4 v[176:179], v254, s[44:47], s6 offen offset:2048 sc1
    s_waitcnt lgkmcnt(0)
    v_mfma_f32_32x32x16_bf16 v[64:79], v[20:23], v[88:91], 0
    v_exp_f32 v48, v48
    v_exp_f32 v49, v49
    v_exp_f32 v50, v50
    v_exp_f32 v51, v51
    v_cvt_pk_bf16_f32 v96, v48, v49
    v_cvt_pk_bf16_f32 v97, v50, v51
    v_mfma_f32_32x32x16_bf16 v[104:119], v[44:47], v[100:103], v[104:119]
    ds_read_b128 v[16:19], v2 offset:23680
    ds_read_b32 v24, v3 offset:24704
    v_exp_f32 v52, v52
    v_exp_f32 v53, v53
    v_exp_f32 v54, v54
    v_exp_f32 v55, v55
    v_cvt_pk_bf16_f32 v98, v52, v53
    v_cvt_pk_bf16_f32 v99, v54, v55
    v_mfma_f32_32x32x16_bf16 v[64:79], v[28:31], v[92:95], v[64:79]
    s_mov_b64 exec, s[10:11]
    ds_read_b128 v[40:43], v4 offset:22464
    ds_read_b128 v[44:47], v4 offset:23072
    s_mov_b64 exec, -1
    v_exp_f32 v56, v56
    v_exp_f32 v57, v57
    v_exp_f32 v58, v58
    v_exp_f32 v59, v59
    v_cvt_pk_bf16_f32 v100, v56, v57
    v_cvt_pk_bf16_f32 v101, v58, v59
    v_mfma_f32_32x32x16_bf16 v[104:119], v[32:35], v[96:99], v[104:119]
    v_exp_f32 v60, v60
    v_exp_f32 v61, v61
    v_exp_f32 v62, v62
    v_exp_f32 v63, v63
    v_cvt_pk_bf16_f32 v102, v60, v61
    v_cvt_pk_bf16_f32 v103, v62, v63
    buffer_load_dwordx4 v[196:199], v1, s[44:47], s60 offen offset:0 sc1
    s_waitcnt vmcnt(8)
    v_mfma_f32_32x32x16_bf16 v[220:235], v[12:15], v[180:183], v[220:235]
    buffer_load_dwordx4 v[180:183], v254, s[44:47], s6 offen offset:2560 sc1
    s_waitcnt lgkmcnt(0)
    v_mfma_f32_32x32x16_bf16 v[48:63], v[16:19], v[88:91], 0
    v_exp_f32 v64, v64
    v_exp_f32 v65, v65
    v_exp_f32 v66, v66
    v_exp_f32 v67, v67
    v_cvt_pk_bf16_f32 v96, v64, v65
    v_cvt_pk_bf16_f32 v97, v66, v67
    v_mfma_f32_32x32x16_bf16 v[104:119], v[36:39], v[100:103], v[104:119]
    ds_read_b128 v[20:23], v2 offset:26048
    ds_read_b32 v28, v3 offset:27072
    v_exp_f32 v68, v68
    v_exp_f32 v69, v69
    v_exp_f32 v70, v70
    v_exp_f32 v71, v71
    v_cvt_pk_bf16_f32 v98, v68, v69
    v_cvt_pk_bf16_f32 v99, v70, v71
    v_mfma_f32_32x32x16_bf16 v[48:63], v[24:27], v[92:95], v[48:63]
    s_mov_b64 exec, s[10:11]
    ds_read_b128 v[32:35], v4 offset:24832
    ds_read_b128 v[36:39], v4 offset:25440
    s_mov_b64 exec, -1
    v_exp_f32 v72, v72
    v_exp_f32 v73, v73
    v_exp_f32 v74, v74
    v_exp_f32 v75, v75
    v_cvt_pk_bf16_f32 v100, v72, v73
    v_cvt_pk_bf16_f32 v101, v74, v75
    v_mfma_f32_32x32x16_bf16 v[104:119], v[40:43], v[96:99], v[104:119]
    v_exp_f32 v76, v76
    v_exp_f32 v77, v77
    v_exp_f32 v78, v78
    v_exp_f32 v79, v79
    v_cvt_pk_bf16_f32 v102, v76, v77
    v_cvt_pk_bf16_f32 v103, v78, v79
    buffer_load_dwordx4 v[200:203], v1, s[44:47], s60 offen offset:1024 sc1
    s_add_u32 s60, s60, 2359296
    s_waitcnt vmcnt(8)
    v_mfma_f32_32x32x16_bf16 v[220:235], v[84:87], v[184:187], v[220:235]
    buffer_load_dwordx4 v[184:187], v254, s[44:47], s6 offen offset:3072 sc1
    s_waitcnt lgkmcnt(0)
    v_mfma_f32_32x32x16_bf16 v[64:79], v[20:23], v[88:91], 0
    v_exp_f32 v48, v48
    v_exp_f32 v49, v49
    v_exp_f32 v50, v50
    v_exp_f32 v51, v51
    v_cvt_pk_bf16_f32 v96, v48, v49
    v_cvt_pk_bf16_f32 v97, v50, v51
    v_mfma_f32_32x32x16_bf16 v[104:119], v[44:47], v[100:103], v[104:119]
    ds_read_b128 v[16:19], v2 offset:28416
    ds_read_b32 v24, v3 offset:29440
    v_exp_f32 v52, v52
    v_exp_f32 v53, v53
    v_exp_f32 v54, v54
    v_exp_f32 v55, v55
    v_cvt_pk_bf16_f32 v98, v52, v53
    v_cvt_pk_bf16_f32 v99, v54, v55
    v_mfma_f32_32x32x16_bf16 v[64:79], v[28:31], v[92:95], v[64:79]
    s_mov_b64 exec, s[10:11]
    ds_read_b128 v[40:43], v4 offset:27200
    ds_read_b128 v[44:47], v4 offset:27808
    s_mov_b64 exec, -1
    v_exp_f32 v56, v56
    v_exp_f32 v57, v57
    v_exp_f32 v58, v58
    v_exp_f32 v59, v59
    v_cvt_pk_bf16_f32 v100, v56, v57
    v_cvt_pk_bf16_f32 v101, v58, v59
    v_mfma_f32_32x32x16_bf16 v[104:119], v[32:35], v[96:99], v[104:119]
    v_exp_f32 v60, v60
    v_exp_f32 v61, v61
    v_exp_f32 v62, v62
    v_exp_f32 v63, v63
    v_cvt_pk_bf16_f32 v102, v60, v61
    v_cvt_pk_bf16_f32 v103, v62, v63
    buffer_load_dwordx4 v[204:207], v1, s[44:47], s60 offen offset:0 sc1
    s_waitcnt lgkmcnt(0)
    v_mfma_f32_32x32x16_bf16 v[48:63], v[16:19], v[88:91], 0
    v_exp_f32 v64, v64
    v_exp_f32 v65, v65
    v_exp_f32 v66, v66
    v_exp_f32 v67, v67
    v_cvt_pk_bf16_f32 v96, v64, v65
    v_cvt_pk_bf16_f32 v97, v66, v67
    v_mfma_f32_32x32x16_bf16 v[104:119], v[36:39], v[100:103], v[104:119]
    ds_read_b128 v[20:23], v2 offset:30784
    ds_read_b32 v28, v3 offset:31808
    v_exp_f32 v68, v68
    v_exp_f32 v69, v69
    v_exp_f32 v70, v70
    v_exp_f32 v71, v71
    v_cvt_pk_bf16_f32 v98, v68, v69
    v_cvt_pk_bf16_f32 v99, v70, v71
    v_mfma_f32_32x32x16_bf16 v[48:63], v[24:27], v[92:95], v[48:63]
    s_mov_b64 exec, s[10:11]
    ds_read_b128 v[32:35], v4 offset:29568
    ds_read_b128 v[36:39], v4 offset:30176
    s_mov_b64 exec, -1
    v_exp_f32 v72, v72
    v_exp_f32 v73, v73
    v_exp_f32 v74, v74
    v_exp_f32 v75, v75
    v_cvt_pk_bf16_f32 v100, v72, v73
    v_cvt_pk_bf16_f32 v101, v74, v75
    v_mfma_f32_32x32x16_bf16 v[104:119], v[40:43], v[96:99], v[104:119]
    v_exp_f32 v76, v76
    v_exp_f32 v77, v77
    v_exp_f32 v78, v78
    v_exp_f32 v79, v79
    v_cvt_pk_bf16_f32 v102, v76, v77
    v_cvt_pk_bf16_f32 v103, v78, v79
    s_waitcnt vmcnt(8)
    v_mfma_f32_32x32x16_bf16 v[220:235], v[12:15], v[188:191], v[220:235]
    buffer_load_dwordx4 v[188:191], v254, s[44:47], s6 offen offset:3584 sc1
    s_waitcnt lgkmcnt(0)
    v_mfma_f32_32x32x16_bf16 v[64:79], v[20:23], v[88:91], 0
    v_exp_f32 v48, v48
    v_exp_f32 v49, v49
    v_exp_f32 v50, v50
    v_exp_f32 v51, v51
    v_cvt_pk_bf16_f32 v96, v48, v49
    v_cvt_pk_bf16_f32 v97, v50, v51
    v_mfma_f32_32x32x16_bf16 v[104:119], v[44:47], v[100:103], v[104:119]
    ds_read_b128 v[16:19], v2 offset:33152
    ds_read_b32 v24, v3 offset:34176
    v_exp_f32 v52, v52
    v_exp_f32 v53, v53
    v_exp_f32 v54, v54
    v_exp_f32 v55, v55
    v_cvt_pk_bf16_f32 v98, v52, v53
    v_cvt_pk_bf16_f32 v99, v54, v55
    v_mfma_f32_32x32x16_bf16 v[64:79], v[28:31], v[92:95], v[64:79]
    s_mov_b64 exec, s[10:11]
    ds_read_b128 v[40:43], v4 offset:31936
    ds_read_b128 v[44:47], v4 offset:32544
    s_mov_b64 exec, -1
    v_exp_f32 v56, v56
    v_exp_f32 v57, v57
    v_exp_f32 v58, v58
    v_exp_f32 v59, v59
    v_cvt_pk_bf16_f32 v100, v56, v57
    v_cvt_pk_bf16_f32 v101, v58, v59
    v_mfma_f32_32x32x16_bf16 v[104:119], v[32:35], v[96:99], v[104:119]
    v_exp_f32 v60, v60
    v_exp_f32 v61, v61
    v_exp_f32 v62, v62
    v_exp_f32 v63, v63
    v_cvt_pk_bf16_f32 v102, v60, v61
    v_cvt_pk_bf16_f32 v103, v62, v63
    buffer_load_dwordx4 v[208:211], v1, s[44:47], s60 offen offset:1024 sc1
    s_add_u32 s60, s60, 2359296
    s_waitcnt vmcnt(8)
    v_mfma_f32_32x32x16_bf16 v[220:235], v[84:87], v[192:195], v[220:235]
    s_add_u32 s6, s6, 4096
    buffer_load_dwordx4 v[192:195], v254, s[44:47], s6 offen offset:0 sc1
    s_waitcnt lgkmcnt(0)
    v_mfma_f32_32x32x16_bf16 v[48:63], v[16:19], v[88:91], 0
    v_exp_f32 v64, v64
    v_exp_f32 v65, v65
    v_exp_f32 v66, v66
    v_exp_f32 v67, v67
    v_cvt_pk_bf16_f32 v96, v64, v65
    v_cvt_pk_bf16_f32 v97, v66, v67
    v_mfma_f32_32x32x16_bf16 v[104:119], v[36:39], v[100:103], v[104:119]
    ds_read_b128 v[20:23], v2 offset:35520
    ds_read_b32 v28, v3 offset:36544
    v_exp_f32 v68, v68
    v_exp_f32 v69, v69
    v_exp_f32 v70, v70
    v_exp_f32 v71, v71
    v_cvt_pk_bf16_f32 v98, v68, v69
    v_cvt_pk_bf16_f32 v99, v70, v71
    v_mfma_f32_32x32x16_bf16 v[48:63], v[24:27], v[92:95], v[48:63]
    s_mov_b64 exec, s[10:11]
    ds_read_b128 v[32:35], v4 offset:34304
    ds_read_b128 v[36:39], v4 offset:34912
    s_mov_b64 exec, -1
    v_exp_f32 v72, v72
    v_exp_f32 v73, v73
    v_exp_f32 v74, v74
    v_exp_f32 v75, v75
    v_cvt_pk_bf16_f32 v100, v72, v73
    v_cvt_pk_bf16_f32 v101, v74, v75
    v_mfma_f32_32x32x16_bf16 v[104:119], v[40:43], v[96:99], v[104:119]
    v_exp_f32 v76, v76
    v_exp_f32 v77, v77
    v_exp_f32 v78, v78
    v_exp_f32 v79, v79
    v_cvt_pk_bf16_f32 v102, v76, v77
    v_cvt_pk_bf16_f32 v103, v78, v79
    buffer_load_dwordx4 v[212:215], v1, s[44:47], s60 offen offset:0 sc1
    s_waitcnt vmcnt(8)
    v_mfma_f32_32x32x16_bf16 v[220:235], v[12:15], v[196:199], v[220:235]
    buffer_load_dwordx4 v[196:199], v254, s[44:47], s6 offen offset:512 sc1
    s_waitcnt lgkmcnt(0)
    v_mfma_f32_32x32x16_bf16 v[64:79], v[20:23], v[88:91], 0
    v_exp_f32 v48, v48
    v_exp_f32 v49, v49
    v_exp_f32 v50, v50
    v_exp_f32 v51, v51
    v_cvt_pk_bf16_f32 v96, v48, v49
    v_cvt_pk_bf16_f32 v97, v50, v51
    v_mfma_f32_32x32x16_bf16 v[104:119], v[44:47], v[100:103], v[104:119]
    ds_read_b128 v[16:19], v2 offset:37888
    ds_read_b32 v24, v3 offset:38912
    v_exp_f32 v52, v52
    v_exp_f32 v53, v53
    v_exp_f32 v54, v54
    v_exp_f32 v55, v55
    v_cvt_pk_bf16_f32 v98, v52, v53
    v_cvt_pk_bf16_f32 v99, v54, v55
    v_mfma_f32_32x32x16_bf16 v[64:79], v[28:31], v[92:95], v[64:79]
    s_mov_b64 exec, s[10:11]
    ds_read_b128 v[40:43], v4 offset:36672
    ds_read_b128 v[44:47], v4 offset:37280
    s_mov_b64 exec, -1
    v_exp_f32 v56, v56
    v_exp_f32 v57, v57
    v_exp_f32 v58, v58
    v_exp_f32 v59, v59
    v_cvt_pk_bf16_f32 v100, v56, v57
    v_cvt_pk_bf16_f32 v101, v58, v59
    v_mfma_f32_32x32x16_bf16 v[104:119], v[32:35], v[96:99], v[104:119]
    v_exp_f32 v60, v60
    v_exp_f32 v61, v61
    v_exp_f32 v62, v62
    v_exp_f32 v63, v63
    v_cvt_pk_bf16_f32 v102, v60, v61
    v_cvt_pk_bf16_f32 v103, v62, v63
    buffer_load_dwordx4 v[216:219], v1, s[44:47], s60 offen offset:1024 sc1
    s_add_u32 s60, s60, 2359296
    s_waitcnt vmcnt(8)
    v_mfma_f32_32x32x16_bf16 v[220:235], v[84:87], v[200:203], v[220:235]
    buffer_load_dwordx4 v[200:203], v255, s[44:47], s8 offen offset:0 sc1
    s_waitcnt lgkmcnt(0)
    v_mfma_f32_32x32x16_bf16 v[48:63], v[16:19], v[88:91], 0
    v_exp_f32 v64, v64
    v_exp_f32 v65, v65
    v_exp_f32 v66, v66
    v_exp_f32 v67, v67
    v_cvt_pk_bf16_f32 v96, v64, v65
    v_cvt_pk_bf16_f32 v97, v66, v67
    v_mfma_f32_32x32x16_bf16 v[104:119], v[36:39], v[100:103], v[104:119]
    ds_read_b128 v[20:23], v2 offset:40256
    ds_read_b32 v28, v3 offset:41280
    v_exp_f32 v68, v68
    v_exp_f32 v69, v69
    v_exp_f32 v70, v70
    v_exp_f32 v71, v71
    v_cvt_pk_bf16_f32 v98, v68, v69
    v_cvt_pk_bf16_f32 v99, v70, v71
    v_mfma_f32_32x32x16_bf16 v[48:63], v[24:27], v[92:95], v[48:63]
    s_mov_b64 exec, s[10:11]
    ds_read_b128 v[32:35], v4 offset:39040
    ds_read_b128 v[36:39], v4 offset:39648
    s_mov_b64 exec, -1
    v_exp_f32 v72, v72
    v_exp_f32 v73, v73
    v_exp_f32 v74, v74
    v_exp_f32 v75, v75
    v_cvt_pk_bf16_f32 v100, v72, v73
    v_cvt_pk_bf16_f32 v101, v74, v75
    v_mfma_f32_32x32x16_bf16 v[104:119], v[40:43], v[96:99], v[104:119]
    v_exp_f32 v76, v76
    v_exp_f32 v77, v77
    v_exp_f32 v78, v78
    v_exp_f32 v79, v79
    v_cvt_pk_bf16_f32 v102, v76, v77
    v_cvt_pk_bf16_f32 v103, v78, v79
    v_add_u32 v2, 37888, v2
    v_add_u32 v3, 37888, v3
    v_add_u32 v4, 37888, v4
    s_waitcnt vmcnt(7)
    v_mfma_f32_32x32x16_bf16 v[220:235], v[12:15], v[204:207], v[220:235]
    buffer_load_dwordx4 v[204:207], v255, s[44:47], s8 offen offset:512 sc1
    s_branch ATT_DONE
ATT_LOOP:
    s_waitcnt lgkmcnt(0)
    v_mfma_f32_32x32x16_bf16 v[64:79], v[20:23], v[88:91], 0
    v_exp_f32 v48, v48
    v_exp_f32 v49, v49
    v_exp_f32 v50, v50
    v_exp_f32 v51, v51
    v_cvt_pk_bf16_f32 v96, v48, v49
    v_cvt_pk_bf16_f32 v97, v50, v51
    v_mfma_f32_32x32x16_bf16 v[104:119], v[44:47], v[100:103], v[104:119]
    ds_read_b128 v[16:19], v2 offset:4736
    ds_read_b32 v24, v3 offset:5760
    v_exp_f32 v52, v52
    v_exp_f32 v53, v53
    v_exp_f32 v54, v54
    v_exp_f32 v55, v55
    v_cvt_pk_bf16_f32 v98, v52, v53
    v_cvt_pk_bf16_f32 v99, v54, v55
    v_mfma_f32_32x32x16_bf16 v[64:79], v[28:31], v[92:95], v[64:79]
    s_mov_b64 exec, s[10:11]
    ds_read_b128 v[40:43], v4 offset:3520
    ds_read_b128 v[44:47], v4 offset:4128
    s_mov_b64 exec, -1
    v_exp_f32 v56, v56
    v_exp_f32 v57, v57
    v_exp_f32 v58, v58
    v_exp_f32 v59, v59
    v_cvt_pk_bf16_f32 v100, v56, v57
    v_cvt_pk_bf16_f32 v101, v58, v59
    v_mfma_f32_32x32x16_bf16 v[104:119], v[32:35], v[96:99], v[104:119]
    v_exp_f32 v60, v60
    v_exp_f32 v61, v61
    v_exp_f32 v62, v62
    v_exp_f32 v63, v63
    v_cvt_pk_bf16_f32 v102, v60, v61
    v_cvt_pk_bf16_f32 v103, v62, v63
    s_waitcnt lgkmcnt(0)
    v_mfma_f32_32x32x16_bf16 v[48:63], v[16:19], v[88:91], 0
    v_exp_f32 v64, v64
    v_exp_f32 v65, v65
    v_exp_f32 v66, v66
    v_exp_f32 v67, v67
    v_cvt_pk_bf16_f32 v96, v64, v65
    v_cvt_pk_bf16_f32 v97, v66, v67
    v_mfma_f32_32x32x16_bf16 v[104:119], v[36:39], v[100:103], v[104:119]
    ds_read_b128 v[20:23], v2 offset:7104
    ds_read_b32 v28, v3 offset:8128
    v_exp_f32 v68, v68
    v_exp_f32 v69, v69
    v_exp_f32 v70, v70
    v_exp_f32 v71, v71
    v_cvt_pk_bf16_f32 v98, v68, v69
    v_cvt_pk_bf16_f32 v99, v70, v71
    v_mfma_f32_32x32x16_bf16 v[48:63], v[24:27], v[92:95], v[48:63]
    s_mov_b64 exec, s[10:11]
    ds_read_b128 v[32:35], v4 offset:5888
    ds_read_b128 v[36:39], v4 offset:6496
    s_mov_b64 exec, -1
    v_exp_f32 v72, v72
    v_exp_f32 v73, v73
    v_exp_f32 v74, v74
    v_exp_f32 v75, v75
    v_cvt_pk_bf16_f32 v100, v72, v73
    v_cvt_pk_bf16_f32 v101, v74, v75
    v_mfma_f32_32x32x16_bf16 v[104:119], v[40:43], v[96:99], v[104:119]
    v_exp_f32 v76, v76
    v_exp_f32 v77, v77
    v_exp_f32 v78, v78
    v_exp_f32 v79, v79
    v_cvt_pk_bf16_f32 v102, v76, v77
    v_cvt_pk_bf16_f32 v103, v78, v79
    s_waitcnt lgkmcnt(0)
    v_mfma_f32_32x32x16_bf16 v[64:79], v[20:23], v[88:91], 0
    v_exp_f32 v48, v48
    v_exp_f32 v49, v49
    v_exp_f32 v50, v50
    v_exp_f32 v51, v51
    v_cvt_pk_bf16_f32 v96, v48, v49
    v_cvt_pk_bf16_f32 v97, v50, v51
    v_mfma_f32_32x32x16_bf16 v[104:119], v[44:47], v[100:103], v[104:119]
    ds_read_b128 v[16:19], v2 offset:9472
    ds_read_b32 v24, v3 offset:10496
    v_exp_f32 v52, v52
    v_exp_f32 v53, v53
    v_exp_f32 v54, v54
    v_exp_f32 v55, v55
    v_cvt_pk_bf16_f32 v98, v52, v53
    v_cvt_pk_bf16_f32 v99, v54, v55
    v_mfma_f32_32x32x16_bf16 v[64:79], v[28:31], v[92:95], v[64:79]
    s_mov_b64 exec, s[10:11]
    ds_read_b128 v[40:43], v4 offset:8256
    ds_read_b128 v[44:47], v4 offset:8864
    s_mov_b64 exec, -1
    v_exp_f32 v56, v56
    v_exp_f32 v57, v57
    v_exp_f32 v58, v58
    v_exp_f32 v59, v59
    v_cvt_pk_bf16_f32 v100, v56, v57
    v_cvt_pk_bf16_f32 v101, v58, v59
    v_mfma_f32_32x32x16_bf16 v[104:119], v[32:35], v[96:99], v[104:119]
    v_exp_f32 v60, v60
    v_exp_f32 v61, v61
    v_exp_f32 v62, v62
    v_exp_f32 v63, v63
    v_cvt_pk_bf16_f32 v102, v60, v61
    v_cvt_pk_bf16_f32 v103, v62, v63
    s_waitcnt lgkmcnt(0)
    v_mfma_f32_32x32x16_bf16 v[48:63], v[16:19], v[88:91], 0
    v_exp_f32 v64, v64
    v_exp_f32 v65, v65
    v_exp_f32 v66, v66
    v_exp_f32 v67, v67
    v_cvt_pk_bf16_f32 v96, v64, v65
    v_cvt_pk_bf16_f32 v97, v66, v67
    v_mfma_f32_32x32x16_bf16 v[104:119], v[36:39], v[100:103], v[104:119]
    ds_read_b128 v[20:23], v2 offset:11840
    ds_read_b32 v28, v3 offset:12864
    v_exp_f32 v68, v68
    v_exp_f32 v69, v69
    v_exp_f32 v70, v70
    v_exp_f32 v71, v71
    v_cvt_pk_bf16_f32 v98, v68, v69
    v_cvt_pk_bf16_f32 v99, v70, v71
    v_mfma_f32_32x32x16_bf16 v[48:63], v[24:27], v[92:95], v[48:63]
    s_mov_b64 exec, s[10:11]
    ds_read_b128 v[32:35], v4 offset:10624
    ds_read_b128 v[36:39], v4 offset:11232
    s_mov_b64 exec, -1
    v_exp_f32 v72, v72
    v_exp_f32 v73, v73
    v_exp_f32 v74, v74
    v_exp_f32 v75, v75
    v_cvt_pk_bf16_f32 v100, v72, v73
    v_cvt_pk_bf16_f32 v101, v74, v75
    v_mfma_f32_32x32x16_bf16 v[104:119], v[40:43], v[96:99], v[104:119]
    v_exp_f32 v76, v76
    v_exp_f32 v77, v77
    v_exp_f32 v78, v78
    v_exp_f32 v79, v79
    v_cvt_pk_bf16_f32 v102, v76, v77
    v_cvt_pk_bf16_f32 v103, v78, v79
    s_waitcnt lgkmcnt(0)
    v_mfma_f32_32x32x16_bf16 v[64:79], v[20:23], v[88:91], 0
    v_exp_f32 v48, v48
    v_exp_f32 v49, v49
    v_exp_f32 v50, v50
    v_exp_f32 v51, v51
    v_cvt_pk_bf16_f32 v96, v48, v49
    v_cvt_pk_bf16_f32 v97, v50, v51
    v_mfma_f32_32x32x16_bf16 v[104:119], v[44:47], v[100:103], v[104:119]
    ds_read_b128 v[16:19], v2 offset:14208
    ds_read_b32 v24, v3 offset:15232
    v_exp_f32 v52, v52
    v_exp_f32 v53, v53
    v_exp_f32 v54, v54
    v_exp_f32 v55, v55
    v_cvt_pk_bf16_f32 v98, v52, v53
    v_cvt_pk_bf16_f32 v99, v54, v55
    v_mfma_f32_32x32x16_bf16 v[64:79], v[28:31], v[92:95], v[64:79]
    s_mov_b64 exec, s[10:11]
    ds_read_b128 v[40:43], v4 offset:12992
    ds_read_b128 v[44:47], v4 offset:13600
    s_mov_b64 exec, -1
    v_exp_f32 v56, v56
    v_exp_f32 v57, v57
    v_exp_f32 v58, v58
    v_exp_f32 v59, v59
    v_cvt_pk_bf16_f32 v100, v56, v57
    v_cvt_pk_bf16_f32 v101, v58, v59
    v_mfma_f32_32x32x16_bf16 v[104:119], v[32:35], v[96:99], v[104:119]
    v_exp_f32 v60, v60
    v_exp_f32 v61, v61
    v_exp_f32 v62, v62
    v_exp_f32 v63, v63
    v_cvt_pk_bf16_f32 v102, v60, v61
    v_cvt_pk_bf16_f32 v103, v62, v63
    s_waitcnt lgkmcnt(0)
    v_mfma_f32_32x32x16_bf16 v[48:63], v[16:19], v[88:91], 0
    v_exp_f32 v64, v64
    v_exp_f32 v65, v65
    v_exp_f32 v66, v66
    v_exp_f32 v67, v67
    v_cvt_pk_bf16_f32 v96, v64, v65
    v_cvt_pk_bf16_f32 v97, v66, v67
    v_mfma_f32_32x32x16_bf16 v[104:119], v[36:39], v[100:103], v[104:119]
    ds_read_b128 v[20:23], v2 offset:16576
    ds_read_b32 v28, v3 offset:17600
    v_exp_f32 v68, v68
    v_exp_f32 v69, v69
    v_exp_f32 v70, v70
    v_exp_f32 v71, v71
    v_cvt_pk_bf16_f32 v98, v68, v69
    v_cvt_pk_bf16_f32 v99, v70, v71
    v_mfma_f32_32x32x16_bf16 v[48:63], v[24:27], v[92:95], v[48:63]
    s_mov_b64 exec, s[10:11]
    ds_read_b128 v[32:35], v4 offset:15360
    ds_read_b128 v[36:39], v4 offset:15968
    s_mov_b64 exec, -1
    v_exp_f32 v72, v72
    v_exp_f32 v73, v73
    v_exp_f32 v74, v74
    v_exp_f32 v75, v75
    v_cvt_pk_bf16_f32 v100, v72, v73
    v_cvt_pk_bf16_f32 v101, v74, v75
    v_mfma_f32_32x32x16_bf16 v[104:119], v[40:43], v[96:99], v[104:119]
    v_exp_f32 v76, v76
    v_exp_f32 v77, v77
    v_exp_f32 v78, v78
    v_exp_f32 v79, v79
    v_cvt_pk_bf16_f32 v102, v76, v77
    v_cvt_pk_bf16_f32 v103, v78, v79
    s_waitcnt lgkmcnt(0)
    v_mfma_f32_32x32x16_bf16 v[64:79], v[20:23], v[88:91], 0
    v_exp_f32 v48, v48
    v_exp_f32 v49, v49
    v_exp_f32 v50, v50
    v_exp_f32 v51, v51
    v_cvt_pk_bf16_f32 v96, v48, v49
    v_cvt_pk_bf16_f32 v97, v50, v51
    v_mfma_f32_32x32x16_bf16 v[104:119], v[44:47], v[100:103], v[104:119]
    ds_read_b128 v[16:19], v2 offset:18944
    ds_read_b32 v24, v3 offset:19968
    v_exp_f32 v52, v52
    v_exp_f32 v53, v53
    v_exp_f32 v54, v54
    v_exp_f32 v55, v55
    v_cvt_pk_bf16_f32 v98, v52, v53
    v_cvt_pk_bf16_f32 v99, v54, v55
    v_mfma_f32_32x32x16_bf16 v[64:79], v[28:31], v[92:95], v[64:79]
    s_mov_b64 exec, s[10:11]
    ds_read_b128 v[40:43], v4 offset:17728
    ds_read_b128 v[44:47], v4 offset:18336
    s_mov_b64 exec, -1
    v_exp_f32 v56, v56
    v_exp_f32 v57, v57
    v_exp_f32 v58, v58
    v_exp_f32 v59, v59
    v_cvt_pk_bf16_f32 v100, v56, v57
    v_cvt_pk_bf16_f32 v101, v58, v59
    v_mfma_f32_32x32x16_bf16 v[104:119], v[32:35], v[96:99], v[104:119]
    v_exp_f32 v60, v60
    v_exp_f32 v61, v61
    v_exp_f32 v62, v62
    v_exp_f32 v63, v63
    v_cvt_pk_bf16_f32 v102, v60, v61
    v_cvt_pk_bf16_f32 v103, v62, v63
    s_waitcnt lgkmcnt(0)
    v_mfma_f32_32x32x16_bf16 v[48:63], v[16:19], v[88:91], 0
    v_exp_f32 v64, v64
    v_exp_f32 v65, v65
    v_exp_f32 v66, v66
    v_exp_f32 v67, v67
    v_cvt_pk_bf16_f32 v96, v64, v65
    v_cvt_pk_bf16_f32 v97, v66, v67
    v_mfma_f32_32x32x16_bf16 v[104:119], v[36:39], v[100:103], v[104:119]
    ds_read_b128 v[20:23], v2 offset:21312
    ds_read_b32 v28, v3 offset:22336
    v_exp_f32 v68, v68
    v_exp_f32 v69, v69
    v_exp_f32 v70, v70
    v_exp_f32 v71, v71
    v_cvt_pk_bf16_f32 v98, v68, v69
    v_cvt_pk_bf16_f32 v99, v70, v71
    v_mfma_f32_32x32x16_bf16 v[48:63], v[24:27], v[92:95], v[48:63]
    s_mov_b64 exec, s[10:11]
    ds_read_b128 v[32:35], v4 offset:20096
    ds_read_b128 v[36:39], v4 offset:20704
    s_mov_b64 exec, -1
    v_exp_f32 v72, v72
    v_exp_f32 v73, v73
    v_exp_f32 v74, v74
    v_exp_f32 v75, v75
    v_cvt_pk_bf16_f32 v100, v72, v73
    v_cvt_pk_bf16_f32 v101, v74, v75
    v_mfma_f32_32x32x16_bf16 v[104:119], v[40:43], v[96:99], v[104:119]
    v_exp_f32 v76, v76
    v_exp_f32 v77, v77
    v_exp_f32 v78, v78
    v_exp_f32 v79, v79
    v_cvt_pk_bf16_f32 v102, v76, v77
    v_cvt_pk_bf16_f32 v103, v78, v79
    s_waitcnt lgkmcnt(0)
    v_mfma_f32_32x32x16_bf16 v[64:79], v[20:23], v[88:91], 0
    v_exp_f32 v48, v48
    v_exp_f32 v49, v49
    v_exp_f32 v50, v50
    v_exp_f32 v51, v51
    v_cvt_pk_bf16_f32 v96, v48, v49
    v_cvt_pk_bf16_f32 v97, v50, v51
    v_mfma_f32_32x32x16_bf16 v[104:119], v[44:47], v[100:103], v[104:119]
    ds_read_b128 v[16:19], v2 offset:23680
    ds_read_b32 v24, v3 offset:24704
    v_exp_f32 v52, v52
    v_exp_f32 v53, v53
    v_exp_f32 v54, v54
    v_exp_f32 v55, v55
    v_cvt_pk_bf16_f32 v98, v52, v53
    v_cvt_pk_bf16_f32 v99, v54, v55
    v_mfma_f32_32x32x16_bf16 v[64:79], v[28:31], v[92:95], v[64:79]
    s_mov_b64 exec, s[10:11]
    ds_read_b128 v[40:43], v4 offset:22464
    ds_read_b128 v[44:47], v4 offset:23072
    s_mov_b64 exec, -1
    v_exp_f32 v56, v56
    v_exp_f32 v57, v57
    v_exp_f32 v58, v58
    v_exp_f32 v59, v59
    v_cvt_pk_bf16_f32 v100, v56, v57
    v_cvt_pk_bf16_f32 v101, v58, v59
    v_mfma_f32_32x32x16_bf16 v[104:119], v[32:35], v[96:99], v[104:119]
    v_exp_f32 v60, v60
    v_exp_f32 v61, v61
    v_exp_f32 v62, v62
    v_exp_f32 v63, v63
    v_cvt_pk_bf16_f32 v102, v60, v61
    v_cvt_pk_bf16_f32 v103, v62, v63
    s_waitcnt lgkmcnt(0)
    v_mfma_f32_32x32x16_bf16 v[48:63], v[16:19], v[88:91], 0
    v_exp_f32 v64, v64
    v_exp_f32 v65, v65
    v_exp_f32 v66, v66
    v_exp_f32 v67, v67
    v_cvt_pk_bf16_f32 v96, v64, v65
    v_cvt_pk_bf16_f32 v97, v66, v67
    v_mfma_f32_32x32x16_bf16 v[104:119], v[36:39], v[100:103], v[104:119]
    ds_read_b128 v[20:23], v2 offset:26048
    ds_read_b32 v28, v3 offset:27072
    v_exp_f32 v68, v68
    v_exp_f32 v69, v69
    v_exp_f32 v70, v70
    v_exp_f32 v71, v71
    v_cvt_pk_bf16_f32 v98, v68, v69
    v_cvt_pk_bf16_f32 v99, v70, v71
    v_mfma_f32_32x32x16_bf16 v[48:63], v[24:27], v[92:95], v[48:63]
    s_mov_b64 exec, s[10:11]
    ds_read_b128 v[32:35], v4 offset:24832
    ds_read_b128 v[36:39], v4 offset:25440
    s_mov_b64 exec, -1
    v_exp_f32 v72, v72
    v_exp_f32 v73, v73
    v_exp_f32 v74, v74
    v_exp_f32 v75, v75
    v_cvt_pk_bf16_f32 v100, v72, v73
    v_cvt_pk_bf16_f32 v101, v74, v75
    v_mfma_f32_32x32x16_bf16 v[104:119], v[40:43], v[96:99], v[104:119]
    v_exp_f32 v76, v76
    v_exp_f32 v77, v77
    v_exp_f32 v78, v78
    v_exp_f32 v79, v79
    v_cvt_pk_bf16_f32 v102, v76, v77
    v_cvt_pk_bf16_f32 v103, v78, v79
    s_waitcnt lgkmcnt(0)
    v_mfma_f32_32x32x16_bf16 v[64:79], v[20:23], v[88:91], 0
    v_exp_f32 v48, v48
    v_exp_f32 v49, v49
    v_exp_f32 v50, v50
    v_exp_f32 v51, v51
    v_cvt_pk_bf16_f32 v96, v48, v49
    v_cvt_pk_bf16_f32 v97, v50, v51
    v_mfma_f32_32x32x16_bf16 v[104:119], v[44:47], v[100:103], v[104:119]
    ds_read_b128 v[16:19], v2 offset:28416
    ds_read_b32 v24, v3 offset:29440
    v_exp_f32 v52, v52
    v_exp_f32 v53, v53
    v_exp_f32 v54, v54
    v_exp_f32 v55, v55
    v_cvt_pk_bf16_f32 v98, v52, v53
    v_cvt_pk_bf16_f32 v99, v54, v55
    v_mfma_f32_32x32x16_bf16 v[64:79], v[28:31], v[92:95], v[64:79]
    s_mov_b64 exec, s[10:11]
    ds_read_b128 v[40:43], v4 offset:27200
    ds_read_b128 v[44:47], v4 offset:27808
    s_mov_b64 exec, -1
    v_exp_f32 v56, v56
    v_exp_f32 v57, v57
    v_exp_f32 v58, v58
    v_exp_f32 v59, v59
    v_cvt_pk_bf16_f32 v100, v56, v57
    v_cvt_pk_bf16_f32 v101, v58, v59
    v_mfma_f32_32x32x16_bf16 v[104:119], v[32:35], v[96:99], v[104:119]
    v_exp_f32 v60, v60
    v_exp_f32 v61, v61
    v_exp_f32 v62, v62
    v_exp_f32 v63, v63
    v_cvt_pk_bf16_f32 v102, v60, v61
    v_cvt_pk_bf16_f32 v103, v62, v63
    s_waitcnt lgkmcnt(0)
    v_mfma_f32_32x32x16_bf16 v[48:63], v[16:19], v[88:91], 0
    v_exp_f32 v64, v64
    v_exp_f32 v65, v65
    v_exp_f32 v66, v66
    v_exp_f32 v67, v67
    v_cvt_pk_bf16_f32 v96, v64, v65
    v_cvt_pk_bf16_f32 v97, v66, v67
    v_mfma_f32_32x32x16_bf16 v[104:119], v[36:39], v[100:103], v[104:119]
    ds_read_b128 v[20:23], v2 offset:30784
    ds_read_b32 v28, v3 offset:31808
    v_exp_f32 v68, v68
    v_exp_f32 v69, v69
    v_exp_f32 v70, v70
    v_exp_f32 v71, v71
    v_cvt_pk_bf16_f32 v98, v68, v69
    v_cvt_pk_bf16_f32 v99, v70, v71
    v_mfma_f32_32x32x16_bf16 v[48:63], v[24:27], v[92:95], v[48:63]
    s_mov_b64 exec, s[10:11]
    ds_read_b128 v[32:35], v4 offset:29568
    ds_read_b128 v[36:39], v4 offset:30176
    s_mov_b64 exec, -1
    v_exp_f32 v72, v72
    v_exp_f32 v73, v73
    v_exp_f32 v74, v74
    v_exp_f32 v75, v75
    v_cvt_pk_bf16_f32 v100, v72, v73
    v_cvt_pk_bf16_f32 v101, v74, v75
    v_mfma_f32_32x32x16_bf16 v[104:119], v[40:43], v[96:99], v[104:119]
    v_exp_f32 v76, v76
    v_exp_f32 v77, v77
    v_exp_f32 v78, v78
    v_exp_f32 v79, v79
    v_cvt_pk_bf16_f32 v102, v76, v77
    v_cvt_pk_bf16_f32 v103, v78, v79
    s_waitcnt lgkmcnt(0)
    v_mfma_f32_32x32x16_bf16 v[64:79], v[20:23], v[88:91], 0
    v_exp_f32 v48, v48
    v_exp_f32 v49, v49
    v_exp_f32 v50, v50
    v_exp_f32 v51, v51
    v_cvt_pk_bf16_f32 v96, v48, v49
    v_cvt_pk_bf16_f32 v97, v50, v51
    v_mfma_f32_32x32x16_bf16 v[104:119], v[44:47], v[100:103], v[104:119]
    ds_read_b128 v[16:19], v2 offset:33152
    ds_read_b32 v24, v3 offset:34176
    v_exp_f32 v52, v52
    v_exp_f32 v53, v53
    v_exp_f32 v54, v54
    v_exp_f32 v55, v55
    v_cvt_pk_bf16_f32 v98, v52, v53
    v_cvt_pk_bf16_f32 v99, v54, v55
    v_mfma_f32_32x32x16_bf16 v[64:79], v[28:31], v[92:95], v[64:79]
    s_mov_b64 exec, s[10:11]
    ds_read_b128 v[40:43], v4 offset:31936
    ds_read_b128 v[44:47], v4 offset:32544
    s_mov_b64 exec, -1
    v_exp_f32 v56, v56
    v_exp_f32 v57, v57
    v_exp_f32 v58, v58
    v_exp_f32 v59, v59
    v_cvt_pk_bf16_f32 v100, v56, v57
    v_cvt_pk_bf16_f32 v101, v58, v59
    v_mfma_f32_32x32x16_bf16 v[104:119], v[32:35], v[96:99], v[104:119]
    v_exp_f32 v60, v60
    v_exp_f32 v61, v61
    v_exp_f32 v62, v62
    v_exp_f32 v63, v63
    v_cvt_pk_bf16_f32 v102, v60, v61
    v_cvt_pk_bf16_f32 v103, v62, v63
    s_waitcnt lgkmcnt(0)
    v_mfma_f32_32x32x16_bf16 v[48:63], v[16:19], v[88:91], 0
    v_exp_f32 v64, v64
    v_exp_f32 v65, v65
    v_exp_f32 v66, v66
    v_exp_f32 v67, v67
    v_cvt_pk_bf16_f32 v96, v64, v65
    v_cvt_pk_bf16_f32 v97, v66, v67
    v_mfma_f32_32x32x16_bf16 v[104:119], v[36:39], v[100:103], v[104:119]
    ds_read_b128 v[20:23], v2 offset:35520
    ds_read_b32 v28, v3 offset:36544
    v_exp_f32 v68, v68
    v_exp_f32 v69, v69
    v_exp_f32 v70, v70
    v_exp_f32 v71, v71
    v_cvt_pk_bf16_f32 v98, v68, v69
    v_cvt_pk_bf16_f32 v99, v70, v71
    v_mfma_f32_32x32x16_bf16 v[48:63], v[24:27], v[92:95], v[48:63]
    s_mov_b64 exec, s[10:11]
    ds_read_b128 v[32:35], v4 offset:34304
    ds_read_b128 v[36:39], v4 offset:34912
    s_mov_b64 exec, -1
    v_exp_f32 v72, v72
    v_exp_f32 v73, v73
    v_exp_f32 v74, v74
    v_exp_f32 v75, v75
    v_cvt_pk_bf16_f32 v100, v72, v73
    v_cvt_pk_bf16_f32 v101, v74, v75
    v_mfma_f32_32x32x16_bf16 v[104:119], v[40:43], v[96:99], v[104:119]
    v_exp_f32 v76, v76
    v_exp_f32 v77, v77
    v_exp_f32 v78, v78
    v_exp_f32 v79, v79
    v_cvt_pk_bf16_f32 v102, v76, v77
    v_cvt_pk_bf16_f32 v103, v78, v79
    s_waitcnt lgkmcnt(0)
    v_mfma_f32_32x32x16_bf16 v[64:79], v[20:23], v[88:91], 0
    v_exp_f32 v48, v48
    v_exp_f32 v49, v49
    v_exp_f32 v50, v50
    v_exp_f32 v51, v51
    v_cvt_pk_bf16_f32 v96, v48, v49
    v_cvt_pk_bf16_f32 v97, v50, v51
    v_mfma_f32_32x32x16_bf16 v[104:119], v[44:47], v[100:103], v[104:119]
    ds_read_b128 v[16:19], v2 offset:37888
    ds_read_b32 v24, v3 offset:38912
    v_exp_f32 v52, v52
    v_exp_f32 v53, v53
    v_exp_f32 v54, v54
    v_exp_f32 v55, v55
    v_cvt_pk_bf16_f32 v98, v52, v53
    v_cvt_pk_bf16_f32 v99, v54, v55
    v_mfma_f32_32x32x16_bf16 v[64:79], v[28:31], v[92:95], v[64:79]
    s_mov_b64 exec, s[10:11]
    ds_read_b128 v[40:43], v4 offset:36672
    ds_read_b128 v[44:47], v4 offset:37280
    s_mov_b64 exec, -1
    v_exp_f32 v56, v56
    v_exp_f32 v57, v57
    v_exp_f32 v58, v58
    v_exp_f32 v59, v59
    v_cvt_pk_bf16_f32 v100, v56, v57
    v_cvt_pk_bf16_f32 v101, v58, v59
    v_mfma_f32_32x32x16_bf16 v[104:119], v[32:35], v[96:99], v[104:119]
    v_exp_f32 v60, v60
    v_exp_f32 v61, v61
    v_exp_f32 v62, v62
    v_exp_f32 v63, v63
    v_cvt_pk_bf16_f32 v102, v60, v61
    v_cvt_pk_bf16_f32 v103, v62, v63
    s_waitcnt lgkmcnt(0)
    v_mfma_f32_32x32x16_bf16 v[48:63], v[16:19], v[88:91], 0
    v_exp_f32 v64, v64
    v_exp_f32 v65, v65
    v_exp_f32 v66, v66
    v_exp_f32 v67, v67
    v_cvt_pk_bf16_f32 v96, v64, v65
    v_cvt_pk_bf16_f32 v97, v66, v67
    v_mfma_f32_32x32x16_bf16 v[104:119], v[36:39], v[100:103], v[104:119]
    ds_read_b128 v[20:23], v2 offset:40256
    ds_read_b32 v28, v3 offset:41280
    v_exp_f32 v68, v68
    v_exp_f32 v69, v69
    v_exp_f32 v70, v70
    v_exp_f32 v71, v71
    v_cvt_pk_bf16_f32 v98, v68, v69
    v_cvt_pk_bf16_f32 v99, v70, v71
    v_mfma_f32_32x32x16_bf16 v[48:63], v[24:27], v[92:95], v[48:63]
    s_mov_b64 exec, s[10:11]
    ds_read_b128 v[32:35], v4 offset:39040
    ds_read_b128 v[36:39], v4 offset:39648
    s_mov_b64 exec, -1
    v_exp_f32 v72, v72
    v_exp_f32 v73, v73
    v_exp_f32 v74, v74
    v_exp_f32 v75, v75
    v_cvt_pk_bf16_f32 v100, v72, v73
    v_cvt_pk_bf16_f32 v101, v74, v75
    v_mfma_f32_32x32x16_bf16 v[104:119], v[40:43], v[96:99], v[104:119]
    v_exp_f32 v76, v76
    v_exp_f32 v77, v77
    v_exp_f32 v78, v78
    v_exp_f32 v79, v79
    v_cvt_pk_bf16_f32 v102, v76, v77
    v_cvt_pk_bf16_f32 v103, v78, v79
    v_add_u32 v2, 37888, v2
    v_add_u32 v3, 37888, v3
    v_add_u32 v4, 37888, v4
    s_add_u32 s12, s12, 1
    s_cmp_lg_u32 s12, 4
    s_cbranch_scc1 ATT_LOOP
ATT_DONE:
    s_nop 1
    v_mfma_f32_32x32x16_bf16 v[104:119], v[44:47], v[100:103], v[104:119]
    s_waitcnt lgkmcnt(0)
    v_subrev_u32 v2, 151552, v2
    v_subrev_u32 v3, 151552, v3
    v_subrev_u32 v4, 151552, v4
    s_nop 15
    v_mov_b32 v5, v114
    v_mov_b32 v6, v114
    s_nop 1
    v_permlane32_swap_b32 v5, v6
    s_nop 1
    v_rcp_f32 v6, v5
    s_nop 0
    v_mul_f32 v104, v104, v6
    v_mul_f32 v105, v105, v6
    v_mul_f32 v106, v106, v6
    v_mul_f32 v107, v107, v6
    v_mul_f32 v108, v108, v6
    v_mul_f32 v109, v109, v6
    v_mul_f32 v110, v110, v6
    v_mul_f32 v111, v111, v6
    v_mul_f32 v112, v112, v6
    v_mul_f32 v113, v113, v6
    v_cndmask_b32 v112, 0, v112, s[70:71]
    v_cndmask_b32 v113, 0, v113, s[70:71]
    v_max3_f32 v7, abs(v104), abs(v105), abs(v106)
    v_add_f32 v8, v104, v105
    v_add_f32 v8, v8, v106
    v_add_f32 v8, v8, v107
    v_add_f32 v8, v8, v108
    v_add_f32 v8, v8, v109
    v_add_f32 v8, v8, v110
    v_add_f32 v8, v8, v111
    v_add_f32 v8, v8, v112
    v_add_f32 v8, v8, v113
    v_max3_f32 v7, v7, abs(v107), abs(v108)
    v_max3_f32 v7, v7, abs(v109), abs(v110)
    v_max3_f32 v7, v7, abs(v111), abs(v112)
    v_max_f32 v7, v7, abs(v113)
    v_mov_b32 v9, 0x6f800000
    v_cmp_nle_f32 vcc, v5, v9
    v_mov_b32 v9, 0x7f000000
    v_cmp_nle_f32 s[74:75], v7, v9
    v_cmp_u_f32 s[68:69], v8, v8
    s_nop 3
    s_or_b64 s[74:75], s[74:75], vcc
    s_or_b64 s[74:75], s[74:75], s[68:69]
    s_cmp_eq_u64 s[74:75], 0
    s_cbranch_scc1 ATT_OUT
    s_cmp_lg_u32 s72, 0
    s_cbranch_scc1 ATT_OUT
    s_mov_b32 s72, 1
    v_mov_b32 v93, 0
    v_mov_b32 v94, 0
    v_mov_b32 v5, 0xff800000
    s_mov_b32 s12, 0
ATT_MAXL:
    ds_read_b128 v[16:19], v2 offset:0
    ds_read_b32 v24, v3 offset:1024
    s_waitcnt lgkmcnt(0)
    v_mfma_f32_32x32x16_bf16 v[48:63], v[16:19], v[88:91], 0
    v_mfma_f32_32x32x16_bf16 v[48:63], v[24:27], v[92:95], v[48:63]
    s_nop 15
    s_nop 3
    v_max3_f32 v5, v5, v48, v49
    v_max3_f32 v5, v5, v50, v51
    v_max3_f32 v5, v5, v52, v53
    v_max3_f32 v5, v5, v54, v55
    v_max3_f32 v5, v5, v56, v57
    v_max3_f32 v5, v5, v58, v59
    v_max3_f32 v5, v5, v60, v61
    v_max3_f32 v5, v5, v62, v63
    v_add_u32 v2, 2368, v2
    v_add_u32 v3, 2368, v3
    s_add_u32 s12, s12, 1
    s_cmp_lg_u32 s12, 64
    s_cbranch_scc1 ATT_MAXL
    v_subrev_u32 v2, 151552, v2
    v_subrev_u32 v3, 151552, v3
    v_mov_b32 v9, v5
    s_nop 1
    v_permlane32_swap_b32 v9, v5
    s_nop 1
    v_max_f32 v5, v5, v9
    v_sub_f32 v9, 0, v5
    v_and_b32 v10, 0xffff0000, v9
    v_sub_f32 v9, v9, v10
    v_and_b32 v11, 0xffff0000, v9
    v_sub_f32 v9, v9, v11
    v_lshrrev_b32 v10, 16, v10
    v_or_b32 v10, v10, v11
    v_lshrrev_b32 v9, 16, v9
    v_cndmask_b32 v93, 0, v10, s[70:71]
    v_cndmask_b32 v94, 0, v9, s[70:71]
    s_branch ATT_PASS
ATT_OUT:
    v_cvt_pk_bf16_f32 v16, v104, v105
    v_cvt_pk_bf16_f32 v17, v106, v107
    v_cvt_pk_bf16_f32 v18, v108, v109
    v_cvt_pk_bf16_f32 v19, v110, v111
    v_cvt_pk_bf16_f32 v20, v112, v113
    s_lshr_b32 s56, s3, 1
    s_lshl_b32 s57, s4, 2
    s_add_u32 s56, s56, s57
    s_mul_i32 s56, s56, 36
    s_and_b32 s57, s3, 1
    s_lshl_b32 s58, s5, 1
    s_add_u32 s57, s57, s58
    s_add_u32 s58, s56, s57
    s_lshl_b32 s58, s58, 10
    s_add_u32 s58, s58, 2523136
    buffer_store_dwordx4 v[16:19], v1, s[44:47], s58 offen sc1
    s_lshr_b32 s59, s57, 3
    s_add_u32 s59, s59, s56
    s_add_u32 s59, s59, 32
    s_lshl_b32 s59, s59, 10
    s_bfe_u32 s60, s57, 0x10002
    s_lshl_b32 s60, s60, 9
    s_add_u32 s59, s59, s60
    s_and_b32 s60, s57, 3
    s_lshl_b32 s60, s60, 2
    s_add_u32 s59, s59, s60
    s_add_u32 s59, s59, 2523136
    s_mov_b32 exec_hi, 0
    buffer_store_dword v20, v1, s[44:47], s59 offen sc1
    s_mov_b64 exec, -1
    s_waitcnt vmcnt(8)
    v_mfma_f32_32x32x16_bf16 v[220:235], v[84:87], v[208:211], v[220:235]
    buffer_load_dwordx4 v[208:211], v255, s[44:47], s8 offen offset:1024 sc1
    s_waitcnt vmcnt(7)
    v_mfma_f32_32x32x16_bf16 v[220:235], v[12:15], v[212:215], v[220:235]
    buffer_load_dwordx4 v[212:215], v255, s[44:47], s9 offen offset:1536 sc1
    s_waitcnt vmcnt(6)
    v_mfma_f32_32x32x16_bf16 v[220:235], v[84:87], v[216:219], v[220:235]
    buffer_load_dwordx4 v[216:219], v255, s[44:47], s9 offen offset:2048 sc1
    s_waitcnt vmcnt(3)
    s_barrier
    s_cmp_lg_u32 s3, 6
    s_cbranch_scc1 FIN_WAIT
    s_lshl_b32 s56, s4, 7
    s_lshl_b32 s57, s5, 3
    s_add_u32 s56, s56, s57
    s_add_u32 s56, s56, 5552128
    v_mov_b32 v6, s76
    v_mov_b32 v7, s77
    s_mov_b32 exec_lo, 1
    s_mov_b32 exec_hi, 0
    buffer_store_dwordx2 v[6:7], off, s[44:47], s56 sc1
    s_mov_b64 exec, -1
    s_nop 1
    v_and_b32 v8, 15, v0
    v_lshlrev_b32 v8, 3, v8
    s_lshl_b32 s62, s4, 7
    s_add_u32 s62, s62, 5552128
    s_mov_b32 s68, 0
FIN_POLL:
    buffer_load_dwordx2 v[24:25], v8, s[44:47], s62 offen sc1
    s_waitcnt vmcnt(0)
    v_cmp_eq_u32 vcc, s76, v24
    v_cmp_eq_u32 s[74:75], s77, v25
    s_nop 3
    s_and_b64 vcc, vcc, s[74:75]
    s_cmp_eq_u64 vcc, -1
    s_cbranch_scc1 FIN_WAIT
    s_sleep 2
    s_add_u32 s68, s68, 1
    s_cmp_lt_u32 s68, 0x8000
    s_cbranch_scc1 FIN_POLL
FIN_WAIT:
    s_barrier
    s_mul_i32 s58, s63, 36864
    s_add_u32 s58, s58, 2523136
    s_add_u32 s57, s3, 0
    s_min_u32 s57, s57, 35
    s_lshl_b32 m0, s57, 10
    s_lshl_b32 s57, s57, 10
    s_add_u32 s57, s57, s58
    buffer_load_dwordx4 v1, s[44:47], s57 offen sc1 lds
    s_add_u32 s57, s3, 8
    s_min_u32 s57, s57, 35
    s_lshl_b32 m0, s57, 10
    s_lshl_b32 s57, s57, 10
    s_add_u32 s57, s57, s58
    buffer_load_dwordx4 v1, s[44:47], s57 offen sc1 lds
    s_add_u32 s57, s3, 16
    s_min_u32 s57, s57, 35
    s_lshl_b32 m0, s57, 10
    s_lshl_b32 s57, s57, 10
    s_add_u32 s57, s57, s58
    buffer_load_dwordx4 v1, s[44:47], s57 offen sc1 lds
    s_add_u32 s57, s3, 24
    s_min_u32 s57, s57, 35
    s_lshl_b32 m0, s57, 10
    s_lshl_b32 s57, s57, 10
    s_add_u32 s57, s57, s58
    buffer_load_dwordx4 v1, s[44:47], s57 offen sc1 lds
    s_add_u32 s57, s3, 32
    s_min_u32 s57, s57, 35
    s_lshl_b32 m0, s57, 10
    s_lshl_b32 s57, s57, 10
    s_add_u32 s57, s57, s58
    buffer_load_dwordx4 v1, s[44:47], s57 offen sc1 lds
    s_lshl_b32 s56, s7, 10
    v_add_u32 v254, s56, v1
    s_lshl_b32 s56, s67, 10
    v_add_u32 v255, s56, v254
    s_waitcnt vmcnt(0)
    s_barrier
    ds_read_b128 v[56:59], v254 offset:0
    ds_read_b128 v[60:63], v254 offset:1024
    ds_read_b128 v[64:67], v254 offset:2048
    ds_read_b128 v[68:71], v254 offset:3072
    ds_read_b128 v[72:75], v254 offset:4096
    ds_read_b128 v[76:79], v254 offset:5120
    ds_read_b128 v[80:83], v254 offset:6144
    ds_read_b128 v[84:87], v254 offset:7168
    ds_read_b128 v[88:91], v254 offset:8192
    ds_read_b128 v[92:95], v254 offset:9216
    s_waitcnt lgkmcnt(9)
    v_mfma_f32_32x32x16_bf16 v[220:235], v[128:131], v[56:59], v[220:235]
    ds_read_b128 v[56:59], v254 offset:10240
    s_waitcnt lgkmcnt(9)
    v_mfma_f32_32x32x16_bf16 v[220:235], v[132:135], v[60:63], v[220:235]
    ds_read_b128 v[60:63], v254 offset:11264
    s_waitcnt lgkmcnt(9)
    v_mfma_f32_32x32x16_bf16 v[220:235], v[136:139], v[64:67], v[220:235]
    ds_read_b128 v[64:67], v254 offset:12288
    s_waitcnt lgkmcnt(9)
    v_mfma_f32_32x32x16_bf16 v[220:235], v[140:143], v[68:71], v[220:235]
    ds_read_b128 v[68:71], v254 offset:13312
    s_waitcnt lgkmcnt(9)
    v_mfma_f32_32x32x16_bf16 v[220:235], v[144:147], v[72:75], v[220:235]
    ds_read_b128 v[72:75], v254 offset:14336
    s_waitcnt lgkmcnt(9)
    v_mfma_f32_32x32x16_bf16 v[220:235], v[148:151], v[76:79], v[220:235]
    ds_read_b128 v[76:79], v254 offset:15360
    s_waitcnt lgkmcnt(9)
    v_mfma_f32_32x32x16_bf16 v[220:235], v[152:155], v[80:83], v[220:235]
    ds_read_b128 v[80:83], v254 offset:16384
    s_waitcnt lgkmcnt(9)
    v_mfma_f32_32x32x16_bf16 v[220:235], v[156:159], v[84:87], v[220:235]
    ds_read_b128 v[84:87], v254 offset:17408
    s_waitcnt lgkmcnt(9)
    v_mfma_f32_32x32x16_bf16 v[220:235], v[160:163], v[88:91], v[220:235]
    ds_read_b128 v[88:91], v255 offset:0
    s_waitcnt lgkmcnt(9)
    v_mfma_f32_32x32x16_bf16 v[220:235], v[164:167], v[92:95], v[220:235]
    ds_read_b128 v[92:95], v255 offset:1024
    s_waitcnt lgkmcnt(9)
    v_mfma_f32_32x32x16_bf16 v[220:235], v[168:171], v[56:59], v[220:235]
    ds_read_b128 v[56:59], v255 offset:2048
    s_waitcnt lgkmcnt(9)
    v_mfma_f32_32x32x16_bf16 v[220:235], v[172:175], v[60:63], v[220:235]
    ds_read_b128 v[60:63], v255 offset:3072
    s_waitcnt lgkmcnt(9)
    v_mfma_f32_32x32x16_bf16 v[220:235], v[176:179], v[64:67], v[220:235]
    ds_read_b128 v[64:67], v255 offset:4096
    s_waitcnt lgkmcnt(9)
    v_mfma_f32_32x32x16_bf16 v[220:235], v[180:183], v[68:71], v[220:235]
    s_waitcnt lgkmcnt(8)
    v_mfma_f32_32x32x16_bf16 v[220:235], v[184:187], v[72:75], v[220:235]
    s_waitcnt lgkmcnt(7)
    v_mfma_f32_32x32x16_bf16 v[220:235], v[188:191], v[76:79], v[220:235]
    s_waitcnt lgkmcnt(6)
    v_mfma_f32_32x32x16_bf16 v[220:235], v[192:195], v[80:83], v[220:235]
    s_waitcnt lgkmcnt(5)
    v_mfma_f32_32x32x16_bf16 v[220:235], v[196:199], v[84:87], v[220:235]
    s_waitcnt lgkmcnt(4)
    v_mfma_f32_32x32x16_bf16 v[236:251], v[200:203], v[88:91], v[236:251]
    s_waitcnt lgkmcnt(3)
    v_mfma_f32_32x32x16_bf16 v[236:251], v[204:207], v[92:95], v[236:251]
    s_waitcnt lgkmcnt(2)
    v_mfma_f32_32x32x16_bf16 v[236:251], v[208:211], v[56:59], v[236:251]
    s_waitcnt lgkmcnt(1)
    v_mfma_f32_32x32x16_bf16 v[236:251], v[212:215], v[60:63], v[236:251]
    s_waitcnt lgkmcnt(0)
    v_mfma_f32_32x32x16_bf16 v[236:251], v[216:219], v[64:67], v[236:251]
    s_nop 15
    s_lshl_b32 s56, s3, 11
    s_add_u32 s56, s56, 40960
    v_add_u32 v254, s56, v1
    s_and_b32 s57, s3, 1
    s_cmp_eq_u32 s57, 0
    s_cselect_b64 s[74:75], -1, 0
    v_cndmask_b32 v24, v220, v228, s[74:75]
    v_cndmask_b32 v32, v228, v220, s[74:75]
    v_cndmask_b32 v25, v221, v229, s[74:75]
    v_cndmask_b32 v33, v229, v221, s[74:75]
    v_cndmask_b32 v26, v222, v230, s[74:75]
    v_cndmask_b32 v34, v230, v222, s[74:75]
    v_cndmask_b32 v27, v223, v231, s[74:75]
    v_cndmask_b32 v35, v231, v223, s[74:75]
    v_cndmask_b32 v28, v224, v232, s[74:75]
    v_cndmask_b32 v36, v232, v224, s[74:75]
    v_cndmask_b32 v29, v225, v233, s[74:75]
    v_cndmask_b32 v37, v233, v225, s[74:75]
    v_cndmask_b32 v30, v226, v234, s[74:75]
    v_cndmask_b32 v38, v234, v226, s[74:75]
    v_cndmask_b32 v31, v227, v235, s[74:75]
    v_cndmask_b32 v39, v235, v227, s[74:75]
    ds_write_b128 v254, v[24:27]
    ds_write_b128 v254, v[28:31] offset:1024
    ds_write_b128 v254, v[236:239] offset:16384
    ds_write_b128 v254, v[240:243] offset:17408
    v_lshlrev_b32 v96, 16, v120
    v_and_b32 v97, 0xffff0000, v120
    v_lshlrev_b32 v98, 16, v121
    v_and_b32 v99, 0xffff0000, v121
    v_lshlrev_b32 v100, 16, v122
    v_and_b32 v101, 0xffff0000, v122
    v_lshlrev_b32 v102, 16, v123
    v_and_b32 v103, 0xffff0000, v123
    v_lshlrev_b32 v104, 16, v124
    v_and_b32 v105, 0xffff0000, v124
    v_lshlrev_b32 v106, 16, v125
    v_and_b32 v107, 0xffff0000, v125
    v_lshlrev_b32 v108, 16, v126
    v_and_b32 v109, 0xffff0000, v126
    v_lshlrev_b32 v110, 16, v127
    v_and_b32 v111, 0xffff0000, v127
    v_add_f32 v96, v96, v32
    v_add_f32 v97, v97, v33
    v_add_f32 v98, v98, v34
    v_add_f32 v99, v99, v35
    v_add_f32 v100, v100, v36
    v_add_f32 v101, v101, v37
    v_add_f32 v102, v102, v38
    v_add_f32 v103, v103, v39
    v_xor_b32 v254, 2048, v254
    v_lshrrev_b32 v255, 3, v0
    v_lshlrev_b32 v255, 11, v255
    v_and_b32 v10, 7, v0
    v_lshl_add_u32 v255, v10, 4, v255
    s_lshl_b32 s56, s3, 7
    s_add_u32 s56, s56, 57344
    v_add_u32 v255, s56, v255
    s_waitcnt lgkmcnt(0)
    s_barrier
    ds_read_b128 v[24:27], v254
    ds_read_b128 v[28:31], v254 offset:1024
    ds_read_b128 v[32:35], v255
    ds_read_b128 v[36:39], v255 offset:1024
    s_waitcnt lgkmcnt(2)
    v_add_f32 v96, v96, v24
    v_add_f32 v97, v97, v25
    v_add_f32 v98, v98, v26
    v_add_f32 v99, v99, v27
    v_add_f32 v100, v100, v28
    v_add_f32 v101, v101, v29
    v_add_f32 v102, v102, v30
    v_add_f32 v103, v103, v31
    v_cvt_pk_bf16_f32 v40, v96, v97
    v_cvt_pk_bf16_f32 v41, v98, v99
    v_cvt_pk_bf16_f32 v42, v100, v101
    v_cvt_pk_bf16_f32 v43, v102, v103
    buffer_store_dwordx2 v[40:41], v252, s[48:51], s65 offen
    buffer_store_dwordx2 v[42:43], v252, s[48:51], s65 offen offset:16
    s_waitcnt lgkmcnt(0)
    v_add_f32_dpp v32, v32, v32 row_ror:8 row_mask:0xf bank_mask:0xf
    v_add_f32_dpp v33, v33, v33 row_ror:8 row_mask:0xf bank_mask:0xf
    v_add_f32_dpp v34, v34, v34 row_ror:8 row_mask:0xf bank_mask:0xf
    v_add_f32_dpp v35, v35, v35 row_ror:8 row_mask:0xf bank_mask:0xf
    v_add_f32_dpp v36, v36, v36 row_ror:8 row_mask:0xf bank_mask:0xf
    v_add_f32_dpp v37, v37, v37 row_ror:8 row_mask:0xf bank_mask:0xf
    v_add_f32_dpp v38, v38, v38 row_ror:8 row_mask:0xf bank_mask:0xf
    v_add_f32_dpp v39, v39, v39 row_ror:8 row_mask:0xf bank_mask:0xf
    v_mov_b32 v48, v32
    v_mov_b32 v49, v33
    v_mov_b32 v50, v34
    v_mov_b32 v51, v35
    v_mov_b32 v52, v36
    v_mov_b32 v53, v37
    v_mov_b32 v54, v38
    v_mov_b32 v55, v39
    v_permlane16_swap_b32 v48, v32
    v_permlane16_swap_b32 v49, v33
    v_permlane16_swap_b32 v50, v34
    v_permlane16_swap_b32 v51, v35
    v_permlane16_swap_b32 v52, v36
    v_permlane16_swap_b32 v53, v37
    v_permlane16_swap_b32 v54, v38
    v_permlane16_swap_b32 v55, v39
    s_nop 1
    v_add_f32 v32, v32, v48
    v_add_f32 v33, v33, v49
    v_add_f32 v34, v34, v50
    v_add_f32 v35, v35, v51
    v_add_f32 v36, v36, v52
    v_add_f32 v37, v37, v53
    v_add_f32 v38, v38, v54
    v_add_f32 v39, v39, v55
    v_mov_b32 v48, v32
    v_mov_b32 v49, v33
    v_mov_b32 v50, v34
    v_mov_b32 v51, v35
    v_mov_b32 v52, v36
    v_mov_b32 v53, v37
    v_mov_b32 v54, v38
    v_mov_b32 v55, v39
    v_permlane32_swap_b32 v48, v32
    v_permlane32_swap_b32 v49, v33
    v_permlane32_swap_b32 v50, v34
    v_permlane32_swap_b32 v51, v35
    v_permlane32_swap_b32 v52, v36
    v_permlane32_swap_b32 v53, v37
    v_permlane32_swap_b32 v54, v38
    v_permlane32_swap_b32 v55, v39
    s_nop 1
    v_add_f32 v32, v32, v48
    v_add_f32 v33, v33, v49
    v_add_f32 v34, v34, v50
    v_add_f32 v35, v35, v51
    v_add_f32 v36, v36, v52
    v_add_f32 v37, v37, v53
    v_add_f32 v38, v38, v54
    v_add_f32 v39, v39, v55
    v_add_f32 v104, v104, v32
    v_add_f32 v105, v105, v33
    v_add_f32 v106, v106, v34
    v_add_f32 v107, v107, v35
    v_add_f32 v108, v108, v36
    v_add_f32 v109, v109, v37
    v_add_f32 v110, v110, v38
    v_add_f32 v111, v111, v39
    v_cvt_pk_bf16_f32 v44, v104, v105
    v_cvt_pk_bf16_f32 v45, v106, v107
    v_cvt_pk_bf16_f32 v46, v108, v109
    v_cvt_pk_bf16_f32 v47, v110, v111
    s_mov_b32 exec_lo, 0xff
    s_mov_b32 exec_hi, 0
    buffer_store_dwordx2 v[44:45], v253, s[48:51], s66 offen
    buffer_store_dwordx2 v[46:47], v253, s[48:51], s66 offen offset:16
END:
    s_endpgm
CODE_END:
.section .rodata,"a"
.p2align 6
.amdhsa_kernel parallel_sum__grouped_kv_mqa__glu_gated_reglu__prompt_kernel
  .amdhsa_next_free_vgpr 256
  .amdhsa_next_free_sgpr 102
  .amdhsa_accum_offset 256
  .amdhsa_group_segment_fixed_size 0
  .amdhsa_kernarg_size 96
  .amdhsa_user_sgpr_count 2
  .amdhsa_user_sgpr_kernarg_segment_ptr 1
  .amdhsa_system_sgpr_workgroup_id_x 1
.end_amdhsa_kernel
```
